```python
import torch

def _softmax(x, axis=-1):
    return torch.softmax(x, dim=axis)
def _gelu(x):
    return torch.nn.functional.gelu(x, approximate="tanh")
def _silu(x):
    return torch.nn.functional.silu(x)
def _sigmoid(x):
    return torch.sigmoid(x)
def _layernorm(x, axis=-1, eps=1e-5):
    m = x.mean(dim=axis, keepdim=True)
    v = x.var(dim=axis, keepdim=True, unbiased=False)
    return (x - m) / torch.sqrt(v + eps)
def _scatter_add(tgt, idx, src, axis=0):
    return tgt.clone().index_add_(axis, idx, src)
def _segment_sum(src, seg, n):
    out = torch.zeros((n,) + src.shape[1:], dtype=src.dtype)
    return out.index_add_(0, seg, src)
def _pad(x, pw):
    flat = tuple(v for pair in reversed(pw) for v in pair)
    return torch.nn.functional.pad(x, flat)

kernel_name = 'concat_heads__spectral_fnet__sliding_block__prompt'

def setup_inputs():

    _w = (lambda a: (lambda t: t.to(torch.bfloat16) if t.is_floating_point() else t)(torch.as_tensor(a)))
    def _A_setup():
        B, S, D = 1, 2048, 640
        ns = torch.arange(S)[:, None] * torch.arange(S)[None, :]
        nd = torch.arange(D)[:, None] * torch.arange(D)[None, :]
        Ws_re = torch.cos(-2.0 * torch.pi * ns / S).to(float)
        Ws_im = torch.sin(-2.0 * torch.pi * ns / S).to(float)
        Wd_re = torch.cos(-2.0 * torch.pi * nd / D).to(float)
        Wd_im = torch.sin(-2.0 * torch.pi * nd / D).to(float)
        return {
            "x": _w((lambda *s: torch.randn(*s, dtype=torch.bfloat16) * 0.05)(B, S, D)),
            "dft_seq_re": _w(Ws_re),
            "dft_seq_im": _w(Ws_im),
            "dft_hid_re": _w(Wd_re),
            "dft_hid_im": _w(Wd_im),
        }
    _A_in = _A_setup()

    def _B_setup():
        B, S, D = 1, 2048, 640
        return {
            "x": _w((lambda *s: torch.randn(*s, dtype=torch.bfloat16) * 0.2)(B, S, D)),
            "wqkv": _w((lambda *s: torch.randn(*s, dtype=torch.bfloat16) * 0.8)(D, 3 * D)),
            "wo": _w((lambda *s: torch.randn(*s, dtype=torch.bfloat16) * 0.2)(D, D)),
        }
    _B_in = _B_setup()

    return {
        "A_x": _A_in["x"],
        "A_dft_seq_re": _A_in["dft_seq_re"],
        "A_dft_seq_im": _A_in["dft_seq_im"],
        "A_dft_hid_re": _A_in["dft_hid_re"],
        "A_dft_hid_im": _A_in["dft_hid_im"],
        "B_x": _B_in["x"],
        "B_wqkv": _B_in["wqkv"],
        "B_wo": _B_in["wo"],
    }

def reference(A_x, A_dft_seq_re, A_dft_seq_im, A_dft_hid_re, A_dft_hid_im, B_x, B_wqkv, B_wo):
    def _A_ref(x, dft_seq_re, dft_seq_im, dft_hid_re, dft_hid_im):
        a = torch.einsum("bsd,ed->bse", x, dft_hid_re)
        b = torch.einsum("bsd,ed->bse", x, dft_hid_im)
        y = torch.einsum("ts,bse->bte", dft_seq_re, a) - torch.einsum("ts,bse->bte", dft_seq_im, b)
        return y

    def _B_ref(x, wqkv, wo):
        B, S, D = x.shape
        H = 32; Dh = D // H; W = 256
        qkv = (lambda x, *d: x.permute(*d))((x @ wqkv).reshape(B, S, 3, H, Dh), 2, 0, 3, 1, 4)
        q, k, v = qkv[0], qkv[1], qkv[2]
        scores = torch.einsum("bhqd,bhkd->bhqk", q, k) * (Dh ** -0.5)
        idx = torch.arange(S)
        mask = (idx[:, None] - idx[None, :] >= 0) & (idx[:, None] - idx[None, :] < W)
        scores = torch.where(mask[None, None], scores, -1e9)
        p = _softmax(scores, axis=-1)
        o = torch.einsum("bhqk,bhkd->bhqd", p, v)
        return (lambda x, *d: x.permute(*d))(o, 0, 2, 1, 3).reshape(B, S, D) @ wo

    a = _A_ref(A_x, A_dft_seq_re, A_dft_seq_im, A_dft_hid_re, A_dft_hid_im)
    b = _B_ref(B_x, B_wqkv, B_wo)
    return torch.concatenate([a, b], axis=-1)
```

```asm
; @launch grid=(256,1,1) block=(512,1,1) lds=163840
.amdgcn_target "amdgcn-amd-amdhsa--gfx950"
.text
.globl concat_heads__spectral_fnet__sliding_block__prompt_kernel
.p2align 8
.type concat_heads__spectral_fnet__sliding_block__prompt_kernel,@function
concat_heads__spectral_fnet__sliding_block__prompt_kernel:
    s_cmp_ge_u32 s2, 256
    s_cbranch_scc1 L_end
    s_xor_b32 s2, s2, 248
    s_load_dwordx4 s[68:71], s[0:1], 40
    s_load_dwordx2 s[64:65], s[0:1], 0
    s_load_dwordx8 s[72:79], s[0:1], 56
    v_lshrrev_b32 v3, 6, v0
    v_and_b32 v2, 63, v0
    s_and_b32 s4, s2, 7
    v_readfirstlane_b32 s3, v3
    s_lshr_b32 s5, s2, 3
    s_cmp_lg_u32 s3, 0
    s_cbranch_scc1 L_pf_1
    s_getpc_b64 s[56:57]
L_pc:
    s_mov_b32 s58, L_codeend-L_pc
    s_mov_b32 s59, 0x20000
    s_and_b32 s40, s5, 31
    v_lshl_add_u32 v5, v2, 5, s40
    v_lshlrev_b32 v5, 7, v5
    buffer_load_dword v15, v5, s[56:59], 0 offen
L_pf_1:
    s_lshr_b32 s7, s2, 5
    s_and_b32 s40, s2, 1
    s_lshl1_add_u32 s7, s7, s40
    s_and_b32 s6, s5, 3
    s_and_b32 s40, s2, 6
    s_lshl1_add_u32 s6, s40, s6
    s_and_b32 s34, s3, 3
    s_cmp_lt_u32 s3, 4
    s_cbranch_scc1 L_C
    v_lshrrev_b32 v3, 3, v2
    v_and_b32 v4, 7, v2
    s_mov_b32 s10, 2621440
    s_mov_b32 s11, 0x20000
    s_mov_b32 s35, 0
    s_cmp_eq_u32 s7, 15
    s_cbranch_scc1 L_A1L
    s_lshl_b32 s40, s6, 7
    s_lshl_b32 s41, s34, 5
    s_add_u32 s40, s40, s41
    v_add_u32 v5, s40, v3
    v_mul_u32_u24 v5, 1280, v5
    v_lshrrev_b32 v6, 1, v3
    v_xor_b32 v7, v6, v4
    v_lshl_add_u32 v10, v7, 4, v5
    v_xor_b32 v7, 4, v7
    v_lshl_add_u32 v11, v7, 4, v5
    v_add_u32 v11, 10240, v11
    v_add_u32 v12, 20480, v10
    v_add_u32 v13, 20480, v11
    s_mul_i32 s40, s7, 52
    s_lshr_b32 s40, s40, 8
    s_mul_i32 s40, s40, 640
    s_lshl_b32 s41, s7, 7
    s_add_u32 s40, s40, s41
    s_mul_i32 s41, s34, 61440
    s_add_u32 s40, s40, s41
    v_and_b32 v6, 2, v3
    v_xor_b32 v6, v6, v4
    v_mul_u32_u24 v5, 3840, v3
    v_lshl_add_u32 v5, v6, 4, v5
    v_add_u32 v14, s40, v5
    v_xor_b32 v15, 64, v14
    v_add_u32 v15, 30720, v15
    s_lshl1_add_u32 s37, s4, s7
    s_mul_i32 s40, s37, 6554
    s_lshr_b32 s40, s40, 16
    s_mul_i32 s40, s40, 10
    s_sub_u32 s37, s37, s40
    s_lshl_b32 s38, s34, 12
    s_lshl_b32 s39, s34, 11
    s_and_b32 s46, s6, 3
    s_and_b32 s47, s6, 1
    s_waitcnt lgkmcnt(0)
    s_mov_b64 s[8:9], s[68:69]
    s_mov_b64 s[12:13], s[70:71]
    s_mov_b32 s14, 2457600
    s_mov_b32 s15, 0x20000
    s_mov_b32 s40, 8
    s_add_u32 s40, s40, s37
    s_sub_u32 s41, s40, 10
    s_cselect_b32 s41, s40, s41
    s_lshl_b32 s40, s41, 7
    s_mul_i32 s41, s41, 245760
    s_add_u32 m0, s39, 122880
    s_nop 0
    buffer_load_dwordx4 v14, s[12:15], s41 offen lds
    s_add_u32 m0, s39, 123904
    s_nop 0
    buffer_load_dwordx4 v15, s[12:15], s41 offen lds
    s_add_u32 m0, s38, 106496
    s_nop 0
    buffer_load_dwordx4 v10, s[8:11], s40 offen lds
    s_add_u32 m0, s38, 107520
    s_nop 0
    buffer_load_dwordx4 v11, s[8:11], s40 offen lds
    s_add_u32 m0, s38, 108544
    s_nop 0
    buffer_load_dwordx4 v12, s[8:11], s40 offen lds
    s_add_u32 m0, s38, 109568
    s_nop 0
    buffer_load_dwordx4 v13, s[8:11], s40 offen lds
    s_add_u32 s44, s41, 640
    s_mov_b32 s41, s44
    s_add_u32 m0, s39, 0
    s_nop 0
    buffer_load_dwordx4 v14, s[12:15], s41 offen lds
    s_add_u32 m0, s39, 1024
    s_nop 0
    buffer_load_dwordx4 v15, s[12:15], s41 offen lds
    s_mov_b32 s40, 9
    s_add_u32 s40, s40, s37
    s_sub_u32 s41, s40, 10
    s_cselect_b32 s41, s40, s41
    s_lshl_b32 s40, s41, 7
    s_mul_i32 s41, s41, 245760
    s_add_u32 m0, s39, 147456
    s_nop 0
    buffer_load_dwordx4 v14, s[12:15], s41 offen lds
    s_add_u32 m0, s39, 148480
    s_nop 0
    buffer_load_dwordx4 v15, s[12:15], s41 offen lds
    s_add_u32 m0, s38, 131072
    s_nop 0
    buffer_load_dwordx4 v10, s[8:11], s40 offen lds
    s_add_u32 m0, s38, 132096
    s_nop 0
    buffer_load_dwordx4 v11, s[8:11], s40 offen lds
    s_add_u32 m0, s38, 133120
    s_nop 0
    buffer_load_dwordx4 v12, s[8:11], s40 offen lds
    s_add_u32 m0, s38, 134144
    s_nop 0
    buffer_load_dwordx4 v13, s[8:11], s40 offen lds
    s_add_u32 s45, s41, 640
    s_xor_b32 s40, s46, 0
    s_add_u32 s40, s40, s37
    s_sub_u32 s41, s40, 10
    s_cselect_b32 s41, s40, s41
    s_lshl_b32 s40, s41, 7
    s_mul_i32 s41, s41, 245760
    s_add_u32 m0, s39, 73728
    s_nop 0
    buffer_load_dwordx4 v14, s[12:15], s41 offen lds
    s_add_u32 m0, s39, 74752
    s_nop 0
    buffer_load_dwordx4 v15, s[12:15], s41 offen lds
    s_add_u32 m0, s38, 57344
    s_nop 0
    buffer_load_dwordx4 v10, s[8:11], s40 offen lds
    s_add_u32 m0, s38, 58368
    s_nop 0
    buffer_load_dwordx4 v11, s[8:11], s40 offen lds
    s_add_u32 m0, s38, 59392
    s_nop 0
    buffer_load_dwordx4 v12, s[8:11], s40 offen lds
    s_add_u32 m0, s38, 60416
    s_nop 0
    buffer_load_dwordx4 v13, s[8:11], s40 offen lds
    s_mov_b32 s41, s45
    s_add_u32 m0, s39, 8192
    s_nop 0
    buffer_load_dwordx4 v14, s[12:15], s41 offen lds
    s_add_u32 m0, s39, 9216
    s_nop 0
    buffer_load_dwordx4 v15, s[12:15], s41 offen lds
    s_mov_b64 s[20:21], s[72:73]
    s_mov_b32 s22, 819200
    s_mov_b32 s23, 0x20000
    s_mov_b64 s[24:25], s[74:75]
    s_mov_b32 s26, 5242880
    s_mov_b32 s27, 0x20000
    s_mov_b64 s[28:29], s[76:77]
    s_mov_b32 s30, 256
    s_mov_b32 s31, 0x20000
    s_mov_b64 s[16:17], s[78:79]
    s_mov_b32 s18, 268435456
    s_mov_b32 s19, 0x20000
    s_cmp_ge_u32 s7, 10
    s_cbranch_scc1 L_B1LV
    s_waitcnt vmcnt(14)
    s_barrier
    s_xor_b32 s40, s46, 1
    s_add_u32 s40, s40, s37
    s_sub_u32 s41, s40, 10
    s_cselect_b32 s41, s40, s41
    s_lshl_b32 s40, s41, 7
    s_mul_i32 s41, s41, 245760
    s_add_u32 m0, s39, 98304
    s_nop 0
    buffer_load_dwordx4 v14, s[12:15], s41 offen lds
    s_add_u32 m0, s39, 99328
    s_nop 0
    buffer_load_dwordx4 v15, s[12:15], s41 offen lds
    s_add_u32 m0, s38, 81920
    s_nop 0
    buffer_load_dwordx4 v10, s[8:11], s40 offen lds
    s_add_u32 m0, s38, 82944
    s_nop 0
    buffer_load_dwordx4 v11, s[8:11], s40 offen lds
    s_add_u32 m0, s38, 83968
    s_nop 0
    buffer_load_dwordx4 v12, s[8:11], s40 offen lds
    s_add_u32 m0, s38, 84992
    s_nop 0
    buffer_load_dwordx4 v13, s[8:11], s40 offen lds
    s_waitcnt vmcnt(14)
    s_barrier
    s_xor_b32 s40, s46, 2
    s_add_u32 s40, s40, s37
    s_sub_u32 s41, s40, 10
    s_cselect_b32 s41, s40, s41
    s_lshl_b32 s40, s41, 7
    s_mul_i32 s41, s41, 245760
    s_add_u32 m0, s39, 122880
    s_nop 0
    buffer_load_dwordx4 v14, s[12:15], s41 offen lds
    s_add_u32 m0, s39, 123904
    s_nop 0
    buffer_load_dwordx4 v15, s[12:15], s41 offen lds
    s_add_u32 m0, s38, 106496
    s_nop 0
    buffer_load_dwordx4 v10, s[8:11], s40 offen lds
    s_add_u32 m0, s38, 107520
    s_nop 0
    buffer_load_dwordx4 v11, s[8:11], s40 offen lds
    s_add_u32 m0, s38, 108544
    s_nop 0
    buffer_load_dwordx4 v12, s[8:11], s40 offen lds
    s_add_u32 m0, s38, 109568
    s_nop 0
    buffer_load_dwordx4 v13, s[8:11], s40 offen lds
    s_waitcnt vmcnt(12)
    s_barrier
    s_xor_b32 s40, s46, 3
    s_add_u32 s40, s40, s37
    s_sub_u32 s41, s40, 10
    s_cselect_b32 s41, s40, s41
    s_lshl_b32 s40, s41, 7
    s_mul_i32 s41, s41, 245760
    s_add_u32 m0, s39, 147456
    s_nop 0
    buffer_load_dwordx4 v14, s[12:15], s41 offen lds
    s_add_u32 m0, s39, 148480
    s_nop 0
    buffer_load_dwordx4 v15, s[12:15], s41 offen lds
    s_add_u32 m0, s38, 131072
    s_nop 0
    buffer_load_dwordx4 v10, s[8:11], s40 offen lds
    s_add_u32 m0, s38, 132096
    s_nop 0
    buffer_load_dwordx4 v11, s[8:11], s40 offen lds
    s_add_u32 m0, s38, 133120
    s_nop 0
    buffer_load_dwordx4 v12, s[8:11], s40 offen lds
    s_add_u32 m0, s38, 134144
    s_nop 0
    buffer_load_dwordx4 v13, s[8:11], s40 offen lds
    s_waitcnt vmcnt(12)
    s_barrier
    s_xor_b32 s40, s46, 4
    s_add_u32 s40, s40, s37
    s_sub_u32 s41, s40, 10
    s_cselect_b32 s41, s40, s41
    s_lshl_b32 s40, s41, 7
    s_mul_i32 s41, s41, 245760
    s_add_u32 m0, s39, 73728
    s_nop 0
    buffer_load_dwordx4 v14, s[12:15], s41 offen lds
    s_add_u32 m0, s39, 74752
    s_nop 0
    buffer_load_dwordx4 v15, s[12:15], s41 offen lds
    s_add_u32 m0, s38, 57344
    s_nop 0
    buffer_load_dwordx4 v10, s[8:11], s40 offen lds
    s_add_u32 m0, s38, 58368
    s_nop 0
    buffer_load_dwordx4 v11, s[8:11], s40 offen lds
    s_add_u32 m0, s38, 59392
    s_nop 0
    buffer_load_dwordx4 v12, s[8:11], s40 offen lds
    s_add_u32 m0, s38, 60416
    s_nop 0
    buffer_load_dwordx4 v13, s[8:11], s40 offen lds
    s_waitcnt vmcnt(12)
    s_barrier
    s_xor_b32 s40, s46, 5
    s_add_u32 s40, s40, s37
    s_sub_u32 s41, s40, 10
    s_cselect_b32 s41, s40, s41
    s_lshl_b32 s40, s41, 7
    s_mul_i32 s41, s41, 245760
    s_add_u32 m0, s39, 98304
    s_nop 0
    buffer_load_dwordx4 v14, s[12:15], s41 offen lds
    s_add_u32 m0, s39, 99328
    s_nop 0
    buffer_load_dwordx4 v15, s[12:15], s41 offen lds
    s_add_u32 m0, s38, 81920
    s_nop 0
    buffer_load_dwordx4 v10, s[8:11], s40 offen lds
    s_add_u32 m0, s38, 82944
    s_nop 0
    buffer_load_dwordx4 v11, s[8:11], s40 offen lds
    s_add_u32 m0, s38, 83968
    s_nop 0
    buffer_load_dwordx4 v12, s[8:11], s40 offen lds
    s_add_u32 m0, s38, 84992
    s_nop 0
    buffer_load_dwordx4 v13, s[8:11], s40 offen lds
    s_waitcnt vmcnt(12)
    s_barrier
    s_xor_b32 s40, s46, 6
    s_add_u32 s40, s40, s37
    s_sub_u32 s41, s40, 10
    s_cselect_b32 s41, s40, s41
    s_lshl_b32 s40, s41, 7
    s_mul_i32 s41, s41, 245760
    s_add_u32 m0, s39, 122880
    s_nop 0
    buffer_load_dwordx4 v14, s[12:15], s41 offen lds
    s_add_u32 m0, s39, 123904
    s_nop 0
    buffer_load_dwordx4 v15, s[12:15], s41 offen lds
    s_add_u32 m0, s38, 106496
    s_nop 0
    buffer_load_dwordx4 v10, s[8:11], s40 offen lds
    s_add_u32 m0, s38, 107520
    s_nop 0
    buffer_load_dwordx4 v11, s[8:11], s40 offen lds
    s_add_u32 m0, s38, 108544
    s_nop 0
    buffer_load_dwordx4 v12, s[8:11], s40 offen lds
    s_add_u32 m0, s38, 109568
    s_nop 0
    buffer_load_dwordx4 v13, s[8:11], s40 offen lds
    s_waitcnt vmcnt(12)
    s_barrier
    s_xor_b32 s40, s46, 7
    s_add_u32 s40, s40, s37
    s_sub_u32 s41, s40, 10
    s_cselect_b32 s41, s40, s41
    s_lshl_b32 s40, s41, 7
    s_mul_i32 s41, s41, 245760
    s_add_u32 m0, s39, 147456
    s_nop 0
    buffer_load_dwordx4 v14, s[12:15], s41 offen lds
    s_add_u32 m0, s39, 148480
    s_nop 0
    buffer_load_dwordx4 v15, s[12:15], s41 offen lds
    s_add_u32 m0, s38, 131072
    s_nop 0
    buffer_load_dwordx4 v10, s[8:11], s40 offen lds
    s_add_u32 m0, s38, 132096
    s_nop 0
    buffer_load_dwordx4 v11, s[8:11], s40 offen lds
    s_add_u32 m0, s38, 133120
    s_nop 0
    buffer_load_dwordx4 v12, s[8:11], s40 offen lds
    s_add_u32 m0, s38, 134144
    s_nop 0
    buffer_load_dwordx4 v13, s[8:11], s40 offen lds
    s_waitcnt vmcnt(12)
    s_waitcnt lgkmcnt(0)
    s_barrier
    s_xor_b32 s40, s46, 0
    s_add_u32 s40, s40, s37
    s_sub_u32 s41, s40, 10
    s_cselect_b32 s41, s40, s41
    s_lshl_b32 s40, s41, 7
    s_mul_i32 s41, s41, 245760
    s_add_u32 s41, s41, 640
    s_add_u32 m0, s39, 16384
    s_nop 0
    buffer_load_dwordx4 v14, s[12:15], s41 offen lds
    s_add_u32 m0, s39, 17408
    s_nop 0
    buffer_load_dwordx4 v15, s[12:15], s41 offen lds
    s_xor_b32 s40, s46, 1
    s_add_u32 s40, s40, s37
    s_sub_u32 s41, s40, 10
    s_cselect_b32 s41, s40, s41
    s_lshl_b32 s40, s41, 7
    s_mul_i32 s41, s41, 245760
    s_add_u32 s41, s41, 640
    s_add_u32 m0, s39, 24576
    s_nop 0
    buffer_load_dwordx4 v14, s[12:15], s41 offen lds
    s_add_u32 m0, s39, 25600
    s_nop 0
    buffer_load_dwordx4 v15, s[12:15], s41 offen lds
    s_xor_b32 s40, s46, 2
    s_add_u32 s40, s40, s37
    s_sub_u32 s41, s40, 10
    s_cselect_b32 s41, s40, s41
    s_lshl_b32 s40, s41, 7
    s_mul_i32 s41, s41, 245760
    s_add_u32 s41, s41, 640
    s_add_u32 m0, s39, 32768
    s_nop 0
    buffer_load_dwordx4 v14, s[12:15], s41 offen lds
    s_add_u32 m0, s39, 33792
    s_nop 0
    buffer_load_dwordx4 v15, s[12:15], s41 offen lds
    s_waitcnt vmcnt(12)
    s_barrier
    s_xor_b32 s40, s46, 3
    s_add_u32 s40, s40, s37
    s_sub_u32 s41, s40, 10
    s_cselect_b32 s41, s40, s41
    s_lshl_b32 s40, s41, 7
    s_mul_i32 s41, s41, 245760
    s_add_u32 s41, s41, 640
    s_add_u32 m0, s39, 40960
    s_nop 0
    buffer_load_dwordx4 v14, s[12:15], s41 offen lds
    s_add_u32 m0, s39, 41984
    s_nop 0
    buffer_load_dwordx4 v15, s[12:15], s41 offen lds
    s_xor_b32 s40, s46, 4
    s_add_u32 s40, s40, s37
    s_sub_u32 s41, s40, 10
    s_cselect_b32 s41, s40, s41
    s_lshl_b32 s40, s41, 7
    s_mul_i32 s41, s41, 245760
    s_add_u32 s41, s41, 640
    s_add_u32 m0, s39, 49152
    s_nop 0
    buffer_load_dwordx4 v14, s[12:15], s41 offen lds
    s_add_u32 m0, s39, 50176
    s_nop 0
    buffer_load_dwordx4 v15, s[12:15], s41 offen lds
    s_xor_b32 s40, s46, 5
    s_add_u32 s40, s40, s37
    s_sub_u32 s41, s40, 10
    s_cselect_b32 s41, s40, s41
    s_lshl_b32 s40, s41, 7
    s_mul_i32 s41, s41, 245760
    s_add_u32 s41, s41, 640
    s_add_u32 m0, s39, 57344
    s_nop 0
    buffer_load_dwordx4 v14, s[12:15], s41 offen lds
    s_add_u32 m0, s39, 58368
    s_nop 0
    buffer_load_dwordx4 v15, s[12:15], s41 offen lds
    s_waitcnt vmcnt(12)
    s_barrier
    s_xor_b32 s40, s46, 6
    s_add_u32 s40, s40, s37
    s_sub_u32 s41, s40, 10
    s_cselect_b32 s41, s40, s41
    s_lshl_b32 s40, s41, 7
    s_mul_i32 s41, s41, 245760
    s_add_u32 s41, s41, 640
    s_add_u32 m0, s39, 0
    s_nop 0
    buffer_load_dwordx4 v14, s[12:15], s41 offen lds
    s_add_u32 m0, s39, 1024
    s_nop 0
    buffer_load_dwordx4 v15, s[12:15], s41 offen lds
    s_xor_b32 s40, s46, 7
    s_add_u32 s40, s40, s37
    s_sub_u32 s41, s40, 10
    s_cselect_b32 s41, s40, s41
    s_lshl_b32 s40, s41, 7
    s_mul_i32 s41, s41, 245760
    s_add_u32 s41, s41, 640
    s_add_u32 m0, s39, 8192
    s_nop 0
    buffer_load_dwordx4 v14, s[12:15], s41 offen lds
    s_add_u32 m0, s39, 9216
    s_nop 0
    buffer_load_dwordx4 v15, s[12:15], s41 offen lds
L_B1LJ:
    s_waitcnt vmcnt(8)
    s_barrier
    v_mov_b32 v9, 163712
    ds_read_b64 v[10:11], v9
    s_waitcnt lgkmcnt(0)
    v_readfirstlane_b32 s32, v10
    v_readfirstlane_b32 s33, v11
    s_mov_b32 s96, 2
    s_branch L_SET
L_SETR2:
    s_waitcnt vmcnt(0)
    s_barrier
    s_branch L_LPOST
L_B1LV:
    s_and_b32 s40, s5, 3
    s_mul_i32 s40, s40, 80
    s_and_b32 s41, s34, 1
    s_add_u32 s40, s40, s41
    s_lshr_b32 s41, s34, 1
    s_lshl4_add_u32 s42, s41, 128
    s_mul_i32 s41, s41, 192
    v_and_b32 v20, 15, v2
    v_lshl_add_u32 v20, v20, 1, s40
    v_lshrrev_b32 v21, 4, v2
    v_lshl_add_u32 v22, v21, 2, s42
    v_lshl_add_u32 v21, v21, 2, s41
    v_cvt_f32_u32 v20, v20
    v_cvt_f32_u32 v21, v21
    v_cvt_f32_u32 v22, v22
    s_waitcnt vmcnt(14)
    s_barrier
    s_xor_b32 s40, s46, 1
    s_add_u32 s40, s40, s37
    s_sub_u32 s41, s40, 10
    s_cselect_b32 s41, s40, s41
    s_lshl_b32 s40, s41, 7
    s_mul_i32 s41, s41, 245760
    s_add_u32 m0, s39, 98304
    s_nop 0
    buffer_load_dwordx4 v14, s[12:15], s41 offen lds
    v_add_f32 v29, 0x0, v20
    v_mul_f32 v23, 0x3acccccd, v29
    v_mul_f32 v30, 0x41800000, v29
    v_mul_f32 v31, 0x3acccccd, v30
    v_rndne_f32 v31, v31
    v_fmamk_f32 v30, v31, 0xc4200000, v30
    v_mul_f32 v24, 0x3acccccd, v30
    v_mul_f32 v30, v29, v21
    v_mul_f32 v31, 0x3acccccd, v30
    v_rndne_f32 v31, v31
    v_fmamk_f32 v30, v31, 0xc4200000, v30
    v_mul_f32 v25, 0x3acccccd, v30
    v_mul_f32 v30, v29, v22
    v_mul_f32 v31, 0x3acccccd, v30
    v_rndne_f32 v31, v31
    v_fmamk_f32 v30, v31, 0xc4200000, v30
    v_mul_f32 v26, 0x3acccccd, v30
    v_cos_f32 v27, v23
    v_cos_f32 v28, v24
    s_nop 0
    v_add_f32 v27, v27, v27
    v_add_f32 v28, v28, v28
    v_add_f32 v30, v25, v23
    v_cos_f32 v32, v25
    v_cos_f32 v33, v30
    v_sin_f32 v34, v25
    v_sin_f32 v35, v30
    v_fma_f32 v40, v27, v33, -v32
    v_cvt_pk_bf16_f32 v136, v32, v33
    v_fma_f32 v42, v27, v35, -v34
    v_cvt_pk_bf16_f32 v140, v34, v35
    v_fma_f32 v41, v27, v40, -v33
    v_fma_f32 v43, v27, v42, -v35
    v_cvt_pk_bf16_f32 v137, v40, v41
    v_cvt_pk_bf16_f32 v141, v42, v43
    s_add_u32 m0, s39, 99328
    s_nop 0
    buffer_load_dwordx4 v15, s[12:15], s41 offen lds
    s_add_u32 m0, s38, 81920
    s_nop 0
    buffer_load_dwordx4 v10, s[8:11], s40 offen lds
    s_add_u32 m0, s38, 82944
    s_nop 0
    buffer_load_dwordx4 v11, s[8:11], s40 offen lds
    v_add_f32 v25, v25, v24
    v_add_f32 v30, v25, v23
    v_cos_f32 v36, v25
    v_cos_f32 v37, v30
    v_sin_f32 v38, v25
    v_sin_f32 v39, v30
    v_fma_f32 v40, v27, v37, -v36
    v_cvt_pk_bf16_f32 v160, v36, v37
    v_fma_f32 v42, v27, v39, -v38
    v_cvt_pk_bf16_f32 v164, v38, v39
    v_fma_f32 v41, v27, v40, -v37
    v_fma_f32 v43, v27, v42, -v39
    v_cvt_pk_bf16_f32 v161, v40, v41
    v_cvt_pk_bf16_f32 v165, v42, v43
    s_add_u32 m0, s38, 83968
    s_nop 0
    buffer_load_dwordx4 v12, s[8:11], s40 offen lds
    s_add_u32 m0, s38, 84992
    s_nop 0
    buffer_load_dwordx4 v13, s[8:11], s40 offen lds
    v_fma_f32 v32, v28, v36, -v32
    v_fma_f32 v33, v28, v37, -v33
    v_fma_f32 v34, v28, v38, -v34
    v_fma_f32 v35, v28, v39, -v35
    v_fma_f32 v40, v27, v33, -v32
    v_cvt_pk_bf16_f32 v138, v32, v33
    v_fma_f32 v42, v27, v35, -v34
    v_cvt_pk_bf16_f32 v142, v34, v35
    v_fma_f32 v41, v27, v40, -v33
    v_fma_f32 v43, v27, v42, -v35
    v_cvt_pk_bf16_f32 v139, v40, v41
    v_cvt_pk_bf16_f32 v143, v42, v43
    s_waitcnt vmcnt(14)
    s_barrier
    s_xor_b32 s40, s46, 2
    s_add_u32 s40, s40, s37
    s_sub_u32 s41, s40, 10
    s_cselect_b32 s41, s40, s41
    s_lshl_b32 s40, s41, 7
    s_mul_i32 s41, s41, 245760
    s_add_u32 m0, s39, 122880
    s_nop 0
    buffer_load_dwordx4 v14, s[12:15], s41 offen lds
    v_fma_f32 v36, v28, v32, -v36
    v_fma_f32 v37, v28, v33, -v37
    v_fma_f32 v38, v28, v34, -v38
    v_fma_f32 v39, v28, v35, -v39
    v_fma_f32 v40, v27, v37, -v36
    v_cvt_pk_bf16_f32 v162, v36, v37
    v_fma_f32 v42, v27, v39, -v38
    v_cvt_pk_bf16_f32 v166, v38, v39
    v_fma_f32 v41, v27, v40, -v37
    v_fma_f32 v43, v27, v42, -v39
    v_cvt_pk_bf16_f32 v163, v40, v41
    v_cvt_pk_bf16_f32 v167, v42, v43
    s_add_u32 m0, s39, 123904
    s_nop 0
    buffer_load_dwordx4 v15, s[12:15], s41 offen lds
    s_add_u32 m0, s38, 106496
    s_nop 0
    buffer_load_dwordx4 v10, s[8:11], s40 offen lds
    s_add_u32 m0, s38, 107520
    s_nop 0
    buffer_load_dwordx4 v11, s[8:11], s40 offen lds
    v_fma_f32 v32, v28, v36, -v32
    v_fma_f32 v33, v28, v37, -v33
    v_fma_f32 v34, v28, v38, -v34
    v_fma_f32 v35, v28, v39, -v35
    v_fma_f32 v40, v27, v33, -v32
    v_cvt_pk_bf16_f32 v184, v32, v33
    v_fma_f32 v42, v27, v35, -v34
    v_cvt_pk_bf16_f32 v188, v34, v35
    v_fma_f32 v41, v27, v40, -v33
    v_fma_f32 v43, v27, v42, -v35
    v_cvt_pk_bf16_f32 v185, v40, v41
    v_cvt_pk_bf16_f32 v189, v42, v43
    s_add_u32 m0, s38, 108544
    s_nop 0
    buffer_load_dwordx4 v12, s[8:11], s40 offen lds
    s_add_u32 m0, s38, 109568
    s_nop 0
    buffer_load_dwordx4 v13, s[8:11], s40 offen lds
    v_fma_f32 v36, v28, v32, -v36
    v_fma_f32 v37, v28, v33, -v37
    v_fma_f32 v38, v28, v34, -v38
    v_fma_f32 v39, v28, v35, -v39
    v_fma_f32 v40, v27, v37, -v36
    v_cvt_pk_bf16_f32 v208, v36, v37
    v_fma_f32 v42, v27, v39, -v38
    v_cvt_pk_bf16_f32 v212, v38, v39
    v_fma_f32 v41, v27, v40, -v37
    v_fma_f32 v43, v27, v42, -v39
    v_cvt_pk_bf16_f32 v209, v40, v41
    v_cvt_pk_bf16_f32 v213, v42, v43
    s_waitcnt vmcnt(12)
    s_barrier
    s_xor_b32 s40, s46, 3
    s_add_u32 s40, s40, s37
    s_sub_u32 s41, s40, 10
    s_cselect_b32 s41, s40, s41
    s_lshl_b32 s40, s41, 7
    s_mul_i32 s41, s41, 245760
    s_add_u32 m0, s39, 147456
    s_nop 0
    buffer_load_dwordx4 v14, s[12:15], s41 offen lds
    v_fma_f32 v32, v28, v36, -v32
    v_fma_f32 v33, v28, v37, -v33
    v_fma_f32 v34, v28, v38, -v34
    v_fma_f32 v35, v28, v39, -v35
    v_fma_f32 v40, v27, v33, -v32
    v_cvt_pk_bf16_f32 v186, v32, v33
    v_fma_f32 v42, v27, v35, -v34
    v_cvt_pk_bf16_f32 v190, v34, v35
    v_fma_f32 v41, v27, v40, -v33
    v_fma_f32 v43, v27, v42, -v35
    v_cvt_pk_bf16_f32 v187, v40, v41
    v_cvt_pk_bf16_f32 v191, v42, v43
    s_add_u32 m0, s39, 148480
    s_nop 0
    buffer_load_dwordx4 v15, s[12:15], s41 offen lds
    s_add_u32 m0, s38, 131072
    s_nop 0
    buffer_load_dwordx4 v10, s[8:11], s40 offen lds
    s_add_u32 m0, s38, 132096
    s_nop 0
    buffer_load_dwordx4 v11, s[8:11], s40 offen lds
    v_fma_f32 v36, v28, v32, -v36
    v_fma_f32 v37, v28, v33, -v37
    v_fma_f32 v38, v28, v34, -v38
    v_fma_f32 v39, v28, v35, -v39
    v_fma_f32 v40, v27, v37, -v36
    v_cvt_pk_bf16_f32 v210, v36, v37
    v_fma_f32 v42, v27, v39, -v38
    v_cvt_pk_bf16_f32 v214, v38, v39
    v_fma_f32 v41, v27, v40, -v37
    v_fma_f32 v43, v27, v42, -v39
    v_cvt_pk_bf16_f32 v211, v40, v41
    v_cvt_pk_bf16_f32 v215, v42, v43
    s_add_u32 m0, s38, 133120
    s_nop 0
    buffer_load_dwordx4 v12, s[8:11], s40 offen lds
    s_add_u32 m0, s38, 134144
    s_nop 0
    buffer_load_dwordx4 v13, s[8:11], s40 offen lds
    v_add_f32 v30, v26, v23
    v_cos_f32 v32, v26
    v_cos_f32 v33, v30
    v_sin_f32 v34, v26
    v_sin_f32 v35, v30
    v_fma_f32 v40, v27, v33, -v32
    v_cvt_pk_bf16_f32 v232, v32, v33
    v_fma_f32 v42, v27, v35, -v34
    v_cvt_pk_bf16_f32 v236, v34, v35
    v_fma_f32 v41, v27, v40, -v33
    v_fma_f32 v43, v27, v42, -v35
    v_cvt_pk_bf16_f32 v233, v40, v41
    v_cvt_pk_bf16_f32 v237, v42, v43
    s_waitcnt vmcnt(12)
    s_barrier
    s_xor_b32 s40, s46, 4
    s_add_u32 s40, s40, s37
    s_sub_u32 s41, s40, 10
    s_cselect_b32 s41, s40, s41
    s_lshl_b32 s40, s41, 7
    s_mul_i32 s41, s41, 245760
    s_add_u32 m0, s39, 73728
    s_nop 0
    buffer_load_dwordx4 v14, s[12:15], s41 offen lds
    v_fma_f32 v26, 2.0, v24, v26
    v_add_f32 v30, v26, v23
    v_cos_f32 v36, v26
    v_cos_f32 v37, v30
    v_sin_f32 v38, v26
    v_sin_f32 v39, v30
    v_fma_f32 v40, v27, v37, -v36
    v_cvt_pk_bf16_f32 v234, v36, v37
    v_fma_f32 v42, v27, v39, -v38
    v_cvt_pk_bf16_f32 v238, v38, v39
    v_fma_f32 v41, v27, v40, -v37
    v_fma_f32 v43, v27, v42, -v39
    v_cvt_pk_bf16_f32 v235, v40, v41
    v_cvt_pk_bf16_f32 v239, v42, v43
    s_add_u32 m0, s39, 74752
    s_nop 0
    buffer_load_dwordx4 v15, s[12:15], s41 offen lds
    s_add_u32 m0, s38, 57344
    s_nop 0
    buffer_load_dwordx4 v10, s[8:11], s40 offen lds
    s_add_u32 m0, s38, 58368
    s_nop 0
    buffer_load_dwordx4 v11, s[8:11], s40 offen lds
    v_add_f32 v29, 0x42000000, v20
    v_mul_f32 v23, 0x3acccccd, v29
    v_mul_f32 v30, 0x41800000, v29
    v_mul_f32 v31, 0x3acccccd, v30
    v_rndne_f32 v31, v31
    v_fmamk_f32 v30, v31, 0xc4200000, v30
    v_mul_f32 v24, 0x3acccccd, v30
    v_mul_f32 v30, v29, v21
    v_mul_f32 v31, 0x3acccccd, v30
    v_rndne_f32 v31, v31
    v_fmamk_f32 v30, v31, 0xc4200000, v30
    v_mul_f32 v25, 0x3acccccd, v30
    v_mul_f32 v30, v29, v22
    v_mul_f32 v31, 0x3acccccd, v30
    v_rndne_f32 v31, v31
    v_fmamk_f32 v30, v31, 0xc4200000, v30
    v_mul_f32 v26, 0x3acccccd, v30
    v_cos_f32 v27, v23
    v_cos_f32 v28, v24
    s_nop 0
    v_add_f32 v27, v27, v27
    v_add_f32 v28, v28, v28
    v_add_f32 v30, v25, v23
    v_cos_f32 v32, v25
    v_cos_f32 v33, v30
    v_sin_f32 v34, v25
    v_sin_f32 v35, v30
    v_fma_f32 v40, v27, v33, -v32
    v_cvt_pk_bf16_f32 v144, v32, v33
    v_fma_f32 v42, v27, v35, -v34
    v_cvt_pk_bf16_f32 v148, v34, v35
    v_fma_f32 v41, v27, v40, -v33
    v_fma_f32 v43, v27, v42, -v35
    v_cvt_pk_bf16_f32 v145, v40, v41
    v_cvt_pk_bf16_f32 v149, v42, v43
    s_add_u32 m0, s38, 59392
    s_nop 0
    buffer_load_dwordx4 v12, s[8:11], s40 offen lds
    s_add_u32 m0, s38, 60416
    s_nop 0
    buffer_load_dwordx4 v13, s[8:11], s40 offen lds
    v_add_f32 v25, v25, v24
    v_add_f32 v30, v25, v23
    v_cos_f32 v36, v25
    v_cos_f32 v37, v30
    v_sin_f32 v38, v25
    v_sin_f32 v39, v30
    v_fma_f32 v40, v27, v37, -v36
    v_cvt_pk_bf16_f32 v168, v36, v37
    v_fma_f32 v42, v27, v39, -v38
    v_cvt_pk_bf16_f32 v172, v38, v39
    v_fma_f32 v41, v27, v40, -v37
    v_fma_f32 v43, v27, v42, -v39
    v_cvt_pk_bf16_f32 v169, v40, v41
    v_cvt_pk_bf16_f32 v173, v42, v43
    s_waitcnt vmcnt(12)
    s_barrier
    s_xor_b32 s40, s46, 5
    s_add_u32 s40, s40, s37
    s_sub_u32 s41, s40, 10
    s_cselect_b32 s41, s40, s41
    s_lshl_b32 s40, s41, 7
    s_mul_i32 s41, s41, 245760
    s_add_u32 m0, s39, 98304
    s_nop 0
    buffer_load_dwordx4 v14, s[12:15], s41 offen lds
    v_fma_f32 v32, v28, v36, -v32
    v_fma_f32 v33, v28, v37, -v33
    v_fma_f32 v34, v28, v38, -v34
    v_fma_f32 v35, v28, v39, -v35
    v_fma_f32 v40, v27, v33, -v32
    v_cvt_pk_bf16_f32 v146, v32, v33
    v_fma_f32 v42, v27, v35, -v34
    v_cvt_pk_bf16_f32 v150, v34, v35
    v_fma_f32 v41, v27, v40, -v33
    v_fma_f32 v43, v27, v42, -v35
    v_cvt_pk_bf16_f32 v147, v40, v41
    v_cvt_pk_bf16_f32 v151, v42, v43
    s_add_u32 m0, s39, 99328
    s_nop 0
    buffer_load_dwordx4 v15, s[12:15], s41 offen lds
    s_add_u32 m0, s38, 81920
    s_nop 0
    buffer_load_dwordx4 v10, s[8:11], s40 offen lds
    s_add_u32 m0, s38, 82944
    s_nop 0
    buffer_load_dwordx4 v11, s[8:11], s40 offen lds
    v_fma_f32 v36, v28, v32, -v36
    v_fma_f32 v37, v28, v33, -v37
    v_fma_f32 v38, v28, v34, -v38
    v_fma_f32 v39, v28, v35, -v39
    v_fma_f32 v40, v27, v37, -v36
    v_cvt_pk_bf16_f32 v170, v36, v37
    v_fma_f32 v42, v27, v39, -v38
    v_cvt_pk_bf16_f32 v174, v38, v39
    v_fma_f32 v41, v27, v40, -v37
    v_fma_f32 v43, v27, v42, -v39
    v_cvt_pk_bf16_f32 v171, v40, v41
    v_cvt_pk_bf16_f32 v175, v42, v43
    s_add_u32 m0, s38, 83968
    s_nop 0
    buffer_load_dwordx4 v12, s[8:11], s40 offen lds
    s_add_u32 m0, s38, 84992
    s_nop 0
    buffer_load_dwordx4 v13, s[8:11], s40 offen lds
    v_fma_f32 v32, v28, v36, -v32
    v_fma_f32 v33, v28, v37, -v33
    v_fma_f32 v34, v28, v38, -v34
    v_fma_f32 v35, v28, v39, -v35
    v_fma_f32 v40, v27, v33, -v32
    v_cvt_pk_bf16_f32 v192, v32, v33
    v_fma_f32 v42, v27, v35, -v34
    v_cvt_pk_bf16_f32 v196, v34, v35
    v_fma_f32 v41, v27, v40, -v33
    v_fma_f32 v43, v27, v42, -v35
    v_cvt_pk_bf16_f32 v193, v40, v41
    v_cvt_pk_bf16_f32 v197, v42, v43
    s_waitcnt vmcnt(12)
    s_barrier
    s_xor_b32 s40, s46, 6
    s_add_u32 s40, s40, s37
    s_sub_u32 s41, s40, 10
    s_cselect_b32 s41, s40, s41
    s_lshl_b32 s40, s41, 7
    s_mul_i32 s41, s41, 245760
    s_add_u32 m0, s39, 122880
    s_nop 0
    buffer_load_dwordx4 v14, s[12:15], s41 offen lds
    v_fma_f32 v36, v28, v32, -v36
    v_fma_f32 v37, v28, v33, -v37
    v_fma_f32 v38, v28, v34, -v38
    v_fma_f32 v39, v28, v35, -v39
    v_fma_f32 v40, v27, v37, -v36
    v_cvt_pk_bf16_f32 v216, v36, v37
    v_fma_f32 v42, v27, v39, -v38
    v_cvt_pk_bf16_f32 v220, v38, v39
    v_fma_f32 v41, v27, v40, -v37
    v_fma_f32 v43, v27, v42, -v39
    v_cvt_pk_bf16_f32 v217, v40, v41
    v_cvt_pk_bf16_f32 v221, v42, v43
    s_add_u32 m0, s39, 123904
    s_nop 0
    buffer_load_dwordx4 v15, s[12:15], s41 offen lds
    s_add_u32 m0, s38, 106496
    s_nop 0
    buffer_load_dwordx4 v10, s[8:11], s40 offen lds
    s_add_u32 m0, s38, 107520
    s_nop 0
    buffer_load_dwordx4 v11, s[8:11], s40 offen lds
    v_fma_f32 v32, v28, v36, -v32
    v_fma_f32 v33, v28, v37, -v33
    v_fma_f32 v34, v28, v38, -v34
    v_fma_f32 v35, v28, v39, -v35
    v_fma_f32 v40, v27, v33, -v32
    v_cvt_pk_bf16_f32 v194, v32, v33
    v_fma_f32 v42, v27, v35, -v34
    v_cvt_pk_bf16_f32 v198, v34, v35
    v_fma_f32 v41, v27, v40, -v33
    v_fma_f32 v43, v27, v42, -v35
    v_cvt_pk_bf16_f32 v195, v40, v41
    v_cvt_pk_bf16_f32 v199, v42, v43
    s_add_u32 m0, s38, 108544
    s_nop 0
    buffer_load_dwordx4 v12, s[8:11], s40 offen lds
    s_add_u32 m0, s38, 109568
    s_nop 0
    buffer_load_dwordx4 v13, s[8:11], s40 offen lds
    v_fma_f32 v36, v28, v32, -v36
    v_fma_f32 v37, v28, v33, -v37
    v_fma_f32 v38, v28, v34, -v38
    v_fma_f32 v39, v28, v35, -v39
    v_fma_f32 v40, v27, v37, -v36
    v_cvt_pk_bf16_f32 v218, v36, v37
    v_fma_f32 v42, v27, v39, -v38
    v_cvt_pk_bf16_f32 v222, v38, v39
    v_fma_f32 v41, v27, v40, -v37
    v_fma_f32 v43, v27, v42, -v39
    v_cvt_pk_bf16_f32 v219, v40, v41
    v_cvt_pk_bf16_f32 v223, v42, v43
    s_waitcnt vmcnt(12)
    s_barrier
    s_xor_b32 s40, s46, 7
    s_add_u32 s40, s40, s37
    s_sub_u32 s41, s40, 10
    s_cselect_b32 s41, s40, s41
    s_lshl_b32 s40, s41, 7
    s_mul_i32 s41, s41, 245760
    s_add_u32 m0, s39, 147456
    s_nop 0
    buffer_load_dwordx4 v14, s[12:15], s41 offen lds
    v_add_f32 v30, v26, v23
    v_cos_f32 v32, v26
    v_cos_f32 v33, v30
    v_sin_f32 v34, v26
    v_sin_f32 v35, v30
    v_fma_f32 v40, v27, v33, -v32
    v_cvt_pk_bf16_f32 v240, v32, v33
    v_fma_f32 v42, v27, v35, -v34
    v_cvt_pk_bf16_f32 v244, v34, v35
    v_fma_f32 v41, v27, v40, -v33
    v_fma_f32 v43, v27, v42, -v35
    v_cvt_pk_bf16_f32 v241, v40, v41
    v_cvt_pk_bf16_f32 v245, v42, v43
    s_add_u32 m0, s39, 148480
    s_nop 0
    buffer_load_dwordx4 v15, s[12:15], s41 offen lds
    s_add_u32 m0, s38, 131072
    s_nop 0
    buffer_load_dwordx4 v10, s[8:11], s40 offen lds
    s_add_u32 m0, s38, 132096
    s_nop 0
    buffer_load_dwordx4 v11, s[8:11], s40 offen lds
    v_fma_f32 v26, 2.0, v24, v26
    v_add_f32 v30, v26, v23
    v_cos_f32 v36, v26
    v_cos_f32 v37, v30
    v_sin_f32 v38, v26
    v_sin_f32 v39, v30
    v_fma_f32 v40, v27, v37, -v36
    v_cvt_pk_bf16_f32 v242, v36, v37
    v_fma_f32 v42, v27, v39, -v38
    v_cvt_pk_bf16_f32 v246, v38, v39
    v_fma_f32 v41, v27, v40, -v37
    v_fma_f32 v43, v27, v42, -v39
    v_cvt_pk_bf16_f32 v243, v40, v41
    v_cvt_pk_bf16_f32 v247, v42, v43
    s_add_u32 m0, s38, 133120
    s_nop 0
    buffer_load_dwordx4 v12, s[8:11], s40 offen lds
    s_add_u32 m0, s38, 134144
    s_nop 0
    buffer_load_dwordx4 v13, s[8:11], s40 offen lds
    s_waitcnt vmcnt(12)
    s_waitcnt lgkmcnt(0)
    s_barrier
    s_xor_b32 s40, s46, 0
    s_add_u32 s40, s40, s37
    s_sub_u32 s41, s40, 10
    s_cselect_b32 s41, s40, s41
    s_lshl_b32 s40, s41, 7
    s_mul_i32 s41, s41, 245760
    s_add_u32 s41, s41, 640
    s_add_u32 m0, s39, 16384
    s_nop 0
    buffer_load_dwordx4 v14, s[12:15], s41 offen lds
    s_add_u32 m0, s39, 17408
    s_nop 0
    buffer_load_dwordx4 v15, s[12:15], s41 offen lds
    s_xor_b32 s40, s46, 1
    s_add_u32 s40, s40, s37
    s_sub_u32 s41, s40, 10
    s_cselect_b32 s41, s40, s41
    s_lshl_b32 s40, s41, 7
    s_mul_i32 s41, s41, 245760
    s_add_u32 s41, s41, 640
    s_add_u32 m0, s39, 24576
    s_nop 0
    buffer_load_dwordx4 v14, s[12:15], s41 offen lds
    s_add_u32 m0, s39, 25600
    s_nop 0
    buffer_load_dwordx4 v15, s[12:15], s41 offen lds
    s_xor_b32 s40, s46, 2
    s_add_u32 s40, s40, s37
    s_sub_u32 s41, s40, 10
    s_cselect_b32 s41, s40, s41
    s_lshl_b32 s40, s41, 7
    s_mul_i32 s41, s41, 245760
    s_add_u32 s41, s41, 640
    s_add_u32 m0, s39, 32768
    s_nop 0
    buffer_load_dwordx4 v14, s[12:15], s41 offen lds
    s_add_u32 m0, s39, 33792
    s_nop 0
    buffer_load_dwordx4 v15, s[12:15], s41 offen lds
    s_waitcnt vmcnt(12)
    s_barrier
    s_xor_b32 s40, s46, 3
    s_add_u32 s40, s40, s37
    s_sub_u32 s41, s40, 10
    s_cselect_b32 s41, s40, s41
    s_lshl_b32 s40, s41, 7
    s_mul_i32 s41, s41, 245760
    s_add_u32 s41, s41, 640
    s_add_u32 m0, s39, 40960
    s_nop 0
    buffer_load_dwordx4 v14, s[12:15], s41 offen lds
    s_add_u32 m0, s39, 41984
    s_nop 0
    buffer_load_dwordx4 v15, s[12:15], s41 offen lds
    s_xor_b32 s40, s46, 4
    s_add_u32 s40, s40, s37
    s_sub_u32 s41, s40, 10
    s_cselect_b32 s41, s40, s41
    s_lshl_b32 s40, s41, 7
    s_mul_i32 s41, s41, 245760
    s_add_u32 s41, s41, 640
    s_add_u32 m0, s39, 49152
    s_nop 0
    buffer_load_dwordx4 v14, s[12:15], s41 offen lds
    s_add_u32 m0, s39, 50176
    s_nop 0
    buffer_load_dwordx4 v15, s[12:15], s41 offen lds
    s_xor_b32 s40, s46, 5
    s_add_u32 s40, s40, s37
    s_sub_u32 s41, s40, 10
    s_cselect_b32 s41, s40, s41
    s_lshl_b32 s40, s41, 7
    s_mul_i32 s41, s41, 245760
    s_add_u32 s41, s41, 640
    s_add_u32 m0, s39, 57344
    s_nop 0
    buffer_load_dwordx4 v14, s[12:15], s41 offen lds
    s_add_u32 m0, s39, 58368
    s_nop 0
    buffer_load_dwordx4 v15, s[12:15], s41 offen lds
    s_waitcnt vmcnt(12)
    s_barrier
    s_xor_b32 s40, s46, 6
    s_add_u32 s40, s40, s37
    s_sub_u32 s41, s40, 10
    s_cselect_b32 s41, s40, s41
    s_lshl_b32 s40, s41, 7
    s_mul_i32 s41, s41, 245760
    s_add_u32 s41, s41, 640
    s_add_u32 m0, s39, 0
    s_nop 0
    buffer_load_dwordx4 v14, s[12:15], s41 offen lds
    s_add_u32 m0, s39, 1024
    s_nop 0
    buffer_load_dwordx4 v15, s[12:15], s41 offen lds
    s_xor_b32 s40, s46, 7
    s_add_u32 s40, s40, s37
    s_sub_u32 s41, s40, 10
    s_cselect_b32 s41, s40, s41
    s_lshl_b32 s40, s41, 7
    s_mul_i32 s41, s41, 245760
    s_add_u32 s41, s41, 640
    s_add_u32 m0, s39, 8192
    s_nop 0
    buffer_load_dwordx4 v14, s[12:15], s41 offen lds
    s_add_u32 m0, s39, 9216
    s_nop 0
    buffer_load_dwordx4 v15, s[12:15], s41 offen lds
    s_branch L_B1LJ
L_A1L:
    s_lshl_b32 s40, s34, 9
    s_add_u32 s40, s40, s6
    v_lshl_add_u32 v5, v3, 4, s40
    v_mul_u32_u24 v5, 1280, v5
    v_bfe_u32 v6, v3, 1, 1
    v_lshlrev_b32 v6, 2, v6
    v_xor_b32 v6, v6, v4
    v_lshl_add_u32 v10, v6, 4, v5
    v_add_u32 v11, 163840, v10
    v_add_u32 v12, 327680, v10
    v_add_u32 v13, 491520, v10
    s_lshl_b32 s38, s34, 12
    s_waitcnt lgkmcnt(0)
    s_mov_b64 s[8:9], s[64:65]
    s_mov_b32 s40, 0
    s_add_u32 m0, s38, 0
    s_nop 0
    buffer_load_dwordx4 v10, s[8:11], s40 offen lds
    s_add_u32 m0, s38, 1024
    s_nop 0
    buffer_load_dwordx4 v11, s[8:11], s40 offen lds
    s_add_u32 m0, s38, 2048
    s_nop 0
    buffer_load_dwordx4 v12, s[8:11], s40 offen lds
    s_add_u32 m0, s38, 3072
    s_nop 0
    buffer_load_dwordx4 v13, s[8:11], s40 offen lds
    s_mov_b32 s40, 640
    s_add_u32 m0, s38, 16384
    s_nop 0
    buffer_load_dwordx4 v10, s[8:11], s40 offen lds
    s_add_u32 m0, s38, 17408
    s_nop 0
    buffer_load_dwordx4 v11, s[8:11], s40 offen lds
    s_add_u32 m0, s38, 18432
    s_nop 0
    buffer_load_dwordx4 v12, s[8:11], s40 offen lds
    s_add_u32 m0, s38, 19456
    s_nop 0
    buffer_load_dwordx4 v13, s[8:11], s40 offen lds
    s_mov_b32 s40, 128
    s_add_u32 m0, s38, 40960
    s_nop 0
    buffer_load_dwordx4 v10, s[8:11], s40 offen lds
    s_add_u32 m0, s38, 41984
    s_nop 0
    buffer_load_dwordx4 v11, s[8:11], s40 offen lds
    s_add_u32 m0, s38, 43008
    s_nop 0
    buffer_load_dwordx4 v12, s[8:11], s40 offen lds
    s_add_u32 m0, s38, 44032
    s_nop 0
    buffer_load_dwordx4 v13, s[8:11], s40 offen lds
    s_mov_b32 s40, 768
    s_add_u32 m0, s38, 57344
    s_nop 0
    buffer_load_dwordx4 v10, s[8:11], s40 offen lds
    s_add_u32 m0, s38, 58368
    s_nop 0
    buffer_load_dwordx4 v11, s[8:11], s40 offen lds
    s_add_u32 m0, s38, 59392
    s_nop 0
    buffer_load_dwordx4 v12, s[8:11], s40 offen lds
    s_add_u32 m0, s38, 60416
    s_nop 0
    buffer_load_dwordx4 v13, s[8:11], s40 offen lds
    s_mov_b64 s[20:21], s[72:73]
    s_mov_b32 s22, 819200
    s_mov_b32 s23, 0x20000
    s_mov_b64 s[24:25], s[74:75]
    s_mov_b32 s26, 5242880
    s_mov_b32 s27, 0x20000
    s_mov_b64 s[28:29], s[76:77]
    s_mov_b32 s30, 256
    s_mov_b32 s31, 0x20000
    s_mov_b64 s[16:17], s[78:79]
    s_mov_b32 s18, 268435456
    s_mov_b32 s19, 0x20000
    s_waitcnt vmcnt(8)
    s_barrier
    s_mov_b32 s40, 256
    s_add_u32 m0, s38, 75776
    s_nop 0
    buffer_load_dwordx4 v10, s[8:11], s40 offen lds
    s_add_u32 m0, s38, 76800
    s_nop 0
    buffer_load_dwordx4 v11, s[8:11], s40 offen lds
    s_add_u32 m0, s38, 77824
    s_nop 0
    buffer_load_dwordx4 v12, s[8:11], s40 offen lds
    s_add_u32 m0, s38, 78848
    s_nop 0
    buffer_load_dwordx4 v13, s[8:11], s40 offen lds
    s_mov_b32 s40, 896
    s_add_u32 m0, s38, 92160
    s_nop 0
    buffer_load_dwordx4 v10, s[8:11], s40 offen lds
    s_add_u32 m0, s38, 93184
    s_nop 0
    buffer_load_dwordx4 v11, s[8:11], s40 offen lds
    s_add_u32 m0, s38, 94208
    s_nop 0
    buffer_load_dwordx4 v12, s[8:11], s40 offen lds
    s_add_u32 m0, s38, 95232
    s_nop 0
    buffer_load_dwordx4 v13, s[8:11], s40 offen lds
    s_waitcnt vmcnt(8)
    v_mov_b32 v8, 163792
    v_mov_b32 v9, 1
    s_mov_b64 exec, 1
    ds_add_u32 v8, v9
    s_mov_b64 exec, -1
    s_mov_b32 s40, 384
    s_add_u32 m0, s38, 108544
    s_nop 0
    buffer_load_dwordx4 v10, s[8:11], s40 offen lds
    s_add_u32 m0, s38, 109568
    s_nop 0
    buffer_load_dwordx4 v11, s[8:11], s40 offen lds
    s_add_u32 m0, s38, 110592
    s_nop 0
    buffer_load_dwordx4 v12, s[8:11], s40 offen lds
    s_add_u32 m0, s38, 111616
    s_nop 0
    buffer_load_dwordx4 v13, s[8:11], s40 offen lds
    s_mov_b32 s40, 1024
    s_add_u32 m0, s38, 124928
    s_nop 0
    buffer_load_dwordx4 v10, s[8:11], s40 offen lds
    s_add_u32 m0, s38, 125952
    s_nop 0
    buffer_load_dwordx4 v11, s[8:11], s40 offen lds
    s_add_u32 m0, s38, 126976
    s_nop 0
    buffer_load_dwordx4 v12, s[8:11], s40 offen lds
    s_add_u32 m0, s38, 128000
    s_nop 0
    buffer_load_dwordx4 v13, s[8:11], s40 offen lds
    s_waitcnt vmcnt(8)
    v_mov_b32 v8, 163796
    v_mov_b32 v9, 1
    s_mov_b64 exec, 1
    ds_add_u32 v8, v9
    s_mov_b64 exec, -1
    s_cmp_lg_u32 s3, 4
    s_cbranch_scc1 L_ni_2
    v_mov_b32 v16, 0
    buffer_load_dwordx2 v[18:19], v16, s[28:31], 0 offen sc1
L_ni_2:
    s_cmp_lg_u32 s3, 4
    s_cbranch_scc1 L_nf_3
    s_mov_b32 s60, 0
L_nr_4:
    s_waitcnt vmcnt(0)
    v_cmp_eq_u64 vcc, 0, v[18:19]
    s_add_u32 s60, s60, 1
    s_cmp_eq_u64 vcc, 0
    s_cbranch_scc1 L_ne_5
    s_cmp_gt_u32 s60, 400000
    s_cbranch_scc1 L_ne_5
    v_mov_b32 v16, 0
    buffer_load_dwordx2 v[18:19], v16, s[28:31], 0 offen sc1
    s_branch L_nr_4
L_ne_5:
    v_mov_b32 v16, 163712
    ds_write_b64 v16, v[18:19]
    s_waitcnt lgkmcnt(0)
L_nf_3:
    s_waitcnt vmcnt(0)
    v_mov_b32 v8, 163800
    v_mov_b32 v9, 1
    s_mov_b64 exec, 1
    ds_add_u32 v8, v9
    s_mov_b64 exec, -1
    v_mov_b32 v8, 163720
    s_mov_b32 s60, 0
L_lw_6:
    ds_read_b32 v9, v8
    s_add_u32 s60, s60, 1
    s_waitcnt lgkmcnt(0)
    v_readfirstlane_b32 s40, v9
    s_cmp_gt_u32 s60, 1600000
    s_cbranch_scc1 L_lwd_7
    s_cmp_lt_u32 s40, 4
    s_cbranch_scc1 L_lw_6
L_lwd_7:
    s_mov_b32 s40, 512
    s_add_u32 m0, s38, 40960
    s_nop 0
    buffer_load_dwordx4 v10, s[8:11], s40 offen lds
    s_add_u32 m0, s38, 41984
    s_nop 0
    buffer_load_dwordx4 v11, s[8:11], s40 offen lds
    s_add_u32 m0, s38, 43008
    s_nop 0
    buffer_load_dwordx4 v12, s[8:11], s40 offen lds
    s_add_u32 m0, s38, 44032
    s_nop 0
    buffer_load_dwordx4 v13, s[8:11], s40 offen lds
    s_mov_b32 s40, 1152
    s_add_u32 m0, s38, 57344
    s_nop 0
    buffer_load_dwordx4 v10, s[8:11], s40 offen lds
    s_add_u32 m0, s38, 58368
    s_nop 0
    buffer_load_dwordx4 v11, s[8:11], s40 offen lds
    s_add_u32 m0, s38, 59392
    s_nop 0
    buffer_load_dwordx4 v12, s[8:11], s40 offen lds
    s_add_u32 m0, s38, 60416
    s_nop 0
    buffer_load_dwordx4 v13, s[8:11], s40 offen lds
    v_mov_b32 v8, 163800
    s_mov_b32 s60, 0
L_lw_8:
    ds_read_b32 v9, v8
    s_add_u32 s60, s60, 1
    s_waitcnt lgkmcnt(0)
    v_readfirstlane_b32 s40, v9
    s_cmp_gt_u32 s60, 1600000
    s_cbranch_scc1 L_lwd_9
    s_cmp_lt_u32 s40, 4
    s_cbranch_scc1 L_lw_8
L_lwd_9:
    v_mov_b32 v9, 163712
    ds_read_b64 v[10:11], v9
    s_waitcnt lgkmcnt(0)
    v_readfirstlane_b32 s32, v10
    v_readfirstlane_b32 s33, v11
    s_mov_b32 s96, 5
    s_branch L_SET
L_SETR5:
    s_waitcnt vmcnt(0)
    v_mov_b32 v8, 163768
    v_mov_b32 v9, 1
    s_mov_b64 exec, 1
    ds_add_u32 v8, v9
    s_mov_b64 exec, -1
    s_and_b32 s40, s5, 3
    s_mul_i32 s40, s40, 80
    s_and_b32 s41, s34, 1
    s_add_u32 s40, s40, s41
    s_lshr_b32 s41, s34, 1
    s_lshl4_add_u32 s42, s41, 128
    s_mul_i32 s41, s41, 192
    v_and_b32 v20, 15, v2
    v_lshl_add_u32 v20, v20, 1, s40
    v_lshrrev_b32 v21, 4, v2
    v_lshl_add_u32 v22, v21, 2, s42
    v_lshl_add_u32 v21, v21, 2, s41
    v_cvt_f32_u32 v20, v20
    v_cvt_f32_u32 v21, v21
    v_cvt_f32_u32 v22, v22
L_LPOST:
    s_mov_b32 s96, 0
    s_cmp_ge_u32 s7, 10
    s_cbranch_scc1 L_CG
    v_lshrrev_b32 v9, 3, v2
    v_bfe_u32 v10, v2, 4, 1
    v_lshlrev_b32 v10, 2, v10
    v_and_b32 v11, 7, v2
    v_xor_b32 v10, v10, v11
    v_mul_u32_u24 v9, 1280, v9
    v_lshl_add_u32 v9, v10, 4, v9
    s_lshl_b32 s41, s7, 7
    v_add_u32 v9, s41, v9
    s_and_b32 s43, s6, 3
    s_mul_i32 s43, s43, 20
    s_add_u32 s43, s43, s34
    s_add_u32 s43, s43, 0
    s_sub_u32 s41, s43, 80
    s_cselect_b32 s43, s43, s41
    s_lshl_b32 s43, s43, 10
    s_add_u32 m0, s43, 73984
    s_mul_i32 s42, s43, 10
    buffer_load_dwordx4 v9, s[20:23], s42 offen lds
    s_add_u32 s43, s43, 4096
    s_sub_u32 s41, s43, 81920
    s_cselect_b32 s43, s43, s41
    s_add_u32 m0, s43, 73984
    s_mul_i32 s42, s43, 10
    buffer_load_dwordx4 v9, s[20:23], s42 offen lds
    s_add_u32 s43, s43, 4096
    s_sub_u32 s41, s43, 81920
    s_cselect_b32 s43, s43, s41
    s_add_u32 m0, s43, 73984
    s_mul_i32 s42, s43, 10
    buffer_load_dwordx4 v9, s[20:23], s42 offen lds
    s_add_u32 s43, s43, 4096
    s_sub_u32 s41, s43, 81920
    s_cselect_b32 s43, s43, s41
    s_add_u32 m0, s43, 73984
    s_mul_i32 s42, s43, 10
    buffer_load_dwordx4 v9, s[20:23], s42 offen lds
    s_add_u32 s43, s43, 4096
    s_sub_u32 s41, s43, 81920
    s_cselect_b32 s43, s43, s41
    s_add_u32 m0, s43, 73984
    s_mul_i32 s42, s43, 10
    buffer_load_dwordx4 v9, s[20:23], s42 offen lds
    s_add_u32 s43, s43, 4096
    s_sub_u32 s41, s43, 81920
    s_cselect_b32 s43, s43, s41
    v_bfe_u32 v9, v2, 2, 2
    v_bfe_u32 v10, v2, 4, 1
    v_bfe_u32 v11, v2, 1, 1
    v_lshl_add_u32 v10, v10, 1, v11
    v_lshrrev_b32 v11, 1, v9
    v_lshlrev_b32 v11, 2, v11
    v_xor_b32 v10, v10, v11
    v_and_b32 v11, 1, v2
    v_lshlrev_b32 v11, 3, v11
    v_lshl_add_u32 v10, v10, 4, v11
    v_lshl_add_u32 v10, v9, 7, v10
    v_add_u32 v10, 73984, v10
    v_lshl_add_u32 v168, v19, 9, v10
    v_xor_b32 v169, 64, v168
    v_mul_u32_u24 v11, 5120, v19
    v_add_u32 v11, 2048, v11
    v_add_u32 v170, v11, v10
    v_xor_b32 v171, 64, v170
    s_lshl_b32 s30, s36, 2
    s_add_u32 s30, s30, s34
    s_lshl_b32 s30, s30, 9
    s_add_u32 s30, s30, 14942208
    s_lshl_b32 s40, s34, 12
    s_add_u32 s40, s40, 0
    v_and_b32 v9, 7, v18
    v_lshl_add_u32 v10, v18, 7, s40
    v_lshl_add_u32 v10, v19, 3, v10
    v_xor_b32 v11, 0, v9
    v_lshl_add_u32 v172, v11, 4, v10
    v_xor_b32 v11, 1, v9
    v_lshl_add_u32 v173, v11, 4, v10
    v_xor_b32 v11, 2, v9
    v_lshl_add_u32 v174, v11, 4, v10
    v_xor_b32 v11, 3, v9
    v_lshl_add_u32 v175, v11, 4, v10
    v_xor_b32 v11, 4, v9
    v_lshl_add_u32 v176, v11, 4, v10
    v_xor_b32 v11, 5, v9
    v_lshl_add_u32 v177, v11, 4, v10
    v_xor_b32 v11, 6, v9
    v_lshl_add_u32 v178, v11, 4, v10
    v_xor_b32 v11, 7, v9
    v_lshl_add_u32 v179, v11, 4, v10
    v_lshrrev_b32 v9, 3, v2
    v_and_b32 v10, 7, v2
    v_xor_b32 v11, v9, v10
    v_lshlrev_b32 v11, 4, v11
    v_lshl_add_u32 v11, v9, 7, v11
    v_add_u32 v180, s40, v11
    s_lshl2_add_u32 s31, s6, s34
    s_mul_i32 s31, s31, 81920
    s_lshl_b32 s40, s7, 7
    s_add_u32 s31, s31, s40
    s_add_u32 s31, s31, 1280
    v_mov_b32 v136, 0
    v_mov_b32 v137, 0
    v_mov_b32 v138, 0
    v_mov_b32 v139, 0
    v_mov_b32 v140, 0
    v_mov_b32 v141, 0
    v_mov_b32 v142, 0
    v_mov_b32 v143, 0
    v_mov_b32 v144, 0
    v_mov_b32 v145, 0
    v_mov_b32 v146, 0
    v_mov_b32 v147, 0
    v_mov_b32 v148, 0
    v_mov_b32 v149, 0
    v_mov_b32 v150, 0
    v_mov_b32 v151, 0
    v_mov_b32 v152, 0
    v_mov_b32 v153, 0
    v_mov_b32 v154, 0
    v_mov_b32 v155, 0
    v_mov_b32 v156, 0
    v_mov_b32 v157, 0
    v_mov_b32 v158, 0
    v_mov_b32 v159, 0
    v_mov_b32 v160, 0
    v_mov_b32 v161, 0
    v_mov_b32 v162, 0
    v_mov_b32 v163, 0
    v_mov_b32 v164, 0
    v_mov_b32 v165, 0
    v_mov_b32 v166, 0
    v_mov_b32 v167, 0
    s_branch L_ATT
L_CG:
    s_and_b32 s40, s34, 1
    s_mul_i32 s40, s40, 20480
    s_add_u32 s40, s40, 11534336
    s_lshr_b32 s41, s34, 1
    s_mul_i32 s31, s41, 12288
    s_add_u32 s31, s31, s40
    s_lshl3_add_u32 s39, s41, s40
    s_add_u32 s39, s39, 8192
    s_sub_u32 s40, s5, 20
    s_lshr_b32 s40, s40, 2
    s_mul_i32 s40, s40, 3
    s_lshl3_add_u32 s40, s4, s40
    s_add_u32 s40, s40, s35
    s_mul_i32 s28, s40, 41088
    s_add_u32 s30, s28, s39
    s_add_u32 s28, s28, s31
    s_add_u32 s29, s28, 4096
    s_mul_i32 s37, s4, 12
    s_add_u32 s37, s37, s5
    s_lshl_b32 s37, s37, 9
    s_add_u32 s37, s37, 15980544
    s_mov_b32 s38, 163720
    s_cmp_eq_u32 s1, 15
    s_cselect_b32 s38, 163764, s38
    v_add_f32 v29, 0x42800000, v20
    v_mul_f32 v23, 0x3acccccd, v29
    v_mul_f32 v30, 0x41800000, v29
    v_mul_f32 v31, 0x3acccccd, v30
    v_rndne_f32 v31, v31
    v_fmamk_f32 v30, v31, 0xc4200000, v30
    v_mul_f32 v24, 0x3acccccd, v30
    v_mul_f32 v30, v29, v21
    v_mul_f32 v31, 0x3acccccd, v30
    v_rndne_f32 v31, v31
    v_fmamk_f32 v30, v31, 0xc4200000, v30
    v_mul_f32 v25, 0x3acccccd, v30
    v_mul_f32 v30, v29, v22
    v_mul_f32 v31, 0x3acccccd, v30
    v_rndne_f32 v31, v31
    v_fmamk_f32 v30, v31, 0xc4200000, v30
    v_mul_f32 v26, 0x3acccccd, v30
    v_cos_f32 v27, v23
    v_cos_f32 v28, v24
    s_nop 0
    v_add_f32 v27, v27, v27
    v_add_f32 v28, v28, v28
    v_add_f32 v30, v25, v23
    v_cos_f32 v32, v25
    v_cos_f32 v33, v30
    v_sin_f32 v34, v25
    v_sin_f32 v35, v30
    v_fma_f32 v40, v27, v33, -v32
    v_cvt_pk_bf16_f32 v152, v32, v33
    v_fma_f32 v42, v27, v35, -v34
    v_cvt_pk_bf16_f32 v156, v34, v35
    v_fma_f32 v41, v27, v40, -v33
    v_fma_f32 v43, v27, v42, -v35
    v_cvt_pk_bf16_f32 v153, v40, v41
    v_cvt_pk_bf16_f32 v157, v42, v43
    v_add_f32 v25, v25, v24
    v_add_f32 v30, v25, v23
    v_cos_f32 v36, v25
    v_cos_f32 v37, v30
    v_sin_f32 v38, v25
    v_sin_f32 v39, v30
    v_fma_f32 v40, v27, v37, -v36
    v_cvt_pk_bf16_f32 v176, v36, v37
    v_fma_f32 v42, v27, v39, -v38
    v_cvt_pk_bf16_f32 v180, v38, v39
    v_fma_f32 v41, v27, v40, -v37
    v_fma_f32 v43, v27, v42, -v39
    v_cvt_pk_bf16_f32 v177, v40, v41
    v_cvt_pk_bf16_f32 v181, v42, v43
    v_fma_f32 v32, v28, v36, -v32
    v_fma_f32 v33, v28, v37, -v33
    v_fma_f32 v34, v28, v38, -v34
    v_fma_f32 v35, v28, v39, -v35
    v_fma_f32 v40, v27, v33, -v32
    v_cvt_pk_bf16_f32 v154, v32, v33
    v_fma_f32 v42, v27, v35, -v34
    v_cvt_pk_bf16_f32 v158, v34, v35
    v_fma_f32 v41, v27, v40, -v33
    v_fma_f32 v43, v27, v42, -v35
    v_cvt_pk_bf16_f32 v155, v40, v41
    v_cvt_pk_bf16_f32 v159, v42, v43
    v_fma_f32 v36, v28, v32, -v36
    v_fma_f32 v37, v28, v33, -v37
    v_fma_f32 v38, v28, v34, -v38
    v_fma_f32 v39, v28, v35, -v39
    v_fma_f32 v40, v27, v37, -v36
    v_cvt_pk_bf16_f32 v178, v36, v37
    v_fma_f32 v42, v27, v39, -v38
    v_cvt_pk_bf16_f32 v182, v38, v39
    v_fma_f32 v41, v27, v40, -v37
    v_fma_f32 v43, v27, v42, -v39
    v_cvt_pk_bf16_f32 v179, v40, v41
    v_cvt_pk_bf16_f32 v183, v42, v43
    v_fma_f32 v32, v28, v36, -v32
    v_fma_f32 v33, v28, v37, -v33
    v_fma_f32 v34, v28, v38, -v34
    v_fma_f32 v35, v28, v39, -v35
    v_fma_f32 v40, v27, v33, -v32
    v_cvt_pk_bf16_f32 v200, v32, v33
    v_fma_f32 v42, v27, v35, -v34
    v_cvt_pk_bf16_f32 v204, v34, v35
    v_fma_f32 v41, v27, v40, -v33
    v_fma_f32 v43, v27, v42, -v35
    v_cvt_pk_bf16_f32 v201, v40, v41
    v_cvt_pk_bf16_f32 v205, v42, v43
    v_fma_f32 v36, v28, v32, -v36
    v_fma_f32 v37, v28, v33, -v37
    v_fma_f32 v38, v28, v34, -v38
    v_fma_f32 v39, v28, v35, -v39
    v_fma_f32 v40, v27, v37, -v36
    v_cvt_pk_bf16_f32 v224, v36, v37
    v_fma_f32 v42, v27, v39, -v38
    v_cvt_pk_bf16_f32 v228, v38, v39
    v_fma_f32 v41, v27, v40, -v37
    v_fma_f32 v43, v27, v42, -v39
    v_cvt_pk_bf16_f32 v225, v40, v41
    v_cvt_pk_bf16_f32 v229, v42, v43
    s_branch L_ATT
L_CG2:
    v_fma_f32 v32, v28, v36, -v32
    v_fma_f32 v33, v28, v37, -v33
    v_fma_f32 v34, v28, v38, -v34
    v_fma_f32 v35, v28, v39, -v35
    v_fma_f32 v40, v27, v33, -v32
    v_cvt_pk_bf16_f32 v202, v32, v33
    v_fma_f32 v42, v27, v35, -v34
    v_cvt_pk_bf16_f32 v206, v34, v35
    v_fma_f32 v41, v27, v40, -v33
    v_fma_f32 v43, v27, v42, -v35
    v_cvt_pk_bf16_f32 v203, v40, v41
    v_cvt_pk_bf16_f32 v207, v42, v43
    v_fma_f32 v36, v28, v32, -v36
    v_fma_f32 v37, v28, v33, -v37
    v_fma_f32 v38, v28, v34, -v38
    v_fma_f32 v39, v28, v35, -v39
    v_fma_f32 v40, v27, v37, -v36
    v_cvt_pk_bf16_f32 v226, v36, v37
    v_fma_f32 v42, v27, v39, -v38
    v_cvt_pk_bf16_f32 v230, v38, v39
    v_fma_f32 v41, v27, v40, -v37
    v_fma_f32 v43, v27, v42, -v39
    v_cvt_pk_bf16_f32 v227, v40, v41
    v_cvt_pk_bf16_f32 v231, v42, v43
    v_add_f32 v30, v26, v23
    v_cos_f32 v32, v26
    v_cos_f32 v33, v30
    v_sin_f32 v34, v26
    v_sin_f32 v35, v30
    v_fma_f32 v40, v27, v33, -v32
    v_cvt_pk_bf16_f32 v248, v32, v33
    v_fma_f32 v42, v27, v35, -v34
    v_cvt_pk_bf16_f32 v252, v34, v35
    v_fma_f32 v41, v27, v40, -v33
    v_fma_f32 v43, v27, v42, -v35
    v_cvt_pk_bf16_f32 v249, v40, v41
    v_cvt_pk_bf16_f32 v253, v42, v43
    v_fma_f32 v26, 2.0, v24, v26
    v_add_f32 v30, v26, v23
    v_cos_f32 v36, v26
    v_cos_f32 v37, v30
    v_sin_f32 v38, v26
    v_sin_f32 v39, v30
    v_fma_f32 v40, v27, v37, -v36
    v_cvt_pk_bf16_f32 v250, v36, v37
    v_fma_f32 v42, v27, v39, -v38
    v_cvt_pk_bf16_f32 v254, v38, v39
    v_fma_f32 v41, v27, v40, -v37
    v_fma_f32 v43, v27, v42, -v39
    v_cvt_pk_bf16_f32 v251, v40, v41
    v_cvt_pk_bf16_f32 v255, v42, v43
    s_branch L_CG2R
L_C:
    s_mov_b32 s35, 1
    s_add_u32 s40, s7, 1
    s_cmp_eq_u32 s6, 0
    s_cselect_b32 s40, s40, s6
    s_cselect_b32 s41, 15, s7
    s_cmp_eq_u32 s7, 15
    s_cselect_b32 s46, s6, s41
    s_cselect_b32 s45, 0, s40
    s_waitcnt lgkmcnt(0)
    s_mov_b64 s[20:21], s[72:73]
    s_mov_b32 s22, 819200
    s_mov_b32 s23, 0x20000
    s_mov_b64 s[24:25], s[74:75]
    s_mov_b32 s26, 5242880
    s_mov_b32 s27, 0x20000
    s_mov_b64 s[28:29], s[76:77]
    s_mov_b32 s30, 256
    s_mov_b32 s31, 0x20000
    s_mov_b64 s[16:17], s[78:79]
    s_mov_b32 s18, 268435456
    s_mov_b32 s19, 0x20000
    s_cmp_lg_u32 s3, 2
    s_cbranch_scc1 L_nw_10
    s_cmp_lg_u32 s2, 248
    s_cbranch_scc1 L_nw_10
    s_memrealtime s[54:55]
    s_waitcnt lgkmcnt(0)
    v_mov_b32 v6, s54
    v_mov_b32 v7, s55
    v_or_b32 v7, 0x40000000, v7
    v_mov_b32 v5, 0
    s_mov_b64 exec, 1
    buffer_store_dwordx2 v[6:7], v5, s[28:31], 0 offen sc1
    s_mov_b64 exec, -1
L_nw_10:
    v_mov_b32 v14, 0x3f803f80
    v_mov_b32 v16, 0x3f80
    v_mov_b32 v10, 0
    v_mov_b32 v11, 0
    s_lshl_b32 s40, s45, 2
    s_sub_u32 s40, 8, s40
    v_add_u32 v5, 0, v0
    v_lshrrev_b32 v6, 5, v5
    v_and_b32 v7, 31, v5
    v_mov_b32 v12, 0x00003f80
    v_mov_b32 v13, 0xf1493f80
    v_cmp_gt_i32 vcc, s40, v6
    s_nop 1
    v_cndmask_b32 v12, v12, v13, vcc
    v_cmp_eq_u32 vcc, 4, v7
    v_lshlrev_b32 v5, 4, v5
    v_add_u32 v5, 155904, v5
    v_cndmask_b32 v9, 0, v12, vcc
    v_cndmask_b32 v8, v16, v14, vcc
    ds_write_b128 v5, v[8:11]
    s_nop 1
    v_add_u32 v5, 128, v0
    v_lshrrev_b32 v6, 5, v5
    v_and_b32 v7, 31, v5
    v_mov_b32 v12, 0x00003f80
    v_mov_b32 v13, 0xf1493f80
    v_cmp_gt_i32 vcc, s40, v6
    s_nop 1
    v_cndmask_b32 v12, v12, v13, vcc
    v_cmp_eq_u32 vcc, 4, v7
    v_lshlrev_b32 v5, 4, v5
    v_add_u32 v5, 155904, v5
    v_cndmask_b32 v9, 0, v12, vcc
    v_cndmask_b32 v8, v16, v14, vcc
    ds_write_b128 v5, v[8:11]
    s_nop 1
    s_mul_i32 s40, s34, 416
    s_add_u32 s40, s40, 162048
    v_mov_b32 v13, 0xf149f2ca
    v_add_u32 v5, 0, v2
    v_add_u32 v6, s34, v5
    v_lshrrev_b32 v6, 5, v6
    v_cmp_eq_u32 vcc, 1, v6
    v_lshl_add_u32 v5, v5, 2, s40
    s_nop 0
    v_cndmask_b32 v7, 0, v13, vcc
    ds_write_b32 v5, v7
    v_add_u32 v5, 40, v2
    v_add_u32 v6, s34, v5
    v_lshrrev_b32 v6, 5, v6
    v_cmp_eq_u32 vcc, 1, v6
    v_lshl_add_u32 v5, v5, 2, s40
    s_nop 0
    v_cndmask_b32 v7, 0, v13, vcc
    ds_write_b32 v5, v7
    v_and_b32 v5, 31, v2
    v_lshlrev_b32 v5, 2, v5
    v_add_u32 v5, 163712, v5
    v_mov_b32 v6, 0
    ds_write_b32 v5, v6
    v_and_b32 v5, 15, v2
    v_lshrrev_b32 v5, 2, v5
    v_lshrrev_b32 v4, 5, v2
    v_lshl_add_u32 v6, v4, 3, v5
    v_lshlrev_b32 v6, 7, v6
    v_and_b32 v7, 1, v2
    v_lshl_add_u32 v6, v7, 3, v6
    v_bfe_u32 v7, v2, 4, 1
    v_bfe_u32 v10, v2, 1, 1
    v_lshl_add_u32 v7, v7, 1, v10
    v_lshrrev_b32 v5, 1, v5
    v_lshlrev_b32 v5, 2, v5
    v_xor_b32 v7, v7, v5
    v_lshl_add_u32 v8, v7, 4, v6
    v_xor_b32 v9, 64, v8
    v_and_b32 v3, 31, v2
    s_cmp_eq_u32 s7, 15
    s_cbranch_scc1 L_A1C
    s_lshl_b32 s40, s34, 12
    s_add_u32 s40, s40, 57344
    v_lshl_add_u32 v5, v3, 7, s40
    v_bfe_u32 v6, v3, 1, 3
    s_lshl_b32 s40, s6, 7
    s_lshl_b32 s41, s34, 5
    s_add_u32 s40, s40, s41
    v_add_u32 v5, s40, v3
    v_lshlrev_b32 v5, 4, v5
    v_lshl_add_u32 v14, v4, 15, v5
    s_mul_i32 s40, s7, 52
    s_lshr_b32 s40, s40, 8
    s_mul_i32 s40, s40, 5
    s_add_u32 s40, s40, s7
    s_lshl_b32 s38, s40, 18
    s_cmp_lt_u32 s7, 5
    s_cselect_b32 s39, 0x3ea52b5c, 1.0
    s_mul_i32 s40, s7, 52
    s_lshr_b32 s40, s40, 8
    s_mul_i32 s41, s40, 5
    s_sub_u32 s41, s7, s41
    v_lshrrev_b32 v5, 4, v2
    v_bfe_u32 v6, v2, 2, 2
    v_and_b32 v7, 3, v2
    v_add_u32 v16, s6, v5
    s_mul_i32 s42, s41, 3
    v_lshl_add_u32 v17, v16, 4, s42
    v_add_u32 v17, v17, v7
    v_lshlrev_b32 v17, 9, v17
    v_lshl_add_u32 v17, v6, 4, v17
    s_min_u32 s41, s41, 1
    s_lshl_b32 s41, s41, 3
    v_mov_b32 v18, s41
    v_cmp_eq_u32 vcc, 0, v7
    s_lshl_b32 s42, s40, 7
    s_sub_u32 s42, s42, 128
    s_cselect_b32 s42, 48, s42
    s_add_u32 s42, s42, 14680064
    v_cndmask_b32 v18, 0, v18, vcc
    v_add3_u32 v17, v17, v18, s42
    s_cmp_eq_u32 s6, 0
    s_cselect_b32 s41, 3, 0
    s_min_u32 s40, s40, 1
    s_lshl_b32 s40, s40, 1
    v_sub_u32 v18, v6, v5
    v_cmp_ge_u32 vcc, s41, v18
    v_cmp_ge_u32 s[44:45], s40, v6
    v_cmp_ge_u32 s[46:47], 15, v16
    s_and_b64 vcc, vcc, s[44:45]
    s_and_b64 vcc, vcc, s[46:47]
    v_mov_b32 v18, 0x7f000000
    v_mov_b32 v20, 163760
    v_mov_b32 v21, 1
    v_cndmask_b32 v31, v18, v17, vcc
    s_lshl_b32 s40, s34, 12
    s_add_u32 s40, s40, 57344
    v_and_b32 v5, 15, v2
    v_lshrrev_b32 v6, 4, v2
    v_lshrrev_b32 v7, 1, v5
    v_xor_b32 v7, v7, v6
    v_lshl_add_u32 v5, v5, 7, s40
    v_lshl_add_u32 v10, v7, 4, v5
    v_xor_b32 v11, 64, v10
    v_add_u32 v12, 49152, v10
    v_add_u32 v13, 49152, v11
    v_bfe_u32 v5, v2, 2, 2
    v_lshl_add_u32 v7, v6, 3, v5
    v_lshlrev_b32 v7, 7, v7
    v_and_b32 v8, 1, v2
    v_lshl_add_u32 v7, v8, 3, v7
    v_and_b32 v5, 2, v5
    v_and_b32 v6, 1, v6
    v_lshl_add_u32 v5, v6, 2, v5
    v_bfe_u32 v8, v2, 1, 1
    v_add_u32 v5, v5, v8
    v_lshl_add_u32 v7, v5, 4, v7
    v_xor_b32 v3, 0, v7
    v_add_u32 v22, 57344, v3
    v_add_u32 v26, 106496, v3
    v_xor_b32 v4, 32, v7
    v_add_u32 v23, 57344, v4
    v_add_u32 v27, 106496, v4
    v_xor_b32 v5, 64, v7
    v_add_u32 v24, 57344, v5
    v_add_u32 v28, 106496, v5
    v_xor_b32 v6, 96, v7
    v_add_u32 v25, 57344, v6
    v_add_u32 v29, 106496, v6
    s_mov_b32 s96, 6
    s_branch L_SET
L_SETR6:
    v_and_b32 v16, 1, v2
    v_lshlrev_b32 v16, 7, v16
    v_bfe_u32 v17, v2, 1, 1
    s_sub_u32 s40, s14, 131072
    v_lshl_add_u32 v18, v17, 17, s40
    s_lshl_b32 s40, s36, 11
    s_add_u32 s40, s40, 14941696
    s_mul_i32 s41, s4, 12
    s_add_u32 s41, s41, s5
    s_lshl_b32 s41, s41, 9
    s_add_u32 s41, s41, 15980032
    s_cmp_lt_u32 s7, 10
    s_cselect_b32 s40, s40, s41
    s_cselect_b32 s41, 20, 6
    v_lshl_add_u32 v17, v17, 19, s40
    v_lshrrev_b32 v19, 2, v2
    v_lshl_add_u32 v17, v19, 9, v17
    v_cmp_gt_u32 vcc, 4, v2
    v_mov_b32 v19, 0x7f000000
    s_nop 0
    v_cndmask_b32 v17, v17, v18, vcc
    v_cmp_gt_u32 vcc, s41, v2
    v_add_u32 v16, v16, v17
    s_nop 0
    v_cndmask_b32 v0, v19, v16, vcc
    v_mov_b32 v9, 163712
    s_waitcnt lgkmcnt(0)
    s_barrier
    ds_read_b128 v[240:243], v12 offset:0
    ds_read_b128 v[244:247], v12 offset:2048
    ds_read_b64_tr_b16 v[32:33], v26 offset:16384
    ds_read_b64_tr_b16 v[34:35], v26 offset:16896
    ds_read_b64_tr_b16 v[36:37], v28 offset:16384
    ds_read_b64_tr_b16 v[38:39], v28 offset:16896
    ds_read_b64_tr_b16 v[40:41], v27 offset:16384
    ds_read_b64_tr_b16 v[42:43], v27 offset:16896
    ds_read_b64_tr_b16 v[44:45], v29 offset:16384
    ds_read_b64_tr_b16 v[46:47], v29 offset:16896
    s_waitcnt lgkmcnt(4)
    v_mfma_f32_16x16x32_bf16 v[64:67], v[32:35], v[240:243], 0
    ds_read_b128 v[248:251], v13 offset:0
    ds_read_b128 v[252:255], v13 offset:2048
    ds_read_b64_tr_b16 v[48:49], v26 offset:20480
    v_mfma_f32_16x16x32_bf16 v[68:71], v[32:35], v[244:247], 0
    ds_read_b64_tr_b16 v[50:51], v26 offset:20992
    v_mfma_f32_16x16x32_bf16 v[80:83], v[36:39], v[240:243], 0
    ds_read_b64_tr_b16 v[52:53], v28 offset:20480
    v_mfma_f32_16x16x32_bf16 v[84:87], v[36:39], v[244:247], 0
    ds_read_b64_tr_b16 v[54:55], v28 offset:20992
    s_waitcnt lgkmcnt(6)
    v_mfma_f32_16x16x32_bf16 v[72:75], v[40:43], v[240:243], 0
    ds_read_b64_tr_b16 v[56:57], v27 offset:20480
    v_mfma_f32_16x16x32_bf16 v[76:79], v[40:43], v[244:247], 0
    ds_read_b64_tr_b16 v[58:59], v27 offset:20992
    v_mfma_f32_16x16x32_bf16 v[88:91], v[44:47], v[240:243], 0
    ds_read_b64_tr_b16 v[60:61], v29 offset:20480
    v_mfma_f32_16x16x32_bf16 v[92:95], v[44:47], v[244:247], 0
    ds_read_b64_tr_b16 v[62:63], v29 offset:20992
    s_waitcnt lgkmcnt(4)
    v_mfma_f32_16x16x32_bf16 v[64:67], v[48:51], v[248:251], v[64:67]
    ds_read_b64_tr_b16 v[32:33], v3 offset:0
    v_mfma_f32_16x16x32_bf16 v[68:71], v[48:51], v[252:255], v[68:71]
    ds_read_b64_tr_b16 v[34:35], v3 offset:512
    v_mfma_f32_16x16x32_bf16 v[80:83], v[52:55], v[248:251], v[80:83]
    ds_read_b64_tr_b16 v[36:37], v5 offset:0
    v_mfma_f32_16x16x32_bf16 v[84:87], v[52:55], v[252:255], v[84:87]
    ds_read_b64_tr_b16 v[38:39], v5 offset:512
    s_waitcnt lgkmcnt(4)
    v_mfma_f32_16x16x32_bf16 v[72:75], v[56:59], v[248:251], v[72:75]
    s_waitcnt lgkmcnt(0)
    s_barrier
    ds_read_b128 v[224:227], v12 offset:24576
    ds_read_b128 v[228:231], v12 offset:26624
    ds_read_b64_tr_b16 v[40:41], v26 offset:40960
    v_mfma_f32_16x16x32_bf16 v[76:79], v[56:59], v[252:255], v[76:79]
    ds_read_b64_tr_b16 v[42:43], v26 offset:41472
    v_mfma_f32_16x16x32_bf16 v[88:91], v[60:63], v[248:251], v[88:91]
    ds_read_b64_tr_b16 v[44:45], v28 offset:40960
    v_mfma_f32_16x16x32_bf16 v[92:95], v[60:63], v[252:255], v[92:95]
    ds_read_b64_tr_b16 v[46:47], v28 offset:41472
    v_mfma_f32_16x16x32_bf16 v[96:99], v[32:35], v[240:243], 0
    ds_read_b64_tr_b16 v[48:49], v27 offset:40960
    v_mfma_f32_16x16x32_bf16 v[100:103], v[32:35], v[244:247], 0
    ds_read_b64_tr_b16 v[50:51], v27 offset:41472
    v_mfma_f32_16x16x32_bf16 v[112:115], v[36:39], v[240:243], 0
    ds_read_b64_tr_b16 v[52:53], v29 offset:40960
    v_mfma_f32_16x16x32_bf16 v[116:119], v[36:39], v[244:247], 0
    ds_read_b64_tr_b16 v[54:55], v29 offset:41472
    s_waitcnt lgkmcnt(4)
    v_mfma_f32_16x16x32_bf16 v[64:67], v[40:43], v[224:227], v[64:67]
    ds_read_b128 v[232:235], v13 offset:24576
    ds_read_b128 v[236:239], v13 offset:26624
    ds_read_b64_tr_b16 v[56:57], v26 offset:45056
    v_mfma_f32_16x16x32_bf16 v[68:71], v[40:43], v[228:231], v[68:71]
    ds_read_b64_tr_b16 v[58:59], v26 offset:45568
    v_mfma_f32_16x16x32_bf16 v[80:83], v[44:47], v[224:227], v[80:83]
    ds_read_b64_tr_b16 v[60:61], v28 offset:45056
    v_mfma_f32_16x16x32_bf16 v[84:87], v[44:47], v[228:231], v[84:87]
    ds_read_b64_tr_b16 v[62:63], v28 offset:45568
    s_waitcnt lgkmcnt(6)
    v_mfma_f32_16x16x32_bf16 v[72:75], v[48:51], v[224:227], v[72:75]
    ds_read_b64_tr_b16 v[32:33], v27 offset:45056
    v_mfma_f32_16x16x32_bf16 v[76:79], v[48:51], v[228:231], v[76:79]
    ds_read_b64_tr_b16 v[34:35], v27 offset:45568
    v_mfma_f32_16x16x32_bf16 v[88:91], v[52:55], v[224:227], v[88:91]
    ds_read_b64_tr_b16 v[36:37], v29 offset:45056
    v_mfma_f32_16x16x32_bf16 v[92:95], v[52:55], v[228:231], v[92:95]
    ds_read_b64_tr_b16 v[38:39], v29 offset:45568
    s_waitcnt lgkmcnt(4)
    v_mfma_f32_16x16x32_bf16 v[64:67], v[56:59], v[232:235], v[64:67]
    ds_read_b64_tr_b16 v[40:41], v4 offset:0
    v_mfma_f32_16x16x32_bf16 v[68:71], v[56:59], v[236:239], v[68:71]
    ds_read_b64_tr_b16 v[42:43], v4 offset:512
    v_mfma_f32_16x16x32_bf16 v[80:83], v[60:63], v[232:235], v[80:83]
    ds_read_b64_tr_b16 v[44:45], v6 offset:0
    v_mfma_f32_16x16x32_bf16 v[84:87], v[60:63], v[236:239], v[84:87]
    ds_read_b64_tr_b16 v[46:47], v6 offset:512
    s_waitcnt lgkmcnt(4)
    v_mfma_f32_16x16x32_bf16 v[72:75], v[32:35], v[232:235], v[72:75]
    s_waitcnt lgkmcnt(0)
    s_barrier
    ds_read_b128 v[128:131], v10 offset:0
    ds_read_b128 v[132:135], v10 offset:2048
    ds_read_b64_tr_b16 v[48:49], v22 offset:16384
    v_mfma_f32_16x16x32_bf16 v[76:79], v[32:35], v[236:239], v[76:79]
    ds_read_b64_tr_b16 v[50:51], v22 offset:16896
    v_mfma_f32_16x16x32_bf16 v[88:91], v[36:39], v[232:235], v[88:91]
    ds_read_b64_tr_b16 v[52:53], v24 offset:16384
    v_mfma_f32_16x16x32_bf16 v[92:95], v[36:39], v[236:239], v[92:95]
    ds_read_b64_tr_b16 v[54:55], v24 offset:16896
    v_mfma_f32_16x16x32_bf16 v[104:107], v[40:43], v[240:243], 0
    ds_read_b64_tr_b16 v[56:57], v23 offset:16384
    v_mfma_f32_16x16x32_bf16 v[108:111], v[40:43], v[244:247], 0
    ds_read_b64_tr_b16 v[58:59], v23 offset:16896
    v_mfma_f32_16x16x32_bf16 v[120:123], v[44:47], v[240:243], 0
    ds_read_b64_tr_b16 v[60:61], v25 offset:16384
    v_mfma_f32_16x16x32_bf16 v[124:127], v[44:47], v[244:247], 0
    ds_read_b64_tr_b16 v[62:63], v25 offset:16896
    s_waitcnt lgkmcnt(4)
    v_mfma_f32_16x16x32_bf16 v[64:67], v[48:51], v[128:131], v[64:67]
    ds_read_b128 v[136:139], v11 offset:0
    ds_read_b128 v[140:143], v11 offset:2048
    ds_read_b64_tr_b16 v[32:33], v22 offset:20480
    v_mfma_f32_16x16x32_bf16 v[68:71], v[48:51], v[132:135], v[68:71]
    ds_read_b64_tr_b16 v[34:35], v22 offset:20992
    v_mfma_f32_16x16x32_bf16 v[80:83], v[52:55], v[128:131], v[80:83]
    ds_read_b64_tr_b16 v[36:37], v24 offset:20480
    v_mfma_f32_16x16x32_bf16 v[84:87], v[52:55], v[132:135], v[84:87]
    ds_read_b64_tr_b16 v[38:39], v24 offset:20992
    s_waitcnt lgkmcnt(6)
    v_mfma_f32_16x16x32_bf16 v[72:75], v[56:59], v[128:131], v[72:75]
    ds_read_b64_tr_b16 v[40:41], v23 offset:20480
    v_mfma_f32_16x16x32_bf16 v[76:79], v[56:59], v[132:135], v[76:79]
    ds_read_b64_tr_b16 v[42:43], v23 offset:20992
    v_mfma_f32_16x16x32_bf16 v[88:91], v[60:63], v[128:131], v[88:91]
    ds_read_b64_tr_b16 v[44:45], v25 offset:20480
    v_mfma_f32_16x16x32_bf16 v[92:95], v[60:63], v[132:135], v[92:95]
    ds_read_b64_tr_b16 v[46:47], v25 offset:20992
    s_waitcnt lgkmcnt(4)
    v_mfma_f32_16x16x32_bf16 v[64:67], v[32:35], v[136:139], v[64:67]
    ds_read_b64_tr_b16 v[48:49], v3 offset:4096
    v_mfma_f32_16x16x32_bf16 v[68:71], v[32:35], v[140:143], v[68:71]
    ds_read_b64_tr_b16 v[50:51], v3 offset:4608
    v_mfma_f32_16x16x32_bf16 v[80:83], v[36:39], v[136:139], v[80:83]
    ds_read_b64_tr_b16 v[52:53], v5 offset:4096
    v_mfma_f32_16x16x32_bf16 v[84:87], v[36:39], v[140:143], v[84:87]
    ds_read_b64_tr_b16 v[54:55], v5 offset:4608
    s_waitcnt lgkmcnt(4)
    v_mfma_f32_16x16x32_bf16 v[72:75], v[40:43], v[136:139], v[72:75]
    s_waitcnt lgkmcnt(0)
    s_cmp_lg_u32 s3, 0
    s_cbranch_scc1 L_ni_11
    v_mov_b32 v16, 0
    buffer_load_dwordx2 v[18:19], v16, s[28:31], 0 offen sc1
L_ni_11:
    s_barrier
    ds_read_b128 v[144:147], v10 offset:24576
    ds_read_b128 v[148:151], v10 offset:26624
    ds_read_b64_tr_b16 v[56:57], v22 offset:40960
    v_mfma_f32_16x16x32_bf16 v[76:79], v[40:43], v[140:143], v[76:79]
    ds_read_b64_tr_b16 v[58:59], v22 offset:41472
    v_mfma_f32_16x16x32_bf16 v[88:91], v[44:47], v[136:139], v[88:91]
    ds_read_b64_tr_b16 v[60:61], v24 offset:40960
    v_mfma_f32_16x16x32_bf16 v[92:95], v[44:47], v[140:143], v[92:95]
    ds_read_b64_tr_b16 v[62:63], v24 offset:41472
    v_mfma_f32_16x16x32_bf16 v[96:99], v[48:51], v[248:251], v[96:99]
    ds_read_b64_tr_b16 v[32:33], v23 offset:40960
    v_mfma_f32_16x16x32_bf16 v[100:103], v[48:51], v[252:255], v[100:103]
    ds_read_b64_tr_b16 v[34:35], v23 offset:41472
    v_mfma_f32_16x16x32_bf16 v[112:115], v[52:55], v[248:251], v[112:115]
    ds_read_b64_tr_b16 v[36:37], v25 offset:40960
    v_mfma_f32_16x16x32_bf16 v[116:119], v[52:55], v[252:255], v[116:119]
    ds_read_b64_tr_b16 v[38:39], v25 offset:41472
    s_waitcnt lgkmcnt(4)
    v_mfma_f32_16x16x32_bf16 v[64:67], v[56:59], v[144:147], v[64:67]
    ds_read_b128 v[152:155], v11 offset:24576
    ds_read_b128 v[156:159], v11 offset:26624
    ds_read_b64_tr_b16 v[40:41], v22 offset:45056
    v_mfma_f32_16x16x32_bf16 v[68:71], v[56:59], v[148:151], v[68:71]
    ds_read_b64_tr_b16 v[42:43], v22 offset:45568
    v_mfma_f32_16x16x32_bf16 v[80:83], v[60:63], v[144:147], v[80:83]
    ds_read_b64_tr_b16 v[44:45], v24 offset:45056
    v_mfma_f32_16x16x32_bf16 v[84:87], v[60:63], v[148:151], v[84:87]
    ds_read_b64_tr_b16 v[46:47], v24 offset:45568
    s_waitcnt lgkmcnt(6)
    v_mfma_f32_16x16x32_bf16 v[72:75], v[32:35], v[144:147], v[72:75]
    ds_read_b64_tr_b16 v[48:49], v23 offset:45056
    v_mfma_f32_16x16x32_bf16 v[76:79], v[32:35], v[148:151], v[76:79]
    ds_read_b64_tr_b16 v[50:51], v23 offset:45568
    v_mfma_f32_16x16x32_bf16 v[88:91], v[36:39], v[144:147], v[88:91]
    ds_read_b64_tr_b16 v[52:53], v25 offset:45056
    v_mfma_f32_16x16x32_bf16 v[92:95], v[36:39], v[148:151], v[92:95]
    ds_read_b64_tr_b16 v[54:55], v25 offset:45568
    s_waitcnt lgkmcnt(4)
    v_mfma_f32_16x16x32_bf16 v[64:67], v[40:43], v[152:155], v[64:67]
    ds_read_b64_tr_b16 v[56:57], v4 offset:4096
    v_mfma_f32_16x16x32_bf16 v[68:71], v[40:43], v[156:159], v[68:71]
    ds_read_b64_tr_b16 v[58:59], v4 offset:4608
    v_mfma_f32_16x16x32_bf16 v[80:83], v[44:47], v[152:155], v[80:83]
    ds_read_b64_tr_b16 v[60:61], v6 offset:4096
    v_mfma_f32_16x16x32_bf16 v[84:87], v[44:47], v[156:159], v[84:87]
    ds_read_b64_tr_b16 v[62:63], v6 offset:4608
    s_waitcnt lgkmcnt(4)
    v_mfma_f32_16x16x32_bf16 v[72:75], v[48:51], v[152:155], v[72:75]
    s_waitcnt lgkmcnt(0)
    s_barrier
    ds_read_b128 v[160:163], v12 offset:0
    ds_read_b128 v[164:167], v12 offset:2048
    ds_read_b64_tr_b16 v[32:33], v26 offset:16384
    v_mfma_f32_16x16x32_bf16 v[76:79], v[48:51], v[156:159], v[76:79]
    ds_read_b64_tr_b16 v[34:35], v26 offset:16896
    v_mfma_f32_16x16x32_bf16 v[88:91], v[52:55], v[152:155], v[88:91]
    ds_read_b64_tr_b16 v[36:37], v28 offset:16384
    v_mfma_f32_16x16x32_bf16 v[92:95], v[52:55], v[156:159], v[92:95]
    ds_read_b64_tr_b16 v[38:39], v28 offset:16896
    v_mfma_f32_16x16x32_bf16 v[104:107], v[56:59], v[248:251], v[104:107]
    ds_read_b64_tr_b16 v[40:41], v27 offset:16384
    v_mfma_f32_16x16x32_bf16 v[108:111], v[56:59], v[252:255], v[108:111]
    ds_read_b64_tr_b16 v[42:43], v27 offset:16896
    v_mfma_f32_16x16x32_bf16 v[120:123], v[60:63], v[248:251], v[120:123]
    ds_read_b64_tr_b16 v[44:45], v29 offset:16384
    v_mfma_f32_16x16x32_bf16 v[124:127], v[60:63], v[252:255], v[124:127]
    ds_read_b64_tr_b16 v[46:47], v29 offset:16896
    s_waitcnt lgkmcnt(4)
    v_mfma_f32_16x16x32_bf16 v[64:67], v[32:35], v[160:163], v[64:67]
    ds_read_b128 v[168:171], v13 offset:0
    ds_read_b128 v[172:175], v13 offset:2048
    ds_read_b64_tr_b16 v[48:49], v26 offset:20480
    v_mfma_f32_16x16x32_bf16 v[68:71], v[32:35], v[164:167], v[68:71]
    ds_read_b64_tr_b16 v[50:51], v26 offset:20992
    v_mfma_f32_16x16x32_bf16 v[80:83], v[36:39], v[160:163], v[80:83]
    ds_read_b64_tr_b16 v[52:53], v28 offset:20480
    v_mfma_f32_16x16x32_bf16 v[84:87], v[36:39], v[164:167], v[84:87]
    ds_read_b64_tr_b16 v[54:55], v28 offset:20992
    s_waitcnt lgkmcnt(6)
    v_mfma_f32_16x16x32_bf16 v[72:75], v[40:43], v[160:163], v[72:75]
    ds_read_b64_tr_b16 v[56:57], v27 offset:20480
    v_mfma_f32_16x16x32_bf16 v[76:79], v[40:43], v[164:167], v[76:79]
    ds_read_b64_tr_b16 v[58:59], v27 offset:20992
    v_mfma_f32_16x16x32_bf16 v[88:91], v[44:47], v[160:163], v[88:91]
    ds_read_b64_tr_b16 v[60:61], v29 offset:20480
    v_mfma_f32_16x16x32_bf16 v[92:95], v[44:47], v[164:167], v[92:95]
    ds_read_b64_tr_b16 v[62:63], v29 offset:20992
    s_waitcnt lgkmcnt(4)
    v_mfma_f32_16x16x32_bf16 v[64:67], v[48:51], v[168:171], v[64:67]
    ds_read_b64_tr_b16 v[32:33], v3 offset:8192
    v_mfma_f32_16x16x32_bf16 v[68:71], v[48:51], v[172:175], v[68:71]
    ds_read_b64_tr_b16 v[34:35], v3 offset:8704
    v_mfma_f32_16x16x32_bf16 v[80:83], v[52:55], v[168:171], v[80:83]
    ds_read_b64_tr_b16 v[36:37], v5 offset:8192
    v_mfma_f32_16x16x32_bf16 v[84:87], v[52:55], v[172:175], v[84:87]
    ds_read_b64_tr_b16 v[38:39], v5 offset:8704
    s_waitcnt lgkmcnt(4)
    v_mfma_f32_16x16x32_bf16 v[72:75], v[56:59], v[168:171], v[72:75]
    s_waitcnt lgkmcnt(0)
    s_barrier
    ds_read_b128 v[176:179], v12 offset:24576
    ds_read_b128 v[180:183], v12 offset:26624
    ds_read_b64_tr_b16 v[40:41], v26 offset:40960
    v_mfma_f32_16x16x32_bf16 v[76:79], v[56:59], v[172:175], v[76:79]
    ds_read_b64_tr_b16 v[42:43], v26 offset:41472
    v_mfma_f32_16x16x32_bf16 v[88:91], v[60:63], v[168:171], v[88:91]
    ds_read_b64_tr_b16 v[44:45], v28 offset:40960
    v_mfma_f32_16x16x32_bf16 v[92:95], v[60:63], v[172:175], v[92:95]
    ds_read_b64_tr_b16 v[46:47], v28 offset:41472
    v_mfma_f32_16x16x32_bf16 v[96:99], v[32:35], v[224:227], v[96:99]
    ds_read_b64_tr_b16 v[48:49], v27 offset:40960
    v_mfma_f32_16x16x32_bf16 v[100:103], v[32:35], v[228:231], v[100:103]
    ds_read_b64_tr_b16 v[50:51], v27 offset:41472
    v_mfma_f32_16x16x32_bf16 v[112:115], v[36:39], v[224:227], v[112:115]
    ds_read_b64_tr_b16 v[52:53], v29 offset:40960
    v_mfma_f32_16x16x32_bf16 v[116:119], v[36:39], v[228:231], v[116:119]
    ds_read_b64_tr_b16 v[54:55], v29 offset:41472
    s_waitcnt lgkmcnt(4)
    v_mfma_f32_16x16x32_bf16 v[64:67], v[40:43], v[176:179], v[64:67]
    ds_read_b128 v[184:187], v13 offset:24576
    ds_read_b128 v[188:191], v13 offset:26624
    ds_read_b64_tr_b16 v[56:57], v26 offset:45056
    v_mfma_f32_16x16x32_bf16 v[68:71], v[40:43], v[180:183], v[68:71]
    ds_read_b64_tr_b16 v[58:59], v26 offset:45568
    v_mfma_f32_16x16x32_bf16 v[80:83], v[44:47], v[176:179], v[80:83]
    ds_read_b64_tr_b16 v[60:61], v28 offset:45056
    v_mfma_f32_16x16x32_bf16 v[84:87], v[44:47], v[180:183], v[84:87]
    ds_read_b64_tr_b16 v[62:63], v28 offset:45568
    s_waitcnt lgkmcnt(6)
    v_mfma_f32_16x16x32_bf16 v[72:75], v[48:51], v[176:179], v[72:75]
    ds_read_b64_tr_b16 v[32:33], v27 offset:45056
    v_mfma_f32_16x16x32_bf16 v[76:79], v[48:51], v[180:183], v[76:79]
    ds_read_b64_tr_b16 v[34:35], v27 offset:45568
    v_mfma_f32_16x16x32_bf16 v[88:91], v[52:55], v[176:179], v[88:91]
    ds_read_b64_tr_b16 v[36:37], v29 offset:45056
    v_mfma_f32_16x16x32_bf16 v[92:95], v[52:55], v[180:183], v[92:95]
    ds_read_b64_tr_b16 v[38:39], v29 offset:45568
    s_waitcnt lgkmcnt(4)
    v_mfma_f32_16x16x32_bf16 v[64:67], v[56:59], v[184:187], v[64:67]
    ds_read_b64_tr_b16 v[40:41], v4 offset:8192
    v_mfma_f32_16x16x32_bf16 v[68:71], v[56:59], v[188:191], v[68:71]
    ds_read_b64_tr_b16 v[42:43], v4 offset:8704
    v_mfma_f32_16x16x32_bf16 v[80:83], v[60:63], v[184:187], v[80:83]
    ds_read_b64_tr_b16 v[44:45], v6 offset:8192
    v_mfma_f32_16x16x32_bf16 v[84:87], v[60:63], v[188:191], v[84:87]
    ds_read_b64_tr_b16 v[46:47], v6 offset:8704
    s_waitcnt lgkmcnt(4)
    v_mfma_f32_16x16x32_bf16 v[72:75], v[32:35], v[184:187], v[72:75]
    s_waitcnt lgkmcnt(0)
    s_cmp_lg_u32 s3, 1
    s_cbranch_scc1 L_vt_12
    buffer_load_dword v15, v0, s[16:19], 0 offen sc1
L_vt_12:
    s_cmp_lg_u32 s3, 0
    s_cbranch_scc1 L_nf_13
    s_mov_b32 s60, 0
L_nr_14:
    s_waitcnt vmcnt(0)
    v_cmp_eq_u64 vcc, 0, v[18:19]
    s_add_u32 s60, s60, 1
    s_cmp_eq_u64 vcc, 0
    s_cbranch_scc1 L_ne_15
    s_cmp_gt_u32 s60, 400000
    s_cbranch_scc1 L_ne_15
    v_mov_b32 v16, 0
    buffer_load_dwordx2 v[18:19], v16, s[28:31], 0 offen sc1
    s_branch L_nr_14
L_ne_15:
    v_mov_b32 v16, 163712
    ds_write_b64 v16, v[18:19]
L_nf_13:
    s_barrier
    ds_read_b128 v[192:195], v10 offset:0
    ds_read_b128 v[196:199], v10 offset:2048
    ds_read_b64_tr_b16 v[48:49], v22 offset:16384
    v_mfma_f32_16x16x32_bf16 v[76:79], v[32:35], v[188:191], v[76:79]
    ds_read_b64_tr_b16 v[50:51], v22 offset:16896
    v_mfma_f32_16x16x32_bf16 v[88:91], v[36:39], v[184:187], v[88:91]
    ds_read_b64_tr_b16 v[52:53], v24 offset:16384
    v_mfma_f32_16x16x32_bf16 v[92:95], v[36:39], v[188:191], v[92:95]
    ds_read_b64_tr_b16 v[54:55], v24 offset:16896
    v_mfma_f32_16x16x32_bf16 v[104:107], v[40:43], v[224:227], v[104:107]
    ds_read_b64_tr_b16 v[56:57], v23 offset:16384
    v_mfma_f32_16x16x32_bf16 v[108:111], v[40:43], v[228:231], v[108:111]
    ds_read_b64_tr_b16 v[58:59], v23 offset:16896
    v_mfma_f32_16x16x32_bf16 v[120:123], v[44:47], v[224:227], v[120:123]
    ds_read_b64_tr_b16 v[60:61], v25 offset:16384
    v_mfma_f32_16x16x32_bf16 v[124:127], v[44:47], v[228:231], v[124:127]
    ds_read_b64_tr_b16 v[62:63], v25 offset:16896
    s_waitcnt lgkmcnt(4)
    v_mfma_f32_16x16x32_bf16 v[64:67], v[48:51], v[192:195], v[64:67]
    ds_read_b128 v[200:203], v11 offset:0
    ds_read_b128 v[204:207], v11 offset:2048
    ds_read_b64_tr_b16 v[32:33], v22 offset:20480
    v_mfma_f32_16x16x32_bf16 v[68:71], v[48:51], v[196:199], v[68:71]
    ds_read_b64_tr_b16 v[34:35], v22 offset:20992
    v_mfma_f32_16x16x32_bf16 v[80:83], v[52:55], v[192:195], v[80:83]
    ds_read_b64_tr_b16 v[36:37], v24 offset:20480
    v_mfma_f32_16x16x32_bf16 v[84:87], v[52:55], v[196:199], v[84:87]
    ds_read_b64_tr_b16 v[38:39], v24 offset:20992
    s_waitcnt lgkmcnt(6)
    v_mfma_f32_16x16x32_bf16 v[72:75], v[56:59], v[192:195], v[72:75]
    ds_read_b64_tr_b16 v[40:41], v23 offset:20480
    v_mfma_f32_16x16x32_bf16 v[76:79], v[56:59], v[196:199], v[76:79]
    ds_read_b64_tr_b16 v[42:43], v23 offset:20992
    v_mfma_f32_16x16x32_bf16 v[88:91], v[60:63], v[192:195], v[88:91]
    ds_read_b64_tr_b16 v[44:45], v25 offset:20480
    v_mfma_f32_16x16x32_bf16 v[92:95], v[60:63], v[196:199], v[92:95]
    ds_read_b64_tr_b16 v[46:47], v25 offset:20992
    s_waitcnt lgkmcnt(4)
    v_mfma_f32_16x16x32_bf16 v[64:67], v[32:35], v[200:203], v[64:67]
    ds_read_b64_tr_b16 v[48:49], v3 offset:12288
    v_mfma_f32_16x16x32_bf16 v[68:71], v[32:35], v[204:207], v[68:71]
    ds_read_b64_tr_b16 v[50:51], v3 offset:12800
    v_mfma_f32_16x16x32_bf16 v[80:83], v[36:39], v[200:203], v[80:83]
    ds_read_b64_tr_b16 v[52:53], v5 offset:12288
    v_mfma_f32_16x16x32_bf16 v[84:87], v[36:39], v[204:207], v[84:87]
    ds_read_b64_tr_b16 v[54:55], v5 offset:12800
    s_waitcnt lgkmcnt(4)
    v_mfma_f32_16x16x32_bf16 v[72:75], v[40:43], v[200:203], v[72:75]
    s_waitcnt lgkmcnt(0)
    s_barrier
    ds_read_b128 v[208:211], v10 offset:24576
    ds_read_b128 v[212:215], v10 offset:26624
    ds_read_b64_tr_b16 v[56:57], v22 offset:40960
    v_mfma_f32_16x16x32_bf16 v[76:79], v[40:43], v[204:207], v[76:79]
    ds_read_b64_tr_b16 v[58:59], v22 offset:41472
    v_mfma_f32_16x16x32_bf16 v[88:91], v[44:47], v[200:203], v[88:91]
    ds_read_b64_tr_b16 v[60:61], v24 offset:40960
    v_mfma_f32_16x16x32_bf16 v[92:95], v[44:47], v[204:207], v[92:95]
    ds_read_b64_tr_b16 v[62:63], v24 offset:41472
    v_mfma_f32_16x16x32_bf16 v[96:99], v[48:51], v[232:235], v[96:99]
    ds_read_b64_tr_b16 v[32:33], v23 offset:40960
    v_mfma_f32_16x16x32_bf16 v[100:103], v[48:51], v[236:239], v[100:103]
    ds_read_b64_tr_b16 v[34:35], v23 offset:41472
    v_mfma_f32_16x16x32_bf16 v[112:115], v[52:55], v[232:235], v[112:115]
    ds_read_b64_tr_b16 v[36:37], v25 offset:40960
    v_mfma_f32_16x16x32_bf16 v[116:119], v[52:55], v[236:239], v[116:119]
    ds_read_b64_tr_b16 v[38:39], v25 offset:41472
    s_waitcnt lgkmcnt(4)
    v_mfma_f32_16x16x32_bf16 v[64:67], v[56:59], v[208:211], v[64:67]
    ds_read_b128 v[216:219], v11 offset:24576
    ds_read_b128 v[220:223], v11 offset:26624
    ds_read_b64_tr_b16 v[40:41], v22 offset:45056
    v_mfma_f32_16x16x32_bf16 v[68:71], v[56:59], v[212:215], v[68:71]
    ds_read_b64_tr_b16 v[42:43], v22 offset:45568
    v_mfma_f32_16x16x32_bf16 v[80:83], v[60:63], v[208:211], v[80:83]
    ds_read_b64_tr_b16 v[44:45], v24 offset:45056
    v_mfma_f32_16x16x32_bf16 v[84:87], v[60:63], v[212:215], v[84:87]
    ds_read_b64_tr_b16 v[46:47], v24 offset:45568
    s_waitcnt lgkmcnt(6)
    v_mfma_f32_16x16x32_bf16 v[72:75], v[32:35], v[208:211], v[72:75]
    ds_read_b64_tr_b16 v[48:49], v23 offset:45056
    v_mfma_f32_16x16x32_bf16 v[76:79], v[32:35], v[212:215], v[76:79]
    ds_read_b64_tr_b16 v[50:51], v23 offset:45568
    v_mfma_f32_16x16x32_bf16 v[88:91], v[36:39], v[208:211], v[88:91]
    ds_read_b64_tr_b16 v[52:53], v25 offset:45056
    v_mfma_f32_16x16x32_bf16 v[92:95], v[36:39], v[212:215], v[92:95]
    ds_read_b64_tr_b16 v[54:55], v25 offset:45568
    s_waitcnt lgkmcnt(4)
    v_mfma_f32_16x16x32_bf16 v[64:67], v[40:43], v[216:219], v[64:67]
    ds_read_b64_tr_b16 v[56:57], v4 offset:12288
    v_mfma_f32_16x16x32_bf16 v[68:71], v[40:43], v[220:223], v[68:71]
    ds_read_b64_tr_b16 v[58:59], v4 offset:12800
    v_mfma_f32_16x16x32_bf16 v[80:83], v[44:47], v[216:219], v[80:83]
    ds_read_b64_tr_b16 v[60:61], v6 offset:12288
    v_mfma_f32_16x16x32_bf16 v[84:87], v[44:47], v[220:223], v[84:87]
    ds_read_b64_tr_b16 v[62:63], v6 offset:12800
    s_waitcnt lgkmcnt(4)
    v_mfma_f32_16x16x32_bf16 v[72:75], v[48:51], v[216:219], v[72:75]
    s_waitcnt lgkmcnt(0)
    s_barrier
    ds_read_b64 v[18:19], v9
    ds_read_b128 v[224:227], v12 offset:0
    ds_read_b128 v[228:231], v12 offset:2048
    ds_read_b64_tr_b16 v[32:33], v26 offset:16384
    v_mfma_f32_16x16x32_bf16 v[76:79], v[48:51], v[220:223], v[76:79]
    ds_read_b64_tr_b16 v[34:35], v26 offset:16896
    v_mfma_f32_16x16x32_bf16 v[88:91], v[52:55], v[216:219], v[88:91]
    ds_read_b64_tr_b16 v[36:37], v28 offset:16384
    v_mfma_f32_16x16x32_bf16 v[92:95], v[52:55], v[220:223], v[92:95]
    ds_read_b64_tr_b16 v[38:39], v28 offset:16896
    v_mfma_f32_16x16x32_bf16 v[104:107], v[56:59], v[232:235], v[104:107]
    ds_read_b64_tr_b16 v[40:41], v27 offset:16384
    v_mfma_f32_16x16x32_bf16 v[108:111], v[56:59], v[236:239], v[108:111]
    ds_read_b64_tr_b16 v[42:43], v27 offset:16896
    v_mfma_f32_16x16x32_bf16 v[120:123], v[60:63], v[232:235], v[120:123]
    ds_read_b64_tr_b16 v[44:45], v29 offset:16384
    v_mfma_f32_16x16x32_bf16 v[124:127], v[60:63], v[236:239], v[124:127]
    ds_read_b64_tr_b16 v[46:47], v29 offset:16896
    s_waitcnt lgkmcnt(4)
    v_mfma_f32_16x16x32_bf16 v[64:67], v[32:35], v[224:227], v[64:67]
    ds_read_b128 v[232:235], v13 offset:0
    ds_read_b128 v[236:239], v13 offset:2048
    ds_read_b64_tr_b16 v[48:49], v26 offset:20480
    v_mfma_f32_16x16x32_bf16 v[68:71], v[32:35], v[228:231], v[68:71]
    ds_read_b64_tr_b16 v[50:51], v26 offset:20992
    v_mfma_f32_16x16x32_bf16 v[80:83], v[36:39], v[224:227], v[80:83]
    ds_read_b64_tr_b16 v[52:53], v28 offset:20480
    v_mfma_f32_16x16x32_bf16 v[84:87], v[36:39], v[228:231], v[84:87]
    ds_read_b64_tr_b16 v[54:55], v28 offset:20992
    s_waitcnt lgkmcnt(6)
    v_mfma_f32_16x16x32_bf16 v[72:75], v[40:43], v[224:227], v[72:75]
    ds_read_b64_tr_b16 v[56:57], v27 offset:20480
    v_mfma_f32_16x16x32_bf16 v[76:79], v[40:43], v[228:231], v[76:79]
    ds_read_b64_tr_b16 v[58:59], v27 offset:20992
    v_mfma_f32_16x16x32_bf16 v[88:91], v[44:47], v[224:227], v[88:91]
    ds_read_b64_tr_b16 v[60:61], v29 offset:20480
    v_mfma_f32_16x16x32_bf16 v[92:95], v[44:47], v[228:231], v[92:95]
    ds_read_b64_tr_b16 v[62:63], v29 offset:20992
    s_waitcnt lgkmcnt(4)
    v_mfma_f32_16x16x32_bf16 v[64:67], v[48:51], v[232:235], v[64:67]
    s_waitcnt lgkmcnt(0)
    s_barrier
    v_readfirstlane_b32 s32, v18
    v_readfirstlane_b32 s33, v19
    ds_read_b128 v[240:243], v12 offset:24576
    ds_read_b128 v[244:247], v12 offset:26624
    ds_read_b64_tr_b16 v[32:33], v26 offset:40960
    v_mfma_f32_16x16x32_bf16 v[68:71], v[48:51], v[236:239], v[68:71]
    ds_read_b64_tr_b16 v[34:35], v26 offset:41472
    v_mfma_f32_16x16x32_bf16 v[80:83], v[52:55], v[232:235], v[80:83]
    ds_read_b64_tr_b16 v[36:37], v28 offset:40960
    v_mfma_f32_16x16x32_bf16 v[84:87], v[52:55], v[236:239], v[84:87]
    ds_read_b64_tr_b16 v[38:39], v28 offset:41472
    v_mfma_f32_16x16x32_bf16 v[72:75], v[56:59], v[232:235], v[72:75]
    ds_read_b64_tr_b16 v[40:41], v27 offset:40960
    v_mfma_f32_16x16x32_bf16 v[76:79], v[56:59], v[236:239], v[76:79]
    ds_read_b64_tr_b16 v[42:43], v27 offset:41472
    v_mfma_f32_16x16x32_bf16 v[88:91], v[60:63], v[232:235], v[88:91]
    ds_read_b64_tr_b16 v[44:45], v29 offset:40960
    v_mfma_f32_16x16x32_bf16 v[92:95], v[60:63], v[236:239], v[92:95]
    ds_read_b64_tr_b16 v[46:47], v29 offset:41472
    s_waitcnt lgkmcnt(4)
    v_mfma_f32_16x16x32_bf16 v[64:67], v[32:35], v[240:243], v[64:67]
    ds_read_b128 v[248:251], v13 offset:24576
    ds_read_b128 v[252:255], v13 offset:26624
    ds_read_b64_tr_b16 v[48:49], v26 offset:45056
    v_mfma_f32_16x16x32_bf16 v[68:71], v[32:35], v[244:247], v[68:71]
    ds_read_b64_tr_b16 v[50:51], v26 offset:45568
    v_mfma_f32_16x16x32_bf16 v[80:83], v[36:39], v[240:243], v[80:83]
    ds_read_b64_tr_b16 v[52:53], v28 offset:45056
    v_mfma_f32_16x16x32_bf16 v[84:87], v[36:39], v[244:247], v[84:87]
    ds_read_b64_tr_b16 v[54:55], v28 offset:45568
    s_waitcnt lgkmcnt(6)
    v_mfma_f32_16x16x32_bf16 v[72:75], v[40:43], v[240:243], v[72:75]
    ds_read_b64_tr_b16 v[56:57], v27 offset:45056
    v_mfma_f32_16x16x32_bf16 v[76:79], v[40:43], v[244:247], v[76:79]
    ds_read_b64_tr_b16 v[58:59], v27 offset:45568
    v_mfma_f32_16x16x32_bf16 v[88:91], v[44:47], v[240:243], v[88:91]
    ds_read_b64_tr_b16 v[60:61], v29 offset:45056
    v_mfma_f32_16x16x32_bf16 v[92:95], v[44:47], v[244:247], v[92:95]
    ds_read_b64_tr_b16 v[62:63], v29 offset:45568
    s_waitcnt lgkmcnt(4)
    v_mfma_f32_16x16x32_bf16 v[64:67], v[48:51], v[248:251], v[64:67]
    v_mfma_f32_16x16x32_bf16 v[68:71], v[48:51], v[252:255], v[68:71]
    v_mfma_f32_16x16x32_bf16 v[80:83], v[52:55], v[248:251], v[80:83]
    v_mfma_f32_16x16x32_bf16 v[84:87], v[52:55], v[252:255], v[84:87]
    s_waitcnt lgkmcnt(0)
    v_mfma_f32_16x16x32_bf16 v[72:75], v[56:59], v[248:251], v[72:75]
    v_mfma_f32_16x16x32_bf16 v[76:79], v[56:59], v[252:255], v[76:79]
    v_mfma_f32_16x16x32_bf16 v[88:91], v[60:63], v[248:251], v[88:91]
    v_mfma_f32_16x16x32_bf16 v[92:95], v[60:63], v[252:255], v[92:95]
    s_nop 11
    v_mul_f32 v64, s39, v64
    v_mul_f32 v65, s39, v65
    v_mul_f32 v66, s39, v66
    v_mul_f32 v67, s39, v67
    v_mul_f32 v68, s39, v68
    v_mul_f32 v69, s39, v69
    v_mul_f32 v70, s39, v70
    v_mul_f32 v71, s39, v71
    v_cvt_pk_bf16_f32 v64, v64, v65
    v_cvt_pk_bf16_f32 v65, v66, v67
    v_cvt_pk_bf16_f32 v66, v68, v69
    v_cvt_pk_bf16_f32 v67, v70, v71
    s_add_u32 s42, s38, 0
    s_nop 0
    v_permlane16_swap_b32 v64, v66
    v_permlane16_swap_b32 v65, v67
    buffer_store_dwordx4 v[64:67], v14, s[16:19], s42 offen sc1
    v_mul_f32 v72, s39, v72
    v_mul_f32 v73, s39, v73
    v_mul_f32 v74, s39, v74
    v_mul_f32 v75, s39, v75
    v_mul_f32 v76, s39, v76
    v_mul_f32 v77, s39, v77
    v_mul_f32 v78, s39, v78
    v_mul_f32 v79, s39, v79
    v_cvt_pk_bf16_f32 v72, v72, v73
    v_cvt_pk_bf16_f32 v73, v74, v75
    v_cvt_pk_bf16_f32 v74, v76, v77
    v_cvt_pk_bf16_f32 v75, v78, v79
    s_add_u32 s42, s38, 65536
    s_nop 0
    v_permlane16_swap_b32 v72, v74
    v_permlane16_swap_b32 v73, v75
    buffer_store_dwordx4 v[72:75], v14, s[16:19], s42 offen sc1
    s_barrier
    ds_read_b64_tr_b16 v[32:33], v3 offset:16384
    ds_read_b64_tr_b16 v[34:35], v3 offset:16896
    ds_read_b64_tr_b16 v[36:37], v5 offset:16384
    ds_read_b64_tr_b16 v[38:39], v5 offset:16896
    ds_read_b64_tr_b16 v[40:41], v4 offset:16384
    ds_read_b64_tr_b16 v[42:43], v4 offset:16896
    ds_read_b64_tr_b16 v[44:45], v6 offset:16384
    ds_read_b64_tr_b16 v[46:47], v6 offset:16896
    s_setprio 2
    s_waitcnt lgkmcnt(4)
    v_mfma_f32_16x16x32_bf16 v[96:99], v[32:35], v[128:131], v[96:99]
    ds_read_b64_tr_b16 v[48:49], v3 offset:20480
    v_mfma_f32_16x16x32_bf16 v[100:103], v[32:35], v[132:135], v[100:103]
    ds_read_b64_tr_b16 v[50:51], v3 offset:20992
    v_mul_f32 v80, s39, v80
    v_mul_f32 v81, s39, v81
    v_mul_f32 v82, s39, v82
    v_mfma_f32_16x16x32_bf16 v[112:115], v[36:39], v[128:131], v[112:115]
    ds_read_b64_tr_b16 v[52:53], v5 offset:20480
    v_mfma_f32_16x16x32_bf16 v[116:119], v[36:39], v[132:135], v[116:119]
    ds_read_b64_tr_b16 v[54:55], v5 offset:20992
    v_mul_f32 v83, s39, v83
    v_mul_f32 v84, s39, v84
    v_mul_f32 v85, s39, v85
    s_waitcnt lgkmcnt(4)
    v_mfma_f32_16x16x32_bf16 v[104:107], v[40:43], v[128:131], v[104:107]
    ds_read_b64_tr_b16 v[56:57], v4 offset:20480
    v_mfma_f32_16x16x32_bf16 v[108:111], v[40:43], v[132:135], v[108:111]
    ds_read_b64_tr_b16 v[58:59], v4 offset:20992
    v_mul_f32 v86, s39, v86
    v_mul_f32 v87, s39, v87
    v_cvt_pk_bf16_f32 v80, v80, v81
    v_mfma_f32_16x16x32_bf16 v[120:123], v[44:47], v[128:131], v[120:123]
    ds_read_b64_tr_b16 v[60:61], v6 offset:20480
    v_mfma_f32_16x16x32_bf16 v[124:127], v[44:47], v[132:135], v[124:127]
    ds_read_b64_tr_b16 v[62:63], v6 offset:20992
    v_cvt_pk_bf16_f32 v81, v82, v83
    v_cvt_pk_bf16_f32 v82, v84, v85
    v_cvt_pk_bf16_f32 v83, v86, v87
    s_waitcnt lgkmcnt(4)
    v_mfma_f32_16x16x32_bf16 v[96:99], v[48:51], v[136:139], v[96:99]
    ds_read_b64_tr_b16 v[32:33], v3 offset:24576
    v_mfma_f32_16x16x32_bf16 v[100:103], v[48:51], v[140:143], v[100:103]
    ds_read_b64_tr_b16 v[34:35], v3 offset:25088
    s_add_u32 s42, s38, 131072
    s_nop 0
    v_permlane16_swap_b32 v80, v82
    v_permlane16_swap_b32 v81, v83
    v_mfma_f32_16x16x32_bf16 v[112:115], v[52:55], v[136:139], v[112:115]
    ds_read_b64_tr_b16 v[36:37], v5 offset:24576
    v_mfma_f32_16x16x32_bf16 v[116:119], v[52:55], v[140:143], v[116:119]
    ds_read_b64_tr_b16 v[38:39], v5 offset:25088
    buffer_store_dwordx4 v[80:83], v14, s[16:19], s42 offen sc1
    v_mul_f32 v88, s39, v88
    v_mul_f32 v89, s39, v89
    v_mul_f32 v90, s39, v90
    s_waitcnt lgkmcnt(4)
    v_mfma_f32_16x16x32_bf16 v[104:107], v[56:59], v[136:139], v[104:107]
    ds_read_b64_tr_b16 v[40:41], v4 offset:24576
    v_mfma_f32_16x16x32_bf16 v[108:111], v[56:59], v[140:143], v[108:111]
    ds_read_b64_tr_b16 v[42:43], v4 offset:25088
    v_mul_f32 v91, s39, v91
    v_mul_f32 v92, s39, v92
    v_mul_f32 v93, s39, v93
    v_mfma_f32_16x16x32_bf16 v[120:123], v[60:63], v[136:139], v[120:123]
    ds_read_b64_tr_b16 v[44:45], v6 offset:24576
    v_mfma_f32_16x16x32_bf16 v[124:127], v[60:63], v[140:143], v[124:127]
    ds_read_b64_tr_b16 v[46:47], v6 offset:25088
    v_mul_f32 v94, s39, v94
    v_mul_f32 v95, s39, v95
    v_cvt_pk_bf16_f32 v88, v88, v89
    s_waitcnt lgkmcnt(4)
    v_mfma_f32_16x16x32_bf16 v[96:99], v[32:35], v[144:147], v[96:99]
    ds_read_b64_tr_b16 v[48:49], v3 offset:28672
    v_mfma_f32_16x16x32_bf16 v[100:103], v[32:35], v[148:151], v[100:103]
    ds_read_b64_tr_b16 v[50:51], v3 offset:29184
    v_cvt_pk_bf16_f32 v89, v90, v91
    v_cvt_pk_bf16_f32 v90, v92, v93
    v_cvt_pk_bf16_f32 v91, v94, v95
    v_mfma_f32_16x16x32_bf16 v[112:115], v[36:39], v[144:147], v[112:115]
    ds_read_b64_tr_b16 v[52:53], v5 offset:28672
    v_mfma_f32_16x16x32_bf16 v[116:119], v[36:39], v[148:151], v[116:119]
    ds_read_b64_tr_b16 v[54:55], v5 offset:29184
    s_add_u32 s42, s38, 196608
    s_nop 0
    v_permlane16_swap_b32 v88, v90
    v_permlane16_swap_b32 v89, v91
    s_waitcnt lgkmcnt(4)
    v_mfma_f32_16x16x32_bf16 v[104:107], v[40:43], v[144:147], v[104:107]
    ds_read_b64_tr_b16 v[56:57], v4 offset:28672
    v_mfma_f32_16x16x32_bf16 v[108:111], v[40:43], v[148:151], v[108:111]
    ds_read_b64_tr_b16 v[58:59], v4 offset:29184
    buffer_store_dwordx4 v[88:91], v14, s[16:19], s42 offen sc1
    v_mfma_f32_16x16x32_bf16 v[120:123], v[44:47], v[144:147], v[120:123]
    ds_read_b64_tr_b16 v[60:61], v6 offset:28672
    v_mfma_f32_16x16x32_bf16 v[124:127], v[44:47], v[148:151], v[124:127]
    ds_read_b64_tr_b16 v[62:63], v6 offset:29184
    s_waitcnt lgkmcnt(4)
    v_mfma_f32_16x16x32_bf16 v[96:99], v[48:51], v[152:155], v[96:99]
    ds_read_b64_tr_b16 v[32:33], v3 offset:32768
    v_mfma_f32_16x16x32_bf16 v[100:103], v[48:51], v[156:159], v[100:103]
    ds_read_b64_tr_b16 v[34:35], v3 offset:33280
    v_mfma_f32_16x16x32_bf16 v[112:115], v[52:55], v[152:155], v[112:115]
    ds_read_b64_tr_b16 v[36:37], v5 offset:32768
    v_mfma_f32_16x16x32_bf16 v[116:119], v[52:55], v[156:159], v[116:119]
    ds_read_b64_tr_b16 v[38:39], v5 offset:33280
    s_waitcnt lgkmcnt(4)
    v_mfma_f32_16x16x32_bf16 v[104:107], v[56:59], v[152:155], v[104:107]
    ds_read_b64_tr_b16 v[40:41], v4 offset:32768
    v_mfma_f32_16x16x32_bf16 v[108:111], v[56:59], v[156:159], v[108:111]
    ds_read_b64_tr_b16 v[42:43], v4 offset:33280
    v_mfma_f32_16x16x32_bf16 v[120:123], v[60:63], v[152:155], v[120:123]
    ds_read_b64_tr_b16 v[44:45], v6 offset:32768
    v_mfma_f32_16x16x32_bf16 v[124:127], v[60:63], v[156:159], v[124:127]
    ds_read_b64_tr_b16 v[46:47], v6 offset:33280
    s_waitcnt lgkmcnt(4)
    v_mfma_f32_16x16x32_bf16 v[96:99], v[32:35], v[160:163], v[96:99]
    ds_read_b64_tr_b16 v[48:49], v3 offset:36864
    v_mfma_f32_16x16x32_bf16 v[100:103], v[32:35], v[164:167], v[100:103]
    ds_read_b64_tr_b16 v[50:51], v3 offset:37376
    v_mfma_f32_16x16x32_bf16 v[112:115], v[36:39], v[160:163], v[112:115]
    ds_read_b64_tr_b16 v[52:53], v5 offset:36864
    v_mfma_f32_16x16x32_bf16 v[116:119], v[36:39], v[164:167], v[116:119]
    ds_read_b64_tr_b16 v[54:55], v5 offset:37376
    s_waitcnt lgkmcnt(4)
    v_mfma_f32_16x16x32_bf16 v[104:107], v[40:43], v[160:163], v[104:107]
    ds_read_b64_tr_b16 v[56:57], v4 offset:36864
    v_mfma_f32_16x16x32_bf16 v[108:111], v[40:43], v[164:167], v[108:111]
    ds_read_b64_tr_b16 v[58:59], v4 offset:37376
    v_mfma_f32_16x16x32_bf16 v[120:123], v[44:47], v[160:163], v[120:123]
    ds_read_b64_tr_b16 v[60:61], v6 offset:36864
    v_mfma_f32_16x16x32_bf16 v[124:127], v[44:47], v[164:167], v[124:127]
    ds_read_b64_tr_b16 v[62:63], v6 offset:37376
    s_waitcnt lgkmcnt(4)
    v_mfma_f32_16x16x32_bf16 v[96:99], v[48:51], v[168:171], v[96:99]
    ds_read_b64_tr_b16 v[32:33], v3 offset:40960
    v_mfma_f32_16x16x32_bf16 v[100:103], v[48:51], v[172:175], v[100:103]
    ds_read_b64_tr_b16 v[34:35], v3 offset:41472
    v_mfma_f32_16x16x32_bf16 v[112:115], v[52:55], v[168:171], v[112:115]
    ds_read_b64_tr_b16 v[36:37], v5 offset:40960
    v_mfma_f32_16x16x32_bf16 v[116:119], v[52:55], v[172:175], v[116:119]
    ds_read_b64_tr_b16 v[38:39], v5 offset:41472
    s_waitcnt lgkmcnt(4)
    v_mfma_f32_16x16x32_bf16 v[104:107], v[56:59], v[168:171], v[104:107]
    ds_read_b64_tr_b16 v[40:41], v4 offset:40960
    v_mfma_f32_16x16x32_bf16 v[108:111], v[56:59], v[172:175], v[108:111]
    ds_read_b64_tr_b16 v[42:43], v4 offset:41472
    v_mfma_f32_16x16x32_bf16 v[120:123], v[60:63], v[168:171], v[120:123]
    ds_read_b64_tr_b16 v[44:45], v6 offset:40960
    v_mfma_f32_16x16x32_bf16 v[124:127], v[60:63], v[172:175], v[124:127]
    ds_read_b64_tr_b16 v[46:47], v6 offset:41472
    s_waitcnt lgkmcnt(4)
    v_mfma_f32_16x16x32_bf16 v[96:99], v[32:35], v[176:179], v[96:99]
    ds_read_b64_tr_b16 v[48:49], v3 offset:45056
    v_mfma_f32_16x16x32_bf16 v[100:103], v[32:35], v[180:183], v[100:103]
    ds_read_b64_tr_b16 v[50:51], v3 offset:45568
    v_mfma_f32_16x16x32_bf16 v[112:115], v[36:39], v[176:179], v[112:115]
    ds_read_b64_tr_b16 v[52:53], v5 offset:45056
    v_mfma_f32_16x16x32_bf16 v[116:119], v[36:39], v[180:183], v[116:119]
    ds_read_b64_tr_b16 v[54:55], v5 offset:45568
    s_waitcnt lgkmcnt(4)
    v_mfma_f32_16x16x32_bf16 v[104:107], v[40:43], v[176:179], v[104:107]
    ds_read_b64_tr_b16 v[56:57], v4 offset:45056
    v_mfma_f32_16x16x32_bf16 v[108:111], v[40:43], v[180:183], v[108:111]
    ds_read_b64_tr_b16 v[58:59], v4 offset:45568
    v_mfma_f32_16x16x32_bf16 v[120:123], v[44:47], v[176:179], v[120:123]
    ds_read_b64_tr_b16 v[60:61], v6 offset:45056
    v_mfma_f32_16x16x32_bf16 v[124:127], v[44:47], v[180:183], v[124:127]
    ds_read_b64_tr_b16 v[62:63], v6 offset:45568
    s_waitcnt lgkmcnt(4)
    v_mfma_f32_16x16x32_bf16 v[96:99], v[48:51], v[184:187], v[96:99]
    s_barrier
    ds_read_b64_tr_b16 v[32:33], v3 offset:49152
    v_mfma_f32_16x16x32_bf16 v[100:103], v[48:51], v[188:191], v[100:103]
    ds_read_b64_tr_b16 v[34:35], v3 offset:49664
    v_mfma_f32_16x16x32_bf16 v[112:115], v[52:55], v[184:187], v[112:115]
    ds_read_b64_tr_b16 v[36:37], v4 offset:49152
    v_mfma_f32_16x16x32_bf16 v[116:119], v[52:55], v[188:191], v[116:119]
    ds_read_b64_tr_b16 v[38:39], v4 offset:49664
    s_waitcnt lgkmcnt(4)
    v_mfma_f32_16x16x32_bf16 v[104:107], v[56:59], v[184:187], v[104:107]
    ds_read_b64_tr_b16 v[40:41], v3 offset:53248
    v_mfma_f32_16x16x32_bf16 v[108:111], v[56:59], v[188:191], v[108:111]
    ds_read_b64_tr_b16 v[42:43], v3 offset:53760
    v_mfma_f32_16x16x32_bf16 v[120:123], v[60:63], v[184:187], v[120:123]
    ds_read_b64_tr_b16 v[44:45], v4 offset:53248
    v_mfma_f32_16x16x32_bf16 v[124:127], v[60:63], v[188:191], v[124:127]
    ds_read_b64_tr_b16 v[46:47], v4 offset:53760
    s_waitcnt lgkmcnt(4)
    v_mfma_f32_16x16x32_bf16 v[96:99], v[32:35], v[192:195], v[96:99]
    ds_read_b64_tr_b16 v[48:49], v22 offset:0
    v_mfma_f32_16x16x32_bf16 v[100:103], v[32:35], v[196:199], v[100:103]
    ds_read_b64_tr_b16 v[50:51], v22 offset:512
    v_mfma_f32_16x16x32_bf16 v[104:107], v[36:39], v[192:195], v[104:107]
    ds_read_b64_tr_b16 v[52:53], v23 offset:0
    v_mfma_f32_16x16x32_bf16 v[108:111], v[36:39], v[196:199], v[108:111]
    ds_read_b64_tr_b16 v[54:55], v23 offset:512
    s_waitcnt lgkmcnt(4)
    v_mfma_f32_16x16x32_bf16 v[96:99], v[40:43], v[200:203], v[96:99]
    ds_read_b64_tr_b16 v[56:57], v22 offset:4096
    v_mfma_f32_16x16x32_bf16 v[100:103], v[40:43], v[204:207], v[100:103]
    ds_read_b64_tr_b16 v[58:59], v22 offset:4608
    v_mfma_f32_16x16x32_bf16 v[104:107], v[44:47], v[200:203], v[104:107]
    ds_read_b64_tr_b16 v[60:61], v23 offset:4096
    v_mfma_f32_16x16x32_bf16 v[108:111], v[44:47], v[204:207], v[108:111]
    ds_read_b64_tr_b16 v[62:63], v23 offset:4608
    s_waitcnt lgkmcnt(4)
    v_mfma_f32_16x16x32_bf16 v[96:99], v[48:51], v[208:211], v[96:99]
    ds_read_b64_tr_b16 v[32:33], v3 offset:0
    v_mfma_f32_16x16x32_bf16 v[100:103], v[48:51], v[212:215], v[100:103]
    ds_read_b64_tr_b16 v[34:35], v3 offset:512
    v_mfma_f32_16x16x32_bf16 v[104:107], v[52:55], v[208:211], v[104:107]
    ds_read_b64_tr_b16 v[36:37], v4 offset:0
    v_mfma_f32_16x16x32_bf16 v[108:111], v[52:55], v[212:215], v[108:111]
    ds_read_b64_tr_b16 v[38:39], v4 offset:512
    s_waitcnt lgkmcnt(4)
    v_mfma_f32_16x16x32_bf16 v[96:99], v[56:59], v[216:219], v[96:99]
    ds_read_b64_tr_b16 v[40:41], v3 offset:4096
    v_mfma_f32_16x16x32_bf16 v[100:103], v[56:59], v[220:223], v[100:103]
    ds_read_b64_tr_b16 v[42:43], v3 offset:4608
    v_mfma_f32_16x16x32_bf16 v[104:107], v[60:63], v[216:219], v[104:107]
    ds_read_b64_tr_b16 v[44:45], v4 offset:4096
    v_mfma_f32_16x16x32_bf16 v[108:111], v[60:63], v[220:223], v[108:111]
    ds_read_b64_tr_b16 v[46:47], v4 offset:4608
    s_waitcnt lgkmcnt(4)
    v_mfma_f32_16x16x32_bf16 v[96:99], v[32:35], v[224:227], v[96:99]
    ds_read_b64_tr_b16 v[48:49], v3 offset:8192
    v_mfma_f32_16x16x32_bf16 v[100:103], v[32:35], v[228:231], v[100:103]
    ds_read_b64_tr_b16 v[50:51], v3 offset:8704
    v_mfma_f32_16x16x32_bf16 v[104:107], v[36:39], v[224:227], v[104:107]
    ds_read_b64_tr_b16 v[52:53], v4 offset:8192
    v_mfma_f32_16x16x32_bf16 v[108:111], v[36:39], v[228:231], v[108:111]
    ds_read_b64_tr_b16 v[54:55], v4 offset:8704
    s_waitcnt vmcnt(0)
    s_mov_b64 exec, 1
    ds_add_rtn_u32 v30, v20, v21 offset:0
    s_mov_b64 exec, -1
    s_waitcnt lgkmcnt(5)
    v_mfma_f32_16x16x32_bf16 v[96:99], v[40:43], v[232:235], v[96:99]
    ds_read_b64_tr_b16 v[56:57], v3 offset:12288
    v_mfma_f32_16x16x32_bf16 v[100:103], v[40:43], v[236:239], v[100:103]
    ds_read_b64_tr_b16 v[58:59], v3 offset:12800
    v_mfma_f32_16x16x32_bf16 v[104:107], v[44:47], v[232:235], v[104:107]
    ds_read_b64_tr_b16 v[60:61], v4 offset:12288
    v_mfma_f32_16x16x32_bf16 v[108:111], v[44:47], v[236:239], v[108:111]
    ds_read_b64_tr_b16 v[62:63], v4 offset:12800
    s_waitcnt lgkmcnt(5)
    v_mfma_f32_16x16x32_bf16 v[96:99], v[48:51], v[240:243], v[96:99]
    ds_read_b64_tr_b16 v[32:33], v5 offset:49152
    v_mfma_f32_16x16x32_bf16 v[100:103], v[48:51], v[244:247], v[100:103]
    ds_read_b64_tr_b16 v[34:35], v5 offset:49664
    v_mfma_f32_16x16x32_bf16 v[104:107], v[52:55], v[240:243], v[104:107]
    ds_read_b64_tr_b16 v[36:37], v6 offset:49152
    v_mfma_f32_16x16x32_bf16 v[108:111], v[52:55], v[244:247], v[108:111]
    ds_read_b64_tr_b16 v[38:39], v6 offset:49664
    s_waitcnt lgkmcnt(8)
    v_readfirstlane_b32 s40, v30
    s_cmp_lg_u32 s40, 3
    s_cbranch_scc1 L_lf_16
    v_mov_b32 v16, s32
    v_mov_b32 v17, s33
    buffer_store_dwordx2 v[16:17], v31, s[16:19], 0 offen sc1
L_lf_16:
    s_waitcnt lgkmcnt(4)
    v_mfma_f32_16x16x32_bf16 v[96:99], v[56:59], v[248:251], v[96:99]
    ds_read_b64_tr_b16 v[40:41], v5 offset:53248
    v_mfma_f32_16x16x32_bf16 v[100:103], v[56:59], v[252:255], v[100:103]
    ds_read_b64_tr_b16 v[42:43], v5 offset:53760
    v_mfma_f32_16x16x32_bf16 v[104:107], v[60:63], v[248:251], v[104:107]
    ds_read_b64_tr_b16 v[44:45], v6 offset:53248
    v_mfma_f32_16x16x32_bf16 v[108:111], v[60:63], v[252:255], v[108:111]
    ds_read_b64_tr_b16 v[46:47], v6 offset:53760
    s_waitcnt lgkmcnt(4)
    v_mfma_f32_16x16x32_bf16 v[112:115], v[32:35], v[192:195], v[112:115]
    ds_read_b64_tr_b16 v[48:49], v24 offset:0
    v_mfma_f32_16x16x32_bf16 v[116:119], v[32:35], v[196:199], v[116:119]
    ds_read_b64_tr_b16 v[50:51], v24 offset:512
    v_mfma_f32_16x16x32_bf16 v[120:123], v[36:39], v[192:195], v[120:123]
    ds_read_b64_tr_b16 v[52:53], v25 offset:0
    v_mfma_f32_16x16x32_bf16 v[124:127], v[36:39], v[196:199], v[124:127]
    ds_read_b64_tr_b16 v[54:55], v25 offset:512
    s_waitcnt lgkmcnt(4)
    v_mfma_f32_16x16x32_bf16 v[112:115], v[40:43], v[200:203], v[112:115]
    ds_read_b64_tr_b16 v[56:57], v24 offset:4096
    v_mfma_f32_16x16x32_bf16 v[116:119], v[40:43], v[204:207], v[116:119]
    ds_read_b64_tr_b16 v[58:59], v24 offset:4608
    v_mfma_f32_16x16x32_bf16 v[120:123], v[44:47], v[200:203], v[120:123]
    ds_read_b64_tr_b16 v[60:61], v25 offset:4096
    v_mfma_f32_16x16x32_bf16 v[124:127], v[44:47], v[204:207], v[124:127]
    ds_read_b64_tr_b16 v[62:63], v25 offset:4608
    v_mul_f32 v96, s39, v96
    v_mul_f32 v97, s39, v97
    v_mul_f32 v98, s39, v98
    s_waitcnt lgkmcnt(4)
    v_mfma_f32_16x16x32_bf16 v[112:115], v[48:51], v[208:211], v[112:115]
    ds_read_b64_tr_b16 v[32:33], v5 offset:0
    v_mfma_f32_16x16x32_bf16 v[116:119], v[48:51], v[212:215], v[116:119]
    ds_read_b64_tr_b16 v[34:35], v5 offset:512
    v_mul_f32 v99, s39, v99
    v_mul_f32 v100, s39, v100
    v_mul_f32 v101, s39, v101
    v_mfma_f32_16x16x32_bf16 v[120:123], v[52:55], v[208:211], v[120:123]
    ds_read_b64_tr_b16 v[36:37], v6 offset:0
    v_mfma_f32_16x16x32_bf16 v[124:127], v[52:55], v[212:215], v[124:127]
    ds_read_b64_tr_b16 v[38:39], v6 offset:512
    v_mul_f32 v102, s39, v102
    v_mul_f32 v103, s39, v103
    v_cvt_pk_bf16_f32 v96, v96, v97
    s_waitcnt lgkmcnt(4)
    v_mfma_f32_16x16x32_bf16 v[112:115], v[56:59], v[216:219], v[112:115]
    ds_read_b64_tr_b16 v[40:41], v5 offset:4096
    v_mfma_f32_16x16x32_bf16 v[116:119], v[56:59], v[220:223], v[116:119]
    ds_read_b64_tr_b16 v[42:43], v5 offset:4608
    v_cvt_pk_bf16_f32 v97, v98, v99
    v_cvt_pk_bf16_f32 v98, v100, v101
    v_cvt_pk_bf16_f32 v99, v102, v103
    v_mfma_f32_16x16x32_bf16 v[120:123], v[60:63], v[216:219], v[120:123]
    ds_read_b64_tr_b16 v[44:45], v6 offset:4096
    v_mfma_f32_16x16x32_bf16 v[124:127], v[60:63], v[220:223], v[124:127]
    ds_read_b64_tr_b16 v[46:47], v6 offset:4608
    s_add_u32 s42, s38, 1310720
    s_nop 0
    v_permlane16_swap_b32 v96, v98
    v_permlane16_swap_b32 v97, v99
    s_waitcnt lgkmcnt(4)
    v_mfma_f32_16x16x32_bf16 v[112:115], v[32:35], v[224:227], v[112:115]
    ds_read_b64_tr_b16 v[48:49], v5 offset:8192
    v_mfma_f32_16x16x32_bf16 v[116:119], v[32:35], v[228:231], v[116:119]
    ds_read_b64_tr_b16 v[50:51], v5 offset:8704
    buffer_store_dwordx4 v[96:99], v14, s[16:19], s42 offen sc1
    v_mul_f32 v104, s39, v104
    v_mul_f32 v105, s39, v105
    v_mul_f32 v106, s39, v106
    v_mfma_f32_16x16x32_bf16 v[120:123], v[36:39], v[224:227], v[120:123]
    ds_read_b64_tr_b16 v[52:53], v6 offset:8192
    v_mfma_f32_16x16x32_bf16 v[124:127], v[36:39], v[228:231], v[124:127]
    ds_read_b64_tr_b16 v[54:55], v6 offset:8704
    v_mul_f32 v107, s39, v107
    v_mul_f32 v108, s39, v108
    v_mul_f32 v109, s39, v109
    s_waitcnt lgkmcnt(4)
    v_mfma_f32_16x16x32_bf16 v[112:115], v[40:43], v[232:235], v[112:115]
    ds_read_b64_tr_b16 v[56:57], v5 offset:12288
    v_mfma_f32_16x16x32_bf16 v[116:119], v[40:43], v[236:239], v[116:119]
    ds_read_b64_tr_b16 v[58:59], v5 offset:12800
    v_mul_f32 v110, s39, v110
    v_mul_f32 v111, s39, v111
    v_cvt_pk_bf16_f32 v104, v104, v105
    v_mfma_f32_16x16x32_bf16 v[120:123], v[44:47], v[232:235], v[120:123]
    ds_read_b64_tr_b16 v[60:61], v6 offset:12288
    v_mfma_f32_16x16x32_bf16 v[124:127], v[44:47], v[236:239], v[124:127]
    ds_read_b64_tr_b16 v[62:63], v6 offset:12800
    v_cvt_pk_bf16_f32 v105, v106, v107
    v_cvt_pk_bf16_f32 v106, v108, v109
    v_cvt_pk_bf16_f32 v107, v110, v111
    s_waitcnt lgkmcnt(4)
    v_mfma_f32_16x16x32_bf16 v[112:115], v[48:51], v[240:243], v[112:115]
    v_mfma_f32_16x16x32_bf16 v[116:119], v[48:51], v[244:247], v[116:119]
    s_add_u32 s42, s38, 1376256
    s_nop 0
    v_permlane16_swap_b32 v104, v106
    v_permlane16_swap_b32 v105, v107
    v_mfma_f32_16x16x32_bf16 v[120:123], v[52:55], v[240:243], v[120:123]
    v_mfma_f32_16x16x32_bf16 v[124:127], v[52:55], v[244:247], v[124:127]
    buffer_store_dwordx4 v[104:107], v14, s[16:19], s42 offen sc1
    s_waitcnt lgkmcnt(0)
    v_mfma_f32_16x16x32_bf16 v[112:115], v[56:59], v[248:251], v[112:115]
    v_mfma_f32_16x16x32_bf16 v[116:119], v[56:59], v[252:255], v[116:119]
    v_mfma_f32_16x16x32_bf16 v[120:123], v[60:63], v[248:251], v[120:123]
    v_mfma_f32_16x16x32_bf16 v[124:127], v[60:63], v[252:255], v[124:127]
    v_mov_b32 v8, 163720
    v_mov_b32 v9, 1
    s_mov_b64 exec, 1
    ds_add_u32 v8, v9
    s_mov_b64 exec, -1
    s_nop 2
    v_mul_f32 v112, s39, v112
    v_mul_f32 v113, s39, v113
    v_mul_f32 v114, s39, v114
    v_mul_f32 v115, s39, v115
    v_mul_f32 v116, s39, v116
    v_mul_f32 v117, s39, v117
    v_mul_f32 v118, s39, v118
    v_mul_f32 v119, s39, v119
    v_cvt_pk_bf16_f32 v112, v112, v113
    v_cvt_pk_bf16_f32 v113, v114, v115
    v_cvt_pk_bf16_f32 v114, v116, v117
    v_cvt_pk_bf16_f32 v115, v118, v119
    s_add_u32 s42, s38, 1441792
    s_nop 0
    v_permlane16_swap_b32 v112, v114
    v_permlane16_swap_b32 v113, v115
    buffer_store_dwordx4 v[112:115], v14, s[16:19], s42 offen sc1
    v_mul_f32 v120, s39, v120
    v_mul_f32 v121, s39, v121
    v_mul_f32 v122, s39, v122
    v_mul_f32 v123, s39, v123
    v_mul_f32 v124, s39, v124
    v_mul_f32 v125, s39, v125
    v_mul_f32 v126, s39, v126
    v_mul_f32 v127, s39, v127
    v_cvt_pk_bf16_f32 v120, v120, v121
    v_cvt_pk_bf16_f32 v121, v122, v123
    v_cvt_pk_bf16_f32 v122, v124, v125
    v_cvt_pk_bf16_f32 v123, v126, v127
    s_add_u32 s42, s38, 1507328
    s_nop 0
    v_permlane16_swap_b32 v120, v122
    v_permlane16_swap_b32 v121, v123
    buffer_store_dwordx4 v[120:123], v14, s[16:19], s42 offen sc1
    s_setprio 0
    s_mov_b32 s96, 3
    s_branch L_SETV
L_SETR3:
    v_add_u32 v31, 131072, v31
    s_waitcnt vmcnt(0)
    s_mov_b64 exec, 1
    ds_add_rtn_u32 v30, v20, v21 offset:4
    s_mov_b64 exec, -1
    s_waitcnt lgkmcnt(0)
    v_readfirstlane_b32 s40, v30
    s_cmp_lg_u32 s40, 3
    s_cbranch_scc1 L_lf_17
    v_mov_b32 v16, s32
    v_mov_b32 v17, s33
    buffer_store_dwordx2 v[16:17], v31, s[16:19], 0 offen sc1
L_lf_17:
    s_branch L_ATT
L_A1C:
    v_lshrrev_b32 v5, 1, v3
    s_lshl_b32 s43, s34, 4
    v_add_u32 v5, s43, v5
    v_cvt_f32_u32 v11, v5
    v_lshl_add_u32 v7, v4, 7, s6
    v_cvt_f32_u32 v7, v7
    v_and_b32 v10, 1, v2
    v_cvt_f32_u32 v10, v10
    v_mul_f32 v10, 0x3e800000, v10
    v_mul_f32 v12, 0x3a000000, v11
    v_fma_f32 v12, v12, v7, v10
    v_mul_f32 v11, 0x3c000000, v11
    v_fmamk_f32 v32, v11, 0x0, v12
    v_fmamk_f32 v33, v11, 0x3f800000, v12
    v_fmamk_f32 v34, v11, 0x40000000, v12
    v_fmamk_f32 v35, v11, 0x40400000, v12
    v_fmamk_f32 v36, v11, 0x40800000, v12
    v_fmamk_f32 v37, v11, 0x40a00000, v12
    v_fmamk_f32 v38, v11, 0x40c00000, v12
    v_fmamk_f32 v39, v11, 0x40e00000, v12
    v_cos_f32 v40, v32
    v_cos_f32 v41, v33
    v_cos_f32 v42, v34
    v_cos_f32 v43, v35
    v_cos_f32 v44, v36
    v_cos_f32 v45, v37
    v_cos_f32 v46, v38
    v_cos_f32 v47, v39
    s_nop 0
    v_cvt_pk_bf16_f32 v192, v40, v41
    v_cvt_pk_bf16_f32 v193, v42, v43
    v_cvt_pk_bf16_f32 v194, v44, v45
    v_cvt_pk_bf16_f32 v195, v46, v47
    v_fmamk_f32 v32, v11, 0x41800000, v12
    v_fmamk_f32 v33, v11, 0x41880000, v12
    v_fmamk_f32 v34, v11, 0x41900000, v12
    v_fmamk_f32 v35, v11, 0x41980000, v12
    v_fmamk_f32 v36, v11, 0x41a00000, v12
    v_fmamk_f32 v37, v11, 0x41a80000, v12
    v_fmamk_f32 v38, v11, 0x41b00000, v12
    v_fmamk_f32 v39, v11, 0x41b80000, v12
    v_cos_f32 v40, v32
    v_cos_f32 v41, v33
    v_cos_f32 v42, v34
    v_cos_f32 v43, v35
    v_cos_f32 v44, v36
    v_cos_f32 v45, v37
    v_cos_f32 v46, v38
    v_cos_f32 v47, v39
    s_nop 0
    v_cvt_pk_bf16_f32 v196, v40, v41
    v_cvt_pk_bf16_f32 v197, v42, v43
    v_cvt_pk_bf16_f32 v198, v44, v45
    v_cvt_pk_bf16_f32 v199, v46, v47
    v_fmamk_f32 v32, v11, 0x42000000, v12
    v_fmamk_f32 v33, v11, 0x42040000, v12
    v_fmamk_f32 v34, v11, 0x42080000, v12
    v_fmamk_f32 v35, v11, 0x420c0000, v12
    v_fmamk_f32 v36, v11, 0x42100000, v12
    v_fmamk_f32 v37, v11, 0x42140000, v12
    v_fmamk_f32 v38, v11, 0x42180000, v12
    v_fmamk_f32 v39, v11, 0x421c0000, v12
    v_cos_f32 v40, v32
    v_cos_f32 v41, v33
    v_cos_f32 v42, v34
    v_cos_f32 v43, v35
    v_cos_f32 v44, v36
    v_cos_f32 v45, v37
    v_cos_f32 v46, v38
    v_cos_f32 v47, v39
    s_nop 0
    v_cvt_pk_bf16_f32 v200, v40, v41
    v_cvt_pk_bf16_f32 v201, v42, v43
    v_cvt_pk_bf16_f32 v202, v44, v45
    v_cvt_pk_bf16_f32 v203, v46, v47
    v_fmamk_f32 v32, v11, 0x42400000, v12
    v_fmamk_f32 v33, v11, 0x42440000, v12
    v_fmamk_f32 v34, v11, 0x42480000, v12
    v_fmamk_f32 v35, v11, 0x424c0000, v12
    v_fmamk_f32 v36, v11, 0x42500000, v12
    v_fmamk_f32 v37, v11, 0x42540000, v12
    v_fmamk_f32 v38, v11, 0x42580000, v12
    v_fmamk_f32 v39, v11, 0x425c0000, v12
    v_cos_f32 v40, v32
    v_cos_f32 v41, v33
    v_cos_f32 v42, v34
    v_cos_f32 v43, v35
    v_cos_f32 v44, v36
    v_cos_f32 v45, v37
    v_cos_f32 v46, v38
    v_cos_f32 v47, v39
    s_nop 0
    v_cvt_pk_bf16_f32 v204, v40, v41
    v_cvt_pk_bf16_f32 v205, v42, v43
    v_cvt_pk_bf16_f32 v206, v44, v45
    v_cvt_pk_bf16_f32 v207, v46, v47
    v_fmamk_f32 v32, v11, 0x42800000, v12
    v_fmamk_f32 v33, v11, 0x42820000, v12
    v_fmamk_f32 v34, v11, 0x42840000, v12
    v_fmamk_f32 v35, v11, 0x42860000, v12
    v_fmamk_f32 v36, v11, 0x42880000, v12
    v_fmamk_f32 v37, v11, 0x428a0000, v12
    v_fmamk_f32 v38, v11, 0x428c0000, v12
    v_fmamk_f32 v39, v11, 0x428e0000, v12
    v_cos_f32 v40, v32
    v_cos_f32 v41, v33
    v_cos_f32 v42, v34
    v_cos_f32 v43, v35
    v_cos_f32 v44, v36
    v_cos_f32 v45, v37
    v_cos_f32 v46, v38
    v_cos_f32 v47, v39
    s_nop 0
    v_cvt_pk_bf16_f32 v208, v40, v41
    v_cvt_pk_bf16_f32 v209, v42, v43
    v_cvt_pk_bf16_f32 v210, v44, v45
    v_cvt_pk_bf16_f32 v211, v46, v47
    v_fmamk_f32 v32, v11, 0x42a00000, v12
    v_fmamk_f32 v33, v11, 0x42a20000, v12
    v_fmamk_f32 v34, v11, 0x42a40000, v12
    v_fmamk_f32 v35, v11, 0x42a60000, v12
    v_fmamk_f32 v36, v11, 0x42a80000, v12
    v_fmamk_f32 v37, v11, 0x42aa0000, v12
    v_fmamk_f32 v38, v11, 0x42ac0000, v12
    v_fmamk_f32 v39, v11, 0x42ae0000, v12
    v_cos_f32 v40, v32
    v_cos_f32 v41, v33
    v_cos_f32 v42, v34
    v_cos_f32 v43, v35
    v_cos_f32 v44, v36
    v_cos_f32 v45, v37
    v_cos_f32 v46, v38
    v_cos_f32 v47, v39
    s_nop 0
    v_cvt_pk_bf16_f32 v212, v40, v41
    v_cvt_pk_bf16_f32 v213, v42, v43
    v_cvt_pk_bf16_f32 v214, v44, v45
    v_cvt_pk_bf16_f32 v215, v46, v47
    v_fmamk_f32 v32, v11, 0x42c00000, v12
    v_fmamk_f32 v33, v11, 0x42c20000, v12
    v_fmamk_f32 v34, v11, 0x42c40000, v12
    v_fmamk_f32 v35, v11, 0x42c60000, v12
    v_fmamk_f32 v36, v11, 0x42c80000, v12
    v_fmamk_f32 v37, v11, 0x42ca0000, v12
    v_fmamk_f32 v38, v11, 0x42cc0000, v12
    v_fmamk_f32 v39, v11, 0x42ce0000, v12
    v_cos_f32 v40, v32
    v_cos_f32 v41, v33
    v_cos_f32 v42, v34
    v_cos_f32 v43, v35
    v_cos_f32 v44, v36
    v_cos_f32 v45, v37
    v_cos_f32 v46, v38
    v_cos_f32 v47, v39
    s_nop 0
    v_cvt_pk_bf16_f32 v216, v40, v41
    v_cvt_pk_bf16_f32 v217, v42, v43
    v_cvt_pk_bf16_f32 v218, v44, v45
    v_cvt_pk_bf16_f32 v219, v46, v47
    v_fmamk_f32 v32, v11, 0x42e00000, v12
    v_fmamk_f32 v33, v11, 0x42e20000, v12
    v_fmamk_f32 v34, v11, 0x42e40000, v12
    v_fmamk_f32 v35, v11, 0x42e60000, v12
    v_fmamk_f32 v36, v11, 0x42e80000, v12
    v_fmamk_f32 v37, v11, 0x42ea0000, v12
    v_fmamk_f32 v38, v11, 0x42ec0000, v12
    v_fmamk_f32 v39, v11, 0x42ee0000, v12
    v_cos_f32 v40, v32
    v_cos_f32 v41, v33
    v_cos_f32 v42, v34
    v_cos_f32 v43, v35
    v_cos_f32 v44, v36
    v_cos_f32 v45, v37
    v_cos_f32 v46, v38
    v_cos_f32 v47, v39
    s_nop 0
    v_cvt_pk_bf16_f32 v220, v40, v41
    v_cvt_pk_bf16_f32 v221, v42, v43
    v_cvt_pk_bf16_f32 v222, v44, v45
    v_cvt_pk_bf16_f32 v223, v46, v47
    s_cmp_lg_u32 s34, 0
    s_cbranch_scc1 L_t0_18
    s_mov_b32 exec_lo, 2
    s_mov_b32 exec_hi, 2
    v_mov_b32 v192, 0xbf803f80
    v_mov_b32 v193, 0xbf803f80
    v_mov_b32 v194, 0xbf803f80
    v_mov_b32 v195, 0xbf803f80
    v_mov_b32 v196, 0xbf803f80
    v_mov_b32 v197, 0xbf803f80
    v_mov_b32 v198, 0xbf803f80
    v_mov_b32 v199, 0xbf803f80
    v_mov_b32 v200, 0xbf803f80
    v_mov_b32 v201, 0xbf803f80
    v_mov_b32 v202, 0xbf803f80
    v_mov_b32 v203, 0xbf803f80
    v_mov_b32 v204, 0xbf803f80
    v_mov_b32 v205, 0xbf803f80
    v_mov_b32 v206, 0xbf803f80
    v_mov_b32 v207, 0xbf803f80
    v_mov_b32 v208, 0xbf803f80
    v_mov_b32 v209, 0xbf803f80
    v_mov_b32 v210, 0xbf803f80
    v_mov_b32 v211, 0xbf803f80
    v_mov_b32 v212, 0xbf803f80
    v_mov_b32 v213, 0xbf803f80
    v_mov_b32 v214, 0xbf803f80
    v_mov_b32 v215, 0xbf803f80
    v_mov_b32 v216, 0xbf803f80
    v_mov_b32 v217, 0xbf803f80
    v_mov_b32 v218, 0xbf803f80
    v_mov_b32 v219, 0xbf803f80
    v_mov_b32 v220, 0xbf803f80
    v_mov_b32 v221, 0xbf803f80
    v_mov_b32 v222, 0xbf803f80
    v_mov_b32 v223, 0xbf803f80
    s_mov_b64 exec, -1
L_t0_18:
    v_lshl_add_u32 v5, v4, 1, s43
    v_mul_u32_u24 v5, 41088, v5
    v_and_b32 v6, 15, v2
    v_lshl_add_u32 v5, v6, 4, v5
    v_and_b32 v6, 16, v2
    v_mul_u32_u24 v6, 1280, v6
    s_lshl_b32 s43, s6, 8
    v_add3_u32 v12, s43, v5, v6
    v_add_u32 v16, 0, v8
    v_add_u32 v17, 0, v9
    v_add_u32 v18, 40960, v8
    v_add_u32 v19, 40960, v9
    v_add_u32 v20, 75776, v8
    v_add_u32 v21, 75776, v9
    v_add_u32 v22, 108544, v8
    v_add_u32 v23, 108544, v9
    v_mov_b32 v10, 163712
    v_mov_b32 v11, 1
    s_mov_b32 s96, 7
    s_branch L_SET
L_SETR7:
    s_waitcnt lgkmcnt(0)
    s_barrier
    ds_read_b64_tr_b16 v[32:33], v16 offset:0
    ds_read_b64_tr_b16 v[34:35], v16 offset:512
    ds_read_b64_tr_b16 v[36:37], v17 offset:0
    ds_read_b64_tr_b16 v[38:39], v17 offset:512
    ds_read_b64_tr_b16 v[40:41], v16 offset:16384
    ds_read_b64_tr_b16 v[42:43], v16 offset:16896
    ds_read_b64_tr_b16 v[44:45], v17 offset:16384
    ds_read_b64_tr_b16 v[46:47], v17 offset:16896
    ds_read_b64_tr_b16 v[48:49], v16 offset:2048
    ds_read_b64_tr_b16 v[50:51], v16 offset:2560
    s_waitcnt lgkmcnt(6)
    v_mfma_f32_32x32x16_bf16 v[64:79], v[192:195], v[32:35], 0
    ds_read_b64_tr_b16 v[52:53], v17 offset:2048
    ds_read_b64_tr_b16 v[54:55], v17 offset:2560
    v_mfma_f32_32x32x16_bf16 v[80:95], v[192:195], v[36:39], 0
    ds_read_b64_tr_b16 v[56:57], v16 offset:18432
    ds_read_b64_tr_b16 v[58:59], v16 offset:18944
    s_waitcnt lgkmcnt(6)
    v_mfma_f32_32x32x16_bf16 v[96:111], v[192:195], v[40:43], 0
    ds_read_b64_tr_b16 v[60:61], v17 offset:18432
    ds_read_b64_tr_b16 v[62:63], v17 offset:18944
    v_mfma_f32_32x32x16_bf16 v[112:127], v[192:195], v[44:47], 0
    ds_read_b64_tr_b16 v[32:33], v16 offset:4096
    ds_read_b64_tr_b16 v[34:35], v16 offset:4608
    s_waitcnt lgkmcnt(6)
    v_mfma_f32_32x32x16_bf16 v[64:79], v[196:199], v[48:51], v[64:79]
    ds_read_b64_tr_b16 v[36:37], v17 offset:4096
    ds_read_b64_tr_b16 v[38:39], v17 offset:4608
    v_mfma_f32_32x32x16_bf16 v[80:95], v[196:199], v[52:55], v[80:95]
    ds_read_b64_tr_b16 v[40:41], v16 offset:20480
    ds_read_b64_tr_b16 v[42:43], v16 offset:20992
    s_waitcnt lgkmcnt(6)
    v_mfma_f32_32x32x16_bf16 v[96:111], v[196:199], v[56:59], v[96:111]
    ds_read_b64_tr_b16 v[44:45], v17 offset:20480
    ds_read_b64_tr_b16 v[46:47], v17 offset:20992
    v_mfma_f32_32x32x16_bf16 v[112:127], v[196:199], v[60:63], v[112:127]
    ds_read_b64_tr_b16 v[48:49], v16 offset:6144
    ds_read_b64_tr_b16 v[50:51], v16 offset:6656
    s_waitcnt lgkmcnt(6)
    v_mfma_f32_32x32x16_bf16 v[64:79], v[200:203], v[32:35], v[64:79]
    ds_read_b64_tr_b16 v[52:53], v17 offset:6144
    ds_read_b64_tr_b16 v[54:55], v17 offset:6656
    v_mfma_f32_32x32x16_bf16 v[80:95], v[200:203], v[36:39], v[80:95]
    ds_read_b64_tr_b16 v[56:57], v16 offset:22528
    ds_read_b64_tr_b16 v[58:59], v16 offset:23040
    s_waitcnt lgkmcnt(6)
    v_mfma_f32_32x32x16_bf16 v[96:111], v[200:203], v[40:43], v[96:111]
    ds_read_b64_tr_b16 v[60:61], v17 offset:22528
    ds_read_b64_tr_b16 v[62:63], v17 offset:23040
    v_mfma_f32_32x32x16_bf16 v[112:127], v[200:203], v[44:47], v[112:127]
    ds_read_b64_tr_b16 v[32:33], v16 offset:8192
    ds_read_b64_tr_b16 v[34:35], v16 offset:8704
    s_waitcnt lgkmcnt(6)
    v_mfma_f32_32x32x16_bf16 v[64:79], v[204:207], v[48:51], v[64:79]
    ds_read_b64_tr_b16 v[36:37], v17 offset:8192
    ds_read_b64_tr_b16 v[38:39], v17 offset:8704
    v_mfma_f32_32x32x16_bf16 v[80:95], v[204:207], v[52:55], v[80:95]
    ds_read_b64_tr_b16 v[40:41], v16 offset:24576
    ds_read_b64_tr_b16 v[42:43], v16 offset:25088
    s_waitcnt lgkmcnt(6)
    v_mfma_f32_32x32x16_bf16 v[96:111], v[204:207], v[56:59], v[96:111]
    ds_read_b64_tr_b16 v[44:45], v17 offset:24576
    ds_read_b64_tr_b16 v[46:47], v17 offset:25088
    v_mfma_f32_32x32x16_bf16 v[112:127], v[204:207], v[60:63], v[112:127]
    ds_read_b64_tr_b16 v[48:49], v16 offset:10240
    ds_read_b64_tr_b16 v[50:51], v16 offset:10752
    s_waitcnt lgkmcnt(6)
    v_mfma_f32_32x32x16_bf16 v[64:79], v[208:211], v[32:35], v[64:79]
    ds_read_b64_tr_b16 v[52:53], v17 offset:10240
    ds_read_b64_tr_b16 v[54:55], v17 offset:10752
    v_mfma_f32_32x32x16_bf16 v[80:95], v[208:211], v[36:39], v[80:95]
    ds_read_b64_tr_b16 v[56:57], v16 offset:26624
    ds_read_b64_tr_b16 v[58:59], v16 offset:27136
    s_waitcnt lgkmcnt(6)
    v_mfma_f32_32x32x16_bf16 v[96:111], v[208:211], v[40:43], v[96:111]
    ds_read_b64_tr_b16 v[60:61], v17 offset:26624
    ds_read_b64_tr_b16 v[62:63], v17 offset:27136
    v_mfma_f32_32x32x16_bf16 v[112:127], v[208:211], v[44:47], v[112:127]
    ds_read_b64_tr_b16 v[32:33], v16 offset:12288
    ds_read_b64_tr_b16 v[34:35], v16 offset:12800
    s_waitcnt lgkmcnt(6)
    v_mfma_f32_32x32x16_bf16 v[64:79], v[212:215], v[48:51], v[64:79]
    ds_read_b64_tr_b16 v[36:37], v17 offset:12288
    ds_read_b64_tr_b16 v[38:39], v17 offset:12800
    v_mfma_f32_32x32x16_bf16 v[80:95], v[212:215], v[52:55], v[80:95]
    ds_read_b64_tr_b16 v[40:41], v16 offset:28672
    ds_read_b64_tr_b16 v[42:43], v16 offset:29184
    s_waitcnt lgkmcnt(6)
    v_mfma_f32_32x32x16_bf16 v[96:111], v[212:215], v[56:59], v[96:111]
    ds_read_b64_tr_b16 v[44:45], v17 offset:28672
    ds_read_b64_tr_b16 v[46:47], v17 offset:29184
    v_mfma_f32_32x32x16_bf16 v[112:127], v[212:215], v[60:63], v[112:127]
    ds_read_b32 v13, v10 offset:80
    ds_read_b64_tr_b16 v[48:49], v16 offset:14336
    ds_read_b64_tr_b16 v[50:51], v16 offset:14848
    s_waitcnt lgkmcnt(7)
    v_mfma_f32_32x32x16_bf16 v[64:79], v[216:219], v[32:35], v[64:79]
    ds_read_b64_tr_b16 v[52:53], v17 offset:14336
    ds_read_b64_tr_b16 v[54:55], v17 offset:14848
    v_mfma_f32_32x32x16_bf16 v[80:95], v[216:219], v[36:39], v[80:95]
    ds_read_b64_tr_b16 v[56:57], v16 offset:30720
    ds_read_b64_tr_b16 v[58:59], v16 offset:31232
    s_waitcnt lgkmcnt(7)
    v_mfma_f32_32x32x16_bf16 v[96:111], v[216:219], v[40:43], v[96:111]
    ds_read_b64_tr_b16 v[60:61], v17 offset:30720
    ds_read_b64_tr_b16 v[62:63], v17 offset:31232
    v_mfma_f32_32x32x16_bf16 v[112:127], v[216:219], v[44:47], v[112:127]
    s_waitcnt lgkmcnt(8)
    v_readfirstlane_b32 s40, v13
    s_cmp_ge_u32 s40, 4
    s_cbranch_scc1 L_ld_19
    v_mov_b32 v26, 163792
    s_mov_b32 s60, 0
L_lw_20:
    ds_read_b32 v27, v26
    s_add_u32 s60, s60, 1
    s_waitcnt lgkmcnt(0)
    v_readfirstlane_b32 s40, v27
    s_cmp_gt_u32 s60, 1600000
    s_cbranch_scc1 L_lwd_21
    s_cmp_lt_u32 s40, 4
    s_cbranch_scc1 L_lw_20
L_lwd_21:
L_ld_19:
    ds_read_b64_tr_b16 v[32:33], v18 offset:0
    ds_read_b64_tr_b16 v[34:35], v18 offset:512
    s_waitcnt lgkmcnt(6)
    v_mfma_f32_32x32x16_bf16 v[64:79], v[220:223], v[48:51], v[64:79]
    ds_read_b64_tr_b16 v[36:37], v19 offset:0
    ds_read_b64_tr_b16 v[38:39], v19 offset:512
    v_mfma_f32_32x32x16_bf16 v[80:95], v[220:223], v[52:55], v[80:95]
    ds_read_b64_tr_b16 v[40:41], v18 offset:16384
    ds_read_b64_tr_b16 v[42:43], v18 offset:16896
    s_waitcnt lgkmcnt(6)
    v_mfma_f32_32x32x16_bf16 v[96:111], v[220:223], v[56:59], v[96:111]
    ds_read_b64_tr_b16 v[44:45], v19 offset:16384
    ds_read_b64_tr_b16 v[46:47], v19 offset:16896
    v_mfma_f32_32x32x16_bf16 v[112:127], v[220:223], v[60:63], v[112:127]
    ds_read_b64_tr_b16 v[48:49], v18 offset:2048
    ds_read_b64_tr_b16 v[50:51], v18 offset:2560
    s_waitcnt lgkmcnt(6)
    v_mfma_f32_32x32x16_bf16 v[128:143], v[192:195], v[32:35], 0
    ds_read_b64_tr_b16 v[52:53], v19 offset:2048
    ds_read_b64_tr_b16 v[54:55], v19 offset:2560
    v_mfma_f32_32x32x16_bf16 v[144:159], v[192:195], v[36:39], 0
    ds_read_b64_tr_b16 v[56:57], v18 offset:18432
    ds_read_b64_tr_b16 v[58:59], v18 offset:18944
    s_waitcnt lgkmcnt(6)
    v_mfma_f32_32x32x16_bf16 v[160:175], v[192:195], v[40:43], 0
    ds_read_b64_tr_b16 v[60:61], v19 offset:18432
    ds_read_b64_tr_b16 v[62:63], v19 offset:18944
    v_mfma_f32_32x32x16_bf16 v[176:191], v[192:195], v[44:47], 0
    ds_read_b64_tr_b16 v[32:33], v18 offset:4096
    ds_read_b64_tr_b16 v[34:35], v18 offset:4608
    v_add_f32 v28, v64, v96
    v_sub_f32 v96, v64, v96
    v_add_f32 v29, v65, v97
    v_sub_f32 v97, v65, v97
    s_waitcnt lgkmcnt(6)
    v_mfma_f32_32x32x16_bf16 v[128:143], v[196:199], v[48:51], v[128:143]
    ds_read_b64_tr_b16 v[36:37], v19 offset:4096
    ds_read_b64_tr_b16 v[38:39], v19 offset:4608
    v_cvt_pk_bf16_f32 v224, v28, v29
    v_cvt_pk_bf16_f32 v226, v96, v97
    v_add_f32 v30, v80, v112
    v_sub_f32 v112, v80, v112
    v_add_f32 v31, v81, v113
    v_mfma_f32_32x32x16_bf16 v[144:159], v[196:199], v[52:55], v[144:159]
    ds_read_b64_tr_b16 v[40:41], v18 offset:20480
    ds_read_b64_tr_b16 v[42:43], v18 offset:20992
    v_sub_f32 v113, v81, v113
    v_cvt_pk_bf16_f32 v225, v30, v31
    v_cvt_pk_bf16_f32 v227, v112, v113
    v_add_f32 v28, v66, v98
    s_waitcnt lgkmcnt(6)
    v_mfma_f32_32x32x16_bf16 v[160:175], v[196:199], v[56:59], v[160:175]
    ds_read_b64_tr_b16 v[44:45], v19 offset:20480
    ds_read_b64_tr_b16 v[46:47], v19 offset:20992
    v_sub_f32 v98, v66, v98
    v_add_f32 v29, v67, v99
    v_sub_f32 v99, v67, v99
    v_permlane16_swap_b32 v224, v226
    v_mfma_f32_32x32x16_bf16 v[176:191], v[196:199], v[60:63], v[176:191]
    ds_read_b64_tr_b16 v[48:49], v18 offset:6144
    ds_read_b64_tr_b16 v[50:51], v18 offset:6656
    v_permlane16_swap_b32 v225, v227
    v_cvt_pk_bf16_f32 v228, v28, v29
    v_cvt_pk_bf16_f32 v230, v98, v99
    s_waitcnt lgkmcnt(6)
    v_mfma_f32_32x32x16_bf16 v[128:143], v[200:203], v[32:35], v[128:143]
    ds_read_b64_tr_b16 v[52:53], v19 offset:6144
    ds_read_b64_tr_b16 v[54:55], v19 offset:6656
    s_mov_b32 s42, 11534336
    buffer_store_dwordx4 v[224:227], v12, s[16:19], s42 offen sc1
    v_add_f32 v30, v82, v114
    v_sub_f32 v114, v82, v114
    v_add_f32 v31, v83, v115
    v_sub_f32 v115, v83, v115
    v_cvt_pk_bf16_f32 v229, v30, v31
    v_mfma_f32_32x32x16_bf16 v[144:159], v[200:203], v[36:39], v[144:159]
    ds_read_b64_tr_b16 v[56:57], v18 offset:22528
    ds_read_b64_tr_b16 v[58:59], v18 offset:23040
    v_cvt_pk_bf16_f32 v231, v114, v115
    v_add_f32 v28, v68, v100
    v_sub_f32 v100, v68, v100
    v_add_f32 v29, v69, v101
    s_waitcnt lgkmcnt(6)
    v_mfma_f32_32x32x16_bf16 v[160:175], v[200:203], v[40:43], v[160:175]
    ds_read_b64_tr_b16 v[60:61], v19 offset:22528
    ds_read_b64_tr_b16 v[62:63], v19 offset:23040
    v_sub_f32 v101, v69, v101
    v_permlane16_swap_b32 v228, v230
    v_permlane16_swap_b32 v229, v231
    v_mfma_f32_32x32x16_bf16 v[176:191], v[200:203], v[44:47], v[176:191]
    ds_read_b64_tr_b16 v[32:33], v18 offset:8192
    ds_read_b64_tr_b16 v[34:35], v18 offset:8704
    s_mov_b32 s42, 11575424
    buffer_store_dwordx4 v[228:231], v12, s[16:19], s42 offen sc1
    v_cvt_pk_bf16_f32 v232, v28, v29
    v_cvt_pk_bf16_f32 v234, v100, v101
    v_add_f32 v30, v84, v116
    v_sub_f32 v116, v84, v116
    s_waitcnt lgkmcnt(6)
    v_mfma_f32_32x32x16_bf16 v[128:143], v[204:207], v[48:51], v[128:143]
    ds_read_b64_tr_b16 v[36:37], v19 offset:8192
    ds_read_b64_tr_b16 v[38:39], v19 offset:8704
    v_add_f32 v31, v85, v117
    v_sub_f32 v117, v85, v117
    v_cvt_pk_bf16_f32 v233, v30, v31
    v_cvt_pk_bf16_f32 v235, v116, v117
    v_add_f32 v28, v70, v102
    v_mfma_f32_32x32x16_bf16 v[144:159], v[204:207], v[52:55], v[144:159]
    ds_read_b64_tr_b16 v[40:41], v18 offset:24576
    ds_read_b64_tr_b16 v[42:43], v18 offset:25088
    v_sub_f32 v102, v70, v102
    v_add_f32 v29, v71, v103
    v_sub_f32 v103, v71, v103
    v_permlane16_swap_b32 v232, v234
    s_waitcnt lgkmcnt(6)
    v_mfma_f32_32x32x16_bf16 v[160:175], v[204:207], v[56:59], v[160:175]
    ds_read_b64_tr_b16 v[44:45], v19 offset:24576
    ds_read_b64_tr_b16 v[46:47], v19 offset:25088
    v_permlane16_swap_b32 v233, v235
    v_cvt_pk_bf16_f32 v236, v28, v29
    v_cvt_pk_bf16_f32 v238, v102, v103
    v_mfma_f32_32x32x16_bf16 v[176:191], v[204:207], v[60:63], v[176:191]
    ds_read_b64_tr_b16 v[48:49], v18 offset:10240
    ds_read_b64_tr_b16 v[50:51], v18 offset:10752
    s_mov_b32 s42, 11698688
    buffer_store_dwordx4 v[232:235], v12, s[16:19], s42 offen sc1
    v_add_f32 v30, v86, v118
    v_sub_f32 v118, v86, v118
    v_add_f32 v31, v87, v119
    v_sub_f32 v119, v87, v119
    s_waitcnt lgkmcnt(6)
    v_mfma_f32_32x32x16_bf16 v[128:143], v[208:211], v[32:35], v[128:143]
    ds_read_b64_tr_b16 v[52:53], v19 offset:10240
    ds_read_b64_tr_b16 v[54:55], v19 offset:10752
    v_cvt_pk_bf16_f32 v237, v30, v31
    v_cvt_pk_bf16_f32 v239, v118, v119
    v_add_f32 v28, v72, v104
    v_sub_f32 v104, v72, v104
    v_add_f32 v29, v73, v105
    v_mfma_f32_32x32x16_bf16 v[144:159], v[208:211], v[36:39], v[144:159]
    ds_read_b64_tr_b16 v[56:57], v18 offset:26624
    ds_read_b64_tr_b16 v[58:59], v18 offset:27136
    v_sub_f32 v105, v73, v105
    v_permlane16_swap_b32 v236, v238
    v_permlane16_swap_b32 v237, v239
    s_waitcnt lgkmcnt(6)
    v_mfma_f32_32x32x16_bf16 v[160:175], v[208:211], v[40:43], v[160:175]
    ds_read_b64_tr_b16 v[60:61], v19 offset:26624
    ds_read_b64_tr_b16 v[62:63], v19 offset:27136
    s_mov_b32 s42, 11739776
    buffer_store_dwordx4 v[236:239], v12, s[16:19], s42 offen sc1
    v_cvt_pk_bf16_f32 v240, v28, v29
    v_cvt_pk_bf16_f32 v242, v104, v105
    v_add_f32 v30, v88, v120
    v_sub_f32 v120, v88, v120
    v_mfma_f32_32x32x16_bf16 v[176:191], v[208:211], v[44:47], v[176:191]
    ds_read_b64_tr_b16 v[32:33], v18 offset:12288
    ds_read_b64_tr_b16 v[34:35], v18 offset:12800
    v_add_f32 v31, v89, v121
    v_sub_f32 v121, v89, v121
    v_cvt_pk_bf16_f32 v241, v30, v31
    v_cvt_pk_bf16_f32 v243, v120, v121
    s_waitcnt lgkmcnt(6)
    v_mfma_f32_32x32x16_bf16 v[128:143], v[212:215], v[48:51], v[128:143]
    ds_read_b64_tr_b16 v[36:37], v19 offset:12288
    ds_read_b64_tr_b16 v[38:39], v19 offset:12800
    v_add_f32 v28, v74, v106
    v_sub_f32 v106, v74, v106
    v_add_f32 v29, v75, v107
    v_sub_f32 v107, v75, v107
    v_permlane16_swap_b32 v240, v242
    v_mfma_f32_32x32x16_bf16 v[144:159], v[212:215], v[52:55], v[144:159]
    ds_read_b64_tr_b16 v[40:41], v18 offset:28672
    ds_read_b64_tr_b16 v[42:43], v18 offset:29184
    v_permlane16_swap_b32 v241, v243
    v_cvt_pk_bf16_f32 v244, v28, v29
    v_cvt_pk_bf16_f32 v246, v106, v107
    s_waitcnt lgkmcnt(6)
    v_mfma_f32_32x32x16_bf16 v[160:175], v[212:215], v[56:59], v[160:175]
    ds_read_b64_tr_b16 v[44:45], v19 offset:28672
    ds_read_b64_tr_b16 v[46:47], v19 offset:29184
    s_mov_b32 s42, 11863040
    buffer_store_dwordx4 v[240:243], v12, s[16:19], s42 offen sc1
    v_add_f32 v30, v90, v122
    v_sub_f32 v122, v90, v122
    v_add_f32 v31, v91, v123
    v_sub_f32 v123, v91, v123
    v_mfma_f32_32x32x16_bf16 v[176:191], v[212:215], v[60:63], v[176:191]
    ds_read_b32 v13, v10 offset:84
    ds_read_b64_tr_b16 v[48:49], v18 offset:14336
    ds_read_b64_tr_b16 v[50:51], v18 offset:14848
    v_cvt_pk_bf16_f32 v245, v30, v31
    v_cvt_pk_bf16_f32 v247, v122, v123
    v_add_f32 v28, v76, v108
    v_sub_f32 v108, v76, v108
    s_waitcnt lgkmcnt(7)
    v_mfma_f32_32x32x16_bf16 v[128:143], v[216:219], v[32:35], v[128:143]
    ds_read_b64_tr_b16 v[52:53], v19 offset:14336
    ds_read_b64_tr_b16 v[54:55], v19 offset:14848
    v_add_f32 v29, v77, v109
    v_sub_f32 v109, v77, v109
    v_permlane16_swap_b32 v244, v246
    v_permlane16_swap_b32 v245, v247
    v_mfma_f32_32x32x16_bf16 v[144:159], v[216:219], v[36:39], v[144:159]
    ds_read_b64_tr_b16 v[56:57], v18 offset:30720
    ds_read_b64_tr_b16 v[58:59], v18 offset:31232
    s_mov_b32 s42, 11904128
    buffer_store_dwordx4 v[244:247], v12, s[16:19], s42 offen sc1
    v_cvt_pk_bf16_f32 v248, v28, v29
    v_cvt_pk_bf16_f32 v250, v108, v109
    v_add_f32 v30, v92, v124
    v_sub_f32 v124, v92, v124
    s_waitcnt lgkmcnt(7)
    v_mfma_f32_32x32x16_bf16 v[160:175], v[216:219], v[40:43], v[160:175]
    ds_read_b64_tr_b16 v[60:61], v19 offset:30720
    ds_read_b64_tr_b16 v[62:63], v19 offset:31232
    v_add_f32 v31, v93, v125
    v_sub_f32 v125, v93, v125
    v_cvt_pk_bf16_f32 v249, v30, v31
    v_cvt_pk_bf16_f32 v251, v124, v125
    v_mfma_f32_32x32x16_bf16 v[176:191], v[216:219], v[44:47], v[176:191]
    s_waitcnt lgkmcnt(8)
    v_readfirstlane_b32 s40, v13
    s_cmp_ge_u32 s40, 4
    s_cbranch_scc1 L_ld_22
    v_mov_b32 v26, 163796
    s_mov_b32 s60, 0
L_lw_23:
    ds_read_b32 v27, v26
    s_add_u32 s60, s60, 1
    s_waitcnt lgkmcnt(0)
    v_readfirstlane_b32 s40, v27
    s_cmp_gt_u32 s60, 1600000
    s_cbranch_scc1 L_lwd_24
    s_cmp_lt_u32 s40, 4
    s_cbranch_scc1 L_lw_23
L_lwd_24:
L_ld_22:
    s_mov_b64 exec, 1
    ds_add_u32 v10, v11 offset:8
    s_mov_b64 exec, -1
    ds_read_b64_tr_b16 v[32:33], v20 offset:0
    ds_read_b64_tr_b16 v[34:35], v20 offset:512
    v_add_f32 v28, v78, v110
    v_sub_f32 v110, v78, v110
    v_add_f32 v29, v79, v111
    v_sub_f32 v111, v79, v111
    s_waitcnt lgkmcnt(7)
    v_mfma_f32_32x32x16_bf16 v[128:143], v[220:223], v[48:51], v[128:143]
    ds_read_b64_tr_b16 v[36:37], v21 offset:0
    ds_read_b64_tr_b16 v[38:39], v21 offset:512
    v_permlane16_swap_b32 v248, v250
    v_permlane16_swap_b32 v249, v251
    v_cvt_pk_bf16_f32 v252, v28, v29
    v_cvt_pk_bf16_f32 v254, v110, v111
    v_mfma_f32_32x32x16_bf16 v[144:159], v[220:223], v[52:55], v[144:159]
    ds_read_b64_tr_b16 v[40:41], v20 offset:16384
    ds_read_b64_tr_b16 v[42:43], v20 offset:16896
    s_mov_b32 s42, 12027392
    buffer_store_dwordx4 v[248:251], v12, s[16:19], s42 offen sc1
    v_add_f32 v30, v94, v126
    v_sub_f32 v126, v94, v126
    v_add_f32 v31, v95, v127
    v_sub_f32 v127, v95, v127
    s_waitcnt lgkmcnt(7)
    v_mfma_f32_32x32x16_bf16 v[160:175], v[220:223], v[56:59], v[160:175]
    ds_read_b64_tr_b16 v[44:45], v21 offset:16384
    ds_read_b64_tr_b16 v[46:47], v21 offset:16896
    v_cvt_pk_bf16_f32 v253, v30, v31
    v_cvt_pk_bf16_f32 v255, v126, v127
    s_nop 1
    v_permlane16_swap_b32 v252, v254
    v_mfma_f32_32x32x16_bf16 v[176:191], v[220:223], v[60:63], v[176:191]
    ds_read_b64_tr_b16 v[48:49], v20 offset:2048
    ds_read_b64_tr_b16 v[50:51], v20 offset:2560
    v_permlane16_swap_b32 v253, v255
    s_waitcnt lgkmcnt(6)
    v_mfma_f32_32x32x16_bf16 v[64:79], v[192:195], v[32:35], 0
    ds_read_b64_tr_b16 v[52:53], v21 offset:2048
    ds_read_b64_tr_b16 v[54:55], v21 offset:2560
    s_mov_b32 s42, 12068480
    buffer_store_dwordx4 v[252:255], v12, s[16:19], s42 offen sc1
    v_mfma_f32_32x32x16_bf16 v[80:95], v[192:195], v[36:39], 0
    ds_read_b64_tr_b16 v[56:57], v20 offset:18432
    ds_read_b64_tr_b16 v[58:59], v20 offset:18944
    s_waitcnt lgkmcnt(6)
    v_mfma_f32_32x32x16_bf16 v[96:111], v[192:195], v[40:43], 0
    ds_read_b64_tr_b16 v[60:61], v21 offset:18432
    ds_read_b64_tr_b16 v[62:63], v21 offset:18944
    v_mfma_f32_32x32x16_bf16 v[112:127], v[192:195], v[44:47], 0
    ds_read_b64_tr_b16 v[32:33], v20 offset:4096
    ds_read_b64_tr_b16 v[34:35], v20 offset:4608
    v_add_f32 v28, v128, v160
    v_sub_f32 v160, v128, v160
    v_add_f32 v29, v129, v161
    v_sub_f32 v161, v129, v161
    s_waitcnt lgkmcnt(6)
    v_mfma_f32_32x32x16_bf16 v[64:79], v[196:199], v[48:51], v[64:79]
    ds_read_b64_tr_b16 v[36:37], v21 offset:4096
    ds_read_b64_tr_b16 v[38:39], v21 offset:4608
    v_cvt_pk_bf16_f32 v224, v28, v29
    v_cvt_pk_bf16_f32 v226, v160, v161
    v_add_f32 v30, v144, v176
    v_sub_f32 v176, v144, v176
    v_add_f32 v31, v145, v177
    v_mfma_f32_32x32x16_bf16 v[80:95], v[196:199], v[52:55], v[80:95]
    ds_read_b64_tr_b16 v[40:41], v20 offset:20480
    ds_read_b64_tr_b16 v[42:43], v20 offset:20992
    v_sub_f32 v177, v145, v177
    v_cvt_pk_bf16_f32 v225, v30, v31
    v_cvt_pk_bf16_f32 v227, v176, v177
    v_add_f32 v28, v130, v162
    s_waitcnt lgkmcnt(6)
    v_mfma_f32_32x32x16_bf16 v[96:111], v[196:199], v[56:59], v[96:111]
    ds_read_b64_tr_b16 v[44:45], v21 offset:20480
    ds_read_b64_tr_b16 v[46:47], v21 offset:20992
    v_sub_f32 v162, v130, v162
    v_add_f32 v29, v131, v163
    v_sub_f32 v163, v131, v163
    v_permlane16_swap_b32 v224, v226
    v_mfma_f32_32x32x16_bf16 v[112:127], v[196:199], v[60:63], v[112:127]
    ds_read_b64_tr_b16 v[48:49], v20 offset:6144
    ds_read_b64_tr_b16 v[50:51], v20 offset:6656
    v_permlane16_swap_b32 v225, v227
    v_cvt_pk_bf16_f32 v228, v28, v29
    v_cvt_pk_bf16_f32 v230, v162, v163
    s_waitcnt lgkmcnt(6)
    v_mfma_f32_32x32x16_bf16 v[64:79], v[200:203], v[32:35], v[64:79]
    ds_read_b64_tr_b16 v[52:53], v21 offset:6144
    ds_read_b64_tr_b16 v[54:55], v21 offset:6656
    s_mov_b32 s42, 11538432
    buffer_store_dwordx4 v[224:227], v12, s[16:19], s42 offen sc1
    v_add_f32 v30, v146, v178
    v_sub_f32 v178, v146, v178
    v_add_f32 v31, v147, v179
    v_sub_f32 v179, v147, v179
    v_cvt_pk_bf16_f32 v229, v30, v31
    v_mfma_f32_32x32x16_bf16 v[80:95], v[200:203], v[36:39], v[80:95]
    ds_read_b64_tr_b16 v[56:57], v20 offset:22528
    ds_read_b64_tr_b16 v[58:59], v20 offset:23040
    v_cvt_pk_bf16_f32 v231, v178, v179
    v_add_f32 v28, v132, v164
    v_sub_f32 v164, v132, v164
    v_add_f32 v29, v133, v165
    s_waitcnt lgkmcnt(6)
    v_mfma_f32_32x32x16_bf16 v[96:111], v[200:203], v[40:43], v[96:111]
    ds_read_b64_tr_b16 v[60:61], v21 offset:22528
    ds_read_b64_tr_b16 v[62:63], v21 offset:23040
    v_sub_f32 v165, v133, v165
    v_permlane16_swap_b32 v228, v230
    v_permlane16_swap_b32 v229, v231
    v_mfma_f32_32x32x16_bf16 v[112:127], v[200:203], v[44:47], v[112:127]
    ds_read_b64_tr_b16 v[32:33], v20 offset:8192
    ds_read_b64_tr_b16 v[34:35], v20 offset:8704
    s_mov_b32 s42, 11579520
    buffer_store_dwordx4 v[228:231], v12, s[16:19], s42 offen sc1
    v_cvt_pk_bf16_f32 v232, v28, v29
    v_cvt_pk_bf16_f32 v234, v164, v165
    v_add_f32 v30, v148, v180
    v_sub_f32 v180, v148, v180
    s_waitcnt lgkmcnt(6)
    v_mfma_f32_32x32x16_bf16 v[64:79], v[204:207], v[48:51], v[64:79]
    ds_read_b64_tr_b16 v[36:37], v21 offset:8192
    ds_read_b64_tr_b16 v[38:39], v21 offset:8704
    v_add_f32 v31, v149, v181
    v_sub_f32 v181, v149, v181
    v_cvt_pk_bf16_f32 v233, v30, v31
    v_cvt_pk_bf16_f32 v235, v180, v181
    v_add_f32 v28, v134, v166
    v_mfma_f32_32x32x16_bf16 v[80:95], v[204:207], v[52:55], v[80:95]
    ds_read_b64_tr_b16 v[40:41], v20 offset:24576
    ds_read_b64_tr_b16 v[42:43], v20 offset:25088
    v_sub_f32 v166, v134, v166
    v_add_f32 v29, v135, v167
    v_sub_f32 v167, v135, v167
    v_permlane16_swap_b32 v232, v234
    s_waitcnt lgkmcnt(6)
    v_mfma_f32_32x32x16_bf16 v[96:111], v[204:207], v[56:59], v[96:111]
    ds_read_b64_tr_b16 v[44:45], v21 offset:24576
    ds_read_b64_tr_b16 v[46:47], v21 offset:25088
    v_permlane16_swap_b32 v233, v235
    v_cvt_pk_bf16_f32 v236, v28, v29
    v_cvt_pk_bf16_f32 v238, v166, v167
    v_mfma_f32_32x32x16_bf16 v[112:127], v[204:207], v[60:63], v[112:127]
    ds_read_b64_tr_b16 v[48:49], v20 offset:10240
    ds_read_b64_tr_b16 v[50:51], v20 offset:10752
    s_mov_b32 s42, 11702784
    buffer_store_dwordx4 v[232:235], v12, s[16:19], s42 offen sc1
    v_add_f32 v30, v150, v182
    v_sub_f32 v182, v150, v182
    v_add_f32 v31, v151, v183
    v_sub_f32 v183, v151, v183
    s_waitcnt lgkmcnt(6)
    v_mfma_f32_32x32x16_bf16 v[64:79], v[208:211], v[32:35], v[64:79]
    ds_read_b64_tr_b16 v[52:53], v21 offset:10240
    ds_read_b64_tr_b16 v[54:55], v21 offset:10752
    v_cvt_pk_bf16_f32 v237, v30, v31
    v_cvt_pk_bf16_f32 v239, v182, v183
    v_add_f32 v28, v136, v168
    v_sub_f32 v168, v136, v168
    v_add_f32 v29, v137, v169
    v_mfma_f32_32x32x16_bf16 v[80:95], v[208:211], v[36:39], v[80:95]
    ds_read_b64_tr_b16 v[56:57], v20 offset:26624
    ds_read_b64_tr_b16 v[58:59], v20 offset:27136
    v_sub_f32 v169, v137, v169
    v_permlane16_swap_b32 v236, v238
    v_permlane16_swap_b32 v237, v239
    s_waitcnt lgkmcnt(6)
    v_mfma_f32_32x32x16_bf16 v[96:111], v[208:211], v[40:43], v[96:111]
    ds_read_b64_tr_b16 v[60:61], v21 offset:26624
    ds_read_b64_tr_b16 v[62:63], v21 offset:27136
    s_mov_b32 s42, 11743872
    buffer_store_dwordx4 v[236:239], v12, s[16:19], s42 offen sc1
    v_cvt_pk_bf16_f32 v240, v28, v29
    v_cvt_pk_bf16_f32 v242, v168, v169
    v_add_f32 v30, v152, v184
    v_sub_f32 v184, v152, v184
    v_mfma_f32_32x32x16_bf16 v[112:127], v[208:211], v[44:47], v[112:127]
    ds_read_b64_tr_b16 v[32:33], v20 offset:12288
    ds_read_b64_tr_b16 v[34:35], v20 offset:12800
    v_add_f32 v31, v153, v185
    v_sub_f32 v185, v153, v185
    v_cvt_pk_bf16_f32 v241, v30, v31
    v_cvt_pk_bf16_f32 v243, v184, v185
    s_waitcnt lgkmcnt(6)
    v_mfma_f32_32x32x16_bf16 v[64:79], v[212:215], v[48:51], v[64:79]
    ds_read_b64_tr_b16 v[36:37], v21 offset:12288
    ds_read_b64_tr_b16 v[38:39], v21 offset:12800
    v_add_f32 v28, v138, v170
    v_sub_f32 v170, v138, v170
    v_add_f32 v29, v139, v171
    v_sub_f32 v171, v139, v171
    v_permlane16_swap_b32 v240, v242
    v_mfma_f32_32x32x16_bf16 v[80:95], v[212:215], v[52:55], v[80:95]
    ds_read_b64_tr_b16 v[40:41], v20 offset:28672
    ds_read_b64_tr_b16 v[42:43], v20 offset:29184
    v_permlane16_swap_b32 v241, v243
    v_cvt_pk_bf16_f32 v244, v28, v29
    v_cvt_pk_bf16_f32 v246, v170, v171
    s_waitcnt lgkmcnt(6)
    v_mfma_f32_32x32x16_bf16 v[96:111], v[212:215], v[56:59], v[96:111]
    ds_read_b64_tr_b16 v[44:45], v21 offset:28672
    ds_read_b64_tr_b16 v[46:47], v21 offset:29184
    s_mov_b32 s42, 11867136
    buffer_store_dwordx4 v[240:243], v12, s[16:19], s42 offen sc1
    v_add_f32 v30, v154, v186
    v_sub_f32 v186, v154, v186
    v_add_f32 v31, v155, v187
    v_sub_f32 v187, v155, v187
    v_mfma_f32_32x32x16_bf16 v[112:127], v[212:215], v[60:63], v[112:127]
    ds_read_b32 v13, v10 offset:88
    ds_read_b64_tr_b16 v[48:49], v20 offset:14336
    ds_read_b64_tr_b16 v[50:51], v20 offset:14848
    v_cvt_pk_bf16_f32 v245, v30, v31
    v_cvt_pk_bf16_f32 v247, v186, v187
    v_add_f32 v28, v140, v172
    v_sub_f32 v172, v140, v172
    s_waitcnt lgkmcnt(7)
    v_mfma_f32_32x32x16_bf16 v[64:79], v[216:219], v[32:35], v[64:79]
    ds_read_b64_tr_b16 v[52:53], v21 offset:14336
    ds_read_b64_tr_b16 v[54:55], v21 offset:14848
    v_add_f32 v29, v141, v173
    v_sub_f32 v173, v141, v173
    v_permlane16_swap_b32 v244, v246
    v_permlane16_swap_b32 v245, v247
    v_mfma_f32_32x32x16_bf16 v[80:95], v[216:219], v[36:39], v[80:95]
    ds_read_b64_tr_b16 v[56:57], v20 offset:30720
    ds_read_b64_tr_b16 v[58:59], v20 offset:31232
    s_mov_b32 s42, 11908224
    buffer_store_dwordx4 v[244:247], v12, s[16:19], s42 offen sc1
    v_cvt_pk_bf16_f32 v248, v28, v29
    v_cvt_pk_bf16_f32 v250, v172, v173
    v_add_f32 v30, v156, v188
    v_sub_f32 v188, v156, v188
    s_waitcnt lgkmcnt(7)
    v_mfma_f32_32x32x16_bf16 v[96:111], v[216:219], v[40:43], v[96:111]
    ds_read_b64_tr_b16 v[60:61], v21 offset:30720
    ds_read_b64_tr_b16 v[62:63], v21 offset:31232
    v_add_f32 v31, v157, v189
    v_sub_f32 v189, v157, v189
    v_cvt_pk_bf16_f32 v249, v30, v31
    v_cvt_pk_bf16_f32 v251, v188, v189
    v_mfma_f32_32x32x16_bf16 v[112:127], v[216:219], v[44:47], v[112:127]
    s_waitcnt lgkmcnt(8)
    v_readfirstlane_b32 s40, v13
    s_cmp_ge_u32 s40, 4
    s_cbranch_scc1 L_ld_25
    v_mov_b32 v26, 163800
    s_mov_b32 s60, 0
L_lw_26:
    ds_read_b32 v27, v26
    s_add_u32 s60, s60, 1
    s_waitcnt lgkmcnt(0)
    v_readfirstlane_b32 s40, v27
    s_cmp_gt_u32 s60, 1600000
    s_cbranch_scc1 L_lwd_27
    s_cmp_lt_u32 s40, 4
    s_cbranch_scc1 L_lw_26
L_lwd_27:
L_ld_25:
    ds_read_b64_tr_b16 v[32:33], v22 offset:0
    ds_read_b64_tr_b16 v[34:35], v22 offset:512
    v_add_f32 v28, v142, v174
    v_sub_f32 v174, v142, v174
    v_add_f32 v29, v143, v175
    v_sub_f32 v175, v143, v175
    s_waitcnt lgkmcnt(6)
    v_mfma_f32_32x32x16_bf16 v[64:79], v[220:223], v[48:51], v[64:79]
    ds_read_b64_tr_b16 v[36:37], v23 offset:0
    ds_read_b64_tr_b16 v[38:39], v23 offset:512
    v_permlane16_swap_b32 v248, v250
    v_permlane16_swap_b32 v249, v251
    v_cvt_pk_bf16_f32 v252, v28, v29
    v_cvt_pk_bf16_f32 v254, v174, v175
    v_mfma_f32_32x32x16_bf16 v[80:95], v[220:223], v[52:55], v[80:95]
    ds_read_b64_tr_b16 v[40:41], v22 offset:16384
    ds_read_b64_tr_b16 v[42:43], v22 offset:16896
    s_mov_b32 s42, 12031488
    buffer_store_dwordx4 v[248:251], v12, s[16:19], s42 offen sc1
    v_add_f32 v30, v158, v190
    v_sub_f32 v190, v158, v190
    v_add_f32 v31, v159, v191
    v_sub_f32 v191, v159, v191
    s_waitcnt lgkmcnt(6)
    v_mfma_f32_32x32x16_bf16 v[96:111], v[220:223], v[56:59], v[96:111]
    ds_read_b64_tr_b16 v[44:45], v23 offset:16384
    ds_read_b64_tr_b16 v[46:47], v23 offset:16896
    v_cvt_pk_bf16_f32 v253, v30, v31
    v_cvt_pk_bf16_f32 v255, v190, v191
    s_nop 1
    v_permlane16_swap_b32 v252, v254
    v_mfma_f32_32x32x16_bf16 v[112:127], v[220:223], v[60:63], v[112:127]
    ds_read_b64_tr_b16 v[48:49], v22 offset:2048
    ds_read_b64_tr_b16 v[50:51], v22 offset:2560
    v_permlane16_swap_b32 v253, v255
    s_waitcnt lgkmcnt(6)
    v_mfma_f32_32x32x16_bf16 v[128:143], v[192:195], v[32:35], 0
    ds_read_b64_tr_b16 v[52:53], v23 offset:2048
    ds_read_b64_tr_b16 v[54:55], v23 offset:2560
    s_mov_b32 s42, 12072576
    buffer_store_dwordx4 v[252:255], v12, s[16:19], s42 offen sc1
    v_mfma_f32_32x32x16_bf16 v[144:159], v[192:195], v[36:39], 0
    ds_read_b64_tr_b16 v[56:57], v22 offset:18432
    ds_read_b64_tr_b16 v[58:59], v22 offset:18944
    s_waitcnt lgkmcnt(6)
    v_mfma_f32_32x32x16_bf16 v[160:175], v[192:195], v[40:43], 0
    ds_read_b64_tr_b16 v[60:61], v23 offset:18432
    ds_read_b64_tr_b16 v[62:63], v23 offset:18944
    v_mfma_f32_32x32x16_bf16 v[176:191], v[192:195], v[44:47], 0
    ds_read_b64_tr_b16 v[32:33], v22 offset:4096
    ds_read_b64_tr_b16 v[34:35], v22 offset:4608
    v_add_f32 v28, v64, v96
    v_sub_f32 v96, v64, v96
    v_add_f32 v29, v65, v97
    v_sub_f32 v97, v65, v97
    s_waitcnt lgkmcnt(6)
    v_mfma_f32_32x32x16_bf16 v[128:143], v[196:199], v[48:51], v[128:143]
    ds_read_b64_tr_b16 v[36:37], v23 offset:4096
    ds_read_b64_tr_b16 v[38:39], v23 offset:4608
    v_cvt_pk_bf16_f32 v224, v28, v29
    v_cvt_pk_bf16_f32 v226, v96, v97
    v_add_f32 v30, v80, v112
    v_sub_f32 v112, v80, v112
    v_add_f32 v31, v81, v113
    v_mfma_f32_32x32x16_bf16 v[144:159], v[196:199], v[52:55], v[144:159]
    ds_read_b64_tr_b16 v[40:41], v22 offset:20480
    ds_read_b64_tr_b16 v[42:43], v22 offset:20992
    v_sub_f32 v113, v81, v113
    v_cvt_pk_bf16_f32 v225, v30, v31
    v_cvt_pk_bf16_f32 v227, v112, v113
    v_add_f32 v28, v66, v98
    s_waitcnt lgkmcnt(6)
    v_mfma_f32_32x32x16_bf16 v[160:175], v[196:199], v[56:59], v[160:175]
    ds_read_b64_tr_b16 v[44:45], v23 offset:20480
    ds_read_b64_tr_b16 v[46:47], v23 offset:20992
    v_sub_f32 v98, v66, v98
    v_add_f32 v29, v67, v99
    v_sub_f32 v99, v67, v99
    v_permlane16_swap_b32 v224, v226
    v_mfma_f32_32x32x16_bf16 v[176:191], v[196:199], v[60:63], v[176:191]
    ds_read_b64_tr_b16 v[48:49], v22 offset:6144
    ds_read_b64_tr_b16 v[50:51], v22 offset:6656
    v_permlane16_swap_b32 v225, v227
    v_cvt_pk_bf16_f32 v228, v28, v29
    v_cvt_pk_bf16_f32 v230, v98, v99
    s_waitcnt lgkmcnt(6)
    v_mfma_f32_32x32x16_bf16 v[128:143], v[200:203], v[32:35], v[128:143]
    ds_read_b64_tr_b16 v[52:53], v23 offset:6144
    ds_read_b64_tr_b16 v[54:55], v23 offset:6656
    s_mov_b32 s42, 11542528
    buffer_store_dwordx4 v[224:227], v12, s[16:19], s42 offen sc1
    v_add_f32 v30, v82, v114
    v_sub_f32 v114, v82, v114
    v_add_f32 v31, v83, v115
    v_sub_f32 v115, v83, v115
    v_cvt_pk_bf16_f32 v229, v30, v31
    v_mfma_f32_32x32x16_bf16 v[144:159], v[200:203], v[36:39], v[144:159]
    ds_read_b64_tr_b16 v[56:57], v22 offset:22528
    ds_read_b64_tr_b16 v[58:59], v22 offset:23040
    v_cvt_pk_bf16_f32 v231, v114, v115
    v_add_f32 v28, v68, v100
    v_sub_f32 v100, v68, v100
    v_add_f32 v29, v69, v101
    s_waitcnt lgkmcnt(6)
    v_mfma_f32_32x32x16_bf16 v[160:175], v[200:203], v[40:43], v[160:175]
    ds_read_b64_tr_b16 v[60:61], v23 offset:22528
    ds_read_b64_tr_b16 v[62:63], v23 offset:23040
    v_sub_f32 v101, v69, v101
    v_permlane16_swap_b32 v228, v230
    v_permlane16_swap_b32 v229, v231
    v_mfma_f32_32x32x16_bf16 v[176:191], v[200:203], v[44:47], v[176:191]
    ds_read_b64_tr_b16 v[32:33], v22 offset:8192
    ds_read_b64_tr_b16 v[34:35], v22 offset:8704
    s_mov_b32 s42, 11583616
    buffer_store_dwordx4 v[228:231], v12, s[16:19], s42 offen sc1
    v_cvt_pk_bf16_f32 v232, v28, v29
    v_cvt_pk_bf16_f32 v234, v100, v101
    v_add_f32 v30, v84, v116
    v_sub_f32 v116, v84, v116
    s_waitcnt lgkmcnt(6)
    v_mfma_f32_32x32x16_bf16 v[128:143], v[204:207], v[48:51], v[128:143]
    ds_read_b64_tr_b16 v[36:37], v23 offset:8192
    ds_read_b64_tr_b16 v[38:39], v23 offset:8704
    v_add_f32 v31, v85, v117
    v_sub_f32 v117, v85, v117
    v_cvt_pk_bf16_f32 v233, v30, v31
    v_cvt_pk_bf16_f32 v235, v116, v117
    v_add_f32 v28, v70, v102
    v_mfma_f32_32x32x16_bf16 v[144:159], v[204:207], v[52:55], v[144:159]
    ds_read_b64_tr_b16 v[40:41], v22 offset:24576
    ds_read_b64_tr_b16 v[42:43], v22 offset:25088
    v_sub_f32 v102, v70, v102
    v_add_f32 v29, v71, v103
    v_sub_f32 v103, v71, v103
    v_permlane16_swap_b32 v232, v234
    s_waitcnt lgkmcnt(6)
    v_mfma_f32_32x32x16_bf16 v[160:175], v[204:207], v[56:59], v[160:175]
    ds_read_b64_tr_b16 v[44:45], v23 offset:24576
    ds_read_b64_tr_b16 v[46:47], v23 offset:25088
    v_permlane16_swap_b32 v233, v235
    v_cvt_pk_bf16_f32 v236, v28, v29
    v_cvt_pk_bf16_f32 v238, v102, v103
    v_mfma_f32_32x32x16_bf16 v[176:191], v[204:207], v[60:63], v[176:191]
    ds_read_b64_tr_b16 v[48:49], v22 offset:10240
    ds_read_b64_tr_b16 v[50:51], v22 offset:10752
    s_mov_b32 s42, 11706880
    buffer_store_dwordx4 v[232:235], v12, s[16:19], s42 offen sc1
    v_add_f32 v30, v86, v118
    v_sub_f32 v118, v86, v118
    v_add_f32 v31, v87, v119
    v_sub_f32 v119, v87, v119
    s_waitcnt lgkmcnt(6)
    v_mfma_f32_32x32x16_bf16 v[128:143], v[208:211], v[32:35], v[128:143]
    ds_read_b64_tr_b16 v[52:53], v23 offset:10240
    ds_read_b64_tr_b16 v[54:55], v23 offset:10752
    v_cvt_pk_bf16_f32 v237, v30, v31
    v_cvt_pk_bf16_f32 v239, v118, v119
    v_add_f32 v28, v72, v104
    v_sub_f32 v104, v72, v104
    v_add_f32 v29, v73, v105
    v_mfma_f32_32x32x16_bf16 v[144:159], v[208:211], v[36:39], v[144:159]
    ds_read_b64_tr_b16 v[56:57], v22 offset:26624
    ds_read_b64_tr_b16 v[58:59], v22 offset:27136
    v_sub_f32 v105, v73, v105
    v_permlane16_swap_b32 v236, v238
    v_permlane16_swap_b32 v237, v239
    s_waitcnt lgkmcnt(6)
    v_mfma_f32_32x32x16_bf16 v[160:175], v[208:211], v[40:43], v[160:175]
    ds_read_b64_tr_b16 v[60:61], v23 offset:26624
    ds_read_b64_tr_b16 v[62:63], v23 offset:27136
    s_mov_b32 s42, 11747968
    buffer_store_dwordx4 v[236:239], v12, s[16:19], s42 offen sc1
    v_cvt_pk_bf16_f32 v240, v28, v29
    v_cvt_pk_bf16_f32 v242, v104, v105
    v_add_f32 v30, v88, v120
    v_sub_f32 v120, v88, v120
    v_mfma_f32_32x32x16_bf16 v[176:191], v[208:211], v[44:47], v[176:191]
    ds_read_b64_tr_b16 v[32:33], v22 offset:12288
    ds_read_b64_tr_b16 v[34:35], v22 offset:12800
    v_add_f32 v31, v89, v121
    v_sub_f32 v121, v89, v121
    v_cvt_pk_bf16_f32 v241, v30, v31
    v_cvt_pk_bf16_f32 v243, v120, v121
    s_waitcnt lgkmcnt(6)
    v_mfma_f32_32x32x16_bf16 v[128:143], v[212:215], v[48:51], v[128:143]
    ds_read_b64_tr_b16 v[36:37], v23 offset:12288
    ds_read_b64_tr_b16 v[38:39], v23 offset:12800
    v_add_f32 v28, v74, v106
    v_sub_f32 v106, v74, v106
    v_add_f32 v29, v75, v107
    v_sub_f32 v107, v75, v107
    v_permlane16_swap_b32 v240, v242
    v_mfma_f32_32x32x16_bf16 v[144:159], v[212:215], v[52:55], v[144:159]
    ds_read_b64_tr_b16 v[40:41], v22 offset:28672
    ds_read_b64_tr_b16 v[42:43], v22 offset:29184
    v_permlane16_swap_b32 v241, v243
    v_cvt_pk_bf16_f32 v244, v28, v29
    v_cvt_pk_bf16_f32 v246, v106, v107
    s_waitcnt lgkmcnt(6)
    v_mfma_f32_32x32x16_bf16 v[160:175], v[212:215], v[56:59], v[160:175]
    ds_read_b64_tr_b16 v[44:45], v23 offset:28672
    ds_read_b64_tr_b16 v[46:47], v23 offset:29184
    s_mov_b32 s42, 11871232
    buffer_store_dwordx4 v[240:243], v12, s[16:19], s42 offen sc1
    v_add_f32 v30, v90, v122
    v_sub_f32 v122, v90, v122
    v_add_f32 v31, v91, v123
    v_sub_f32 v123, v91, v123
    v_mfma_f32_32x32x16_bf16 v[176:191], v[212:215], v[60:63], v[176:191]
    ds_read_b32 v13, v10 offset:56
    ds_read_b64_tr_b16 v[48:49], v22 offset:14336
    ds_read_b64_tr_b16 v[50:51], v22 offset:14848
    v_cvt_pk_bf16_f32 v245, v30, v31
    v_cvt_pk_bf16_f32 v247, v122, v123
    v_add_f32 v28, v76, v108
    v_sub_f32 v108, v76, v108
    s_waitcnt lgkmcnt(7)
    v_mfma_f32_32x32x16_bf16 v[128:143], v[216:219], v[32:35], v[128:143]
    ds_read_b64_tr_b16 v[52:53], v23 offset:14336
    ds_read_b64_tr_b16 v[54:55], v23 offset:14848
    v_add_f32 v29, v77, v109
    v_sub_f32 v109, v77, v109
    v_permlane16_swap_b32 v244, v246
    v_permlane16_swap_b32 v245, v247
    v_mfma_f32_32x32x16_bf16 v[144:159], v[216:219], v[36:39], v[144:159]
    ds_read_b64_tr_b16 v[56:57], v22 offset:30720
    ds_read_b64_tr_b16 v[58:59], v22 offset:31232
    s_mov_b32 s42, 11912320
    buffer_store_dwordx4 v[244:247], v12, s[16:19], s42 offen sc1
    v_cvt_pk_bf16_f32 v248, v28, v29
    v_cvt_pk_bf16_f32 v250, v108, v109
    v_add_f32 v30, v92, v124
    v_sub_f32 v124, v92, v124
    s_waitcnt lgkmcnt(7)
    v_mfma_f32_32x32x16_bf16 v[160:175], v[216:219], v[40:43], v[160:175]
    ds_read_b64_tr_b16 v[60:61], v23 offset:30720
    ds_read_b64_tr_b16 v[62:63], v23 offset:31232
    v_add_f32 v31, v93, v125
    v_sub_f32 v125, v93, v125
    v_cvt_pk_bf16_f32 v249, v30, v31
    v_cvt_pk_bf16_f32 v251, v124, v125
    v_mfma_f32_32x32x16_bf16 v[176:191], v[216:219], v[44:47], v[176:191]
    s_waitcnt lgkmcnt(8)
    v_readfirstlane_b32 s40, v13
    s_cmp_ge_u32 s40, 4
    s_cbranch_scc1 L_ld_28
    v_mov_b32 v26, 163768
    s_mov_b32 s60, 0
L_lw_29:
    ds_read_b32 v27, v26
    s_add_u32 s60, s60, 1
    s_waitcnt lgkmcnt(0)
    v_readfirstlane_b32 s40, v27
    s_cmp_gt_u32 s60, 1600000
    s_cbranch_scc1 L_lwd_30
    s_cmp_lt_u32 s40, 4
    s_cbranch_scc1 L_lw_29
L_lwd_30:
L_ld_28:
    ds_read_b64_tr_b16 v[32:33], v18 offset:0
    ds_read_b64_tr_b16 v[34:35], v18 offset:512
    v_add_f32 v28, v78, v110
    v_sub_f32 v110, v78, v110
    v_add_f32 v29, v79, v111
    v_sub_f32 v111, v79, v111
    s_waitcnt lgkmcnt(6)
    v_mfma_f32_32x32x16_bf16 v[128:143], v[220:223], v[48:51], v[128:143]
    ds_read_b64_tr_b16 v[36:37], v19 offset:0
    ds_read_b64_tr_b16 v[38:39], v19 offset:512
    v_permlane16_swap_b32 v248, v250
    v_permlane16_swap_b32 v249, v251
    v_cvt_pk_bf16_f32 v252, v28, v29
    v_cvt_pk_bf16_f32 v254, v110, v111
    v_mfma_f32_32x32x16_bf16 v[144:159], v[220:223], v[52:55], v[144:159]
    ds_read_b64_tr_b16 v[40:41], v18 offset:16384
    ds_read_b64_tr_b16 v[42:43], v18 offset:16896
    s_mov_b32 s42, 12035584
    buffer_store_dwordx4 v[248:251], v12, s[16:19], s42 offen sc1
    v_add_f32 v30, v94, v126
    v_sub_f32 v126, v94, v126
    v_add_f32 v31, v95, v127
    v_sub_f32 v127, v95, v127
    s_waitcnt lgkmcnt(6)
    v_mfma_f32_32x32x16_bf16 v[160:175], v[220:223], v[56:59], v[160:175]
    ds_read_b64_tr_b16 v[44:45], v19 offset:16384
    ds_read_b64_tr_b16 v[46:47], v19 offset:16896
    v_cvt_pk_bf16_f32 v253, v30, v31
    v_cvt_pk_bf16_f32 v255, v126, v127
    s_nop 1
    v_permlane16_swap_b32 v252, v254
    v_mfma_f32_32x32x16_bf16 v[176:191], v[220:223], v[60:63], v[176:191]
    ds_read_b64_tr_b16 v[48:49], v18 offset:2048
    ds_read_b64_tr_b16 v[50:51], v18 offset:2560
    v_permlane16_swap_b32 v253, v255
    s_waitcnt lgkmcnt(6)
    v_mfma_f32_32x32x16_bf16 v[64:79], v[192:195], v[32:35], 0
    ds_read_b64_tr_b16 v[52:53], v19 offset:2048
    ds_read_b64_tr_b16 v[54:55], v19 offset:2560
    s_mov_b32 s42, 12076672
    buffer_store_dwordx4 v[252:255], v12, s[16:19], s42 offen sc1
    v_mfma_f32_32x32x16_bf16 v[80:95], v[192:195], v[36:39], 0
    ds_read_b64_tr_b16 v[56:57], v18 offset:18432
    ds_read_b64_tr_b16 v[58:59], v18 offset:18944
    s_waitcnt lgkmcnt(6)
    v_mfma_f32_32x32x16_bf16 v[96:111], v[192:195], v[40:43], 0
    ds_read_b64_tr_b16 v[60:61], v19 offset:18432
    ds_read_b64_tr_b16 v[62:63], v19 offset:18944
    v_mfma_f32_32x32x16_bf16 v[112:127], v[192:195], v[44:47], 0
    ds_read_b64_tr_b16 v[32:33], v18 offset:4096
    ds_read_b64_tr_b16 v[34:35], v18 offset:4608
    v_add_f32 v28, v128, v160
    v_sub_f32 v160, v128, v160
    v_add_f32 v29, v129, v161
    v_sub_f32 v161, v129, v161
    s_waitcnt lgkmcnt(6)
    v_mfma_f32_32x32x16_bf16 v[64:79], v[196:199], v[48:51], v[64:79]
    ds_read_b64_tr_b16 v[36:37], v19 offset:4096
    ds_read_b64_tr_b16 v[38:39], v19 offset:4608
    v_cvt_pk_bf16_f32 v224, v28, v29
    v_cvt_pk_bf16_f32 v226, v160, v161
    v_add_f32 v30, v144, v176
    v_sub_f32 v176, v144, v176
    v_add_f32 v31, v145, v177
    v_mfma_f32_32x32x16_bf16 v[80:95], v[196:199], v[52:55], v[80:95]
    ds_read_b64_tr_b16 v[40:41], v18 offset:20480
    ds_read_b64_tr_b16 v[42:43], v18 offset:20992
    v_sub_f32 v177, v145, v177
    v_cvt_pk_bf16_f32 v225, v30, v31
    v_cvt_pk_bf16_f32 v227, v176, v177
    v_add_f32 v28, v130, v162
    s_waitcnt lgkmcnt(6)
    v_mfma_f32_32x32x16_bf16 v[96:111], v[196:199], v[56:59], v[96:111]
    ds_read_b64_tr_b16 v[44:45], v19 offset:20480
    ds_read_b64_tr_b16 v[46:47], v19 offset:20992
    v_sub_f32 v162, v130, v162
    v_add_f32 v29, v131, v163
    v_sub_f32 v163, v131, v163
    v_permlane16_swap_b32 v224, v226
    v_mfma_f32_32x32x16_bf16 v[112:127], v[196:199], v[60:63], v[112:127]
    ds_read_b64_tr_b16 v[48:49], v18 offset:6144
    ds_read_b64_tr_b16 v[50:51], v18 offset:6656
    v_permlane16_swap_b32 v225, v227
    v_cvt_pk_bf16_f32 v228, v28, v29
    v_cvt_pk_bf16_f32 v230, v162, v163
    s_waitcnt lgkmcnt(6)
    v_mfma_f32_32x32x16_bf16 v[64:79], v[200:203], v[32:35], v[64:79]
    ds_read_b64_tr_b16 v[52:53], v19 offset:6144
    ds_read_b64_tr_b16 v[54:55], v19 offset:6656
    s_mov_b32 s42, 11546624
    buffer_store_dwordx4 v[224:227], v12, s[16:19], s42 offen sc1
    v_add_f32 v30, v146, v178
    v_sub_f32 v178, v146, v178
    v_add_f32 v31, v147, v179
    v_sub_f32 v179, v147, v179
    v_cvt_pk_bf16_f32 v229, v30, v31
    v_mfma_f32_32x32x16_bf16 v[80:95], v[200:203], v[36:39], v[80:95]
    ds_read_b64_tr_b16 v[56:57], v18 offset:22528
    ds_read_b64_tr_b16 v[58:59], v18 offset:23040
    v_cvt_pk_bf16_f32 v231, v178, v179
    v_add_f32 v28, v132, v164
    v_sub_f32 v164, v132, v164
    v_add_f32 v29, v133, v165
    s_waitcnt lgkmcnt(6)
    v_mfma_f32_32x32x16_bf16 v[96:111], v[200:203], v[40:43], v[96:111]
    ds_read_b64_tr_b16 v[60:61], v19 offset:22528
    ds_read_b64_tr_b16 v[62:63], v19 offset:23040
    v_sub_f32 v165, v133, v165
    v_permlane16_swap_b32 v228, v230
    v_permlane16_swap_b32 v229, v231
    v_mfma_f32_32x32x16_bf16 v[112:127], v[200:203], v[44:47], v[112:127]
    ds_read_b64_tr_b16 v[32:33], v18 offset:8192
    ds_read_b64_tr_b16 v[34:35], v18 offset:8704
    s_mov_b32 s42, 11587712
    buffer_store_dwordx4 v[228:231], v12, s[16:19], s42 offen sc1
    v_cvt_pk_bf16_f32 v232, v28, v29
    v_cvt_pk_bf16_f32 v234, v164, v165
    v_add_f32 v30, v148, v180
    v_sub_f32 v180, v148, v180
    s_waitcnt lgkmcnt(6)
    v_mfma_f32_32x32x16_bf16 v[64:79], v[204:207], v[48:51], v[64:79]
    ds_read_b64_tr_b16 v[36:37], v19 offset:8192
    ds_read_b64_tr_b16 v[38:39], v19 offset:8704
    v_add_f32 v31, v149, v181
    v_sub_f32 v181, v149, v181
    v_cvt_pk_bf16_f32 v233, v30, v31
    v_cvt_pk_bf16_f32 v235, v180, v181
    v_add_f32 v28, v134, v166
    v_mfma_f32_32x32x16_bf16 v[80:95], v[204:207], v[52:55], v[80:95]
    ds_read_b64_tr_b16 v[40:41], v18 offset:24576
    ds_read_b64_tr_b16 v[42:43], v18 offset:25088
    v_sub_f32 v166, v134, v166
    v_add_f32 v29, v135, v167
    v_sub_f32 v167, v135, v167
    v_permlane16_swap_b32 v232, v234
    s_waitcnt lgkmcnt(6)
    v_mfma_f32_32x32x16_bf16 v[96:111], v[204:207], v[56:59], v[96:111]
    ds_read_b64_tr_b16 v[44:45], v19 offset:24576
    ds_read_b64_tr_b16 v[46:47], v19 offset:25088
    v_permlane16_swap_b32 v233, v235
    v_cvt_pk_bf16_f32 v236, v28, v29
    v_cvt_pk_bf16_f32 v238, v166, v167
    v_mfma_f32_32x32x16_bf16 v[112:127], v[204:207], v[60:63], v[112:127]
    ds_read_b64_tr_b16 v[48:49], v18 offset:10240
    ds_read_b64_tr_b16 v[50:51], v18 offset:10752
    s_mov_b32 s42, 11710976
    buffer_store_dwordx4 v[232:235], v12, s[16:19], s42 offen sc1
    v_add_f32 v30, v150, v182
    v_sub_f32 v182, v150, v182
    v_add_f32 v31, v151, v183
    v_sub_f32 v183, v151, v183
    s_waitcnt lgkmcnt(6)
    v_mfma_f32_32x32x16_bf16 v[64:79], v[208:211], v[32:35], v[64:79]
    ds_read_b64_tr_b16 v[52:53], v19 offset:10240
    ds_read_b64_tr_b16 v[54:55], v19 offset:10752
    v_cvt_pk_bf16_f32 v237, v30, v31
    v_cvt_pk_bf16_f32 v239, v182, v183
    v_add_f32 v28, v136, v168
    v_sub_f32 v168, v136, v168
    v_add_f32 v29, v137, v169
    v_mfma_f32_32x32x16_bf16 v[80:95], v[208:211], v[36:39], v[80:95]
    ds_read_b64_tr_b16 v[56:57], v18 offset:26624
    ds_read_b64_tr_b16 v[58:59], v18 offset:27136
    v_sub_f32 v169, v137, v169
    v_permlane16_swap_b32 v236, v238
    v_permlane16_swap_b32 v237, v239
    s_waitcnt lgkmcnt(6)
    v_mfma_f32_32x32x16_bf16 v[96:111], v[208:211], v[40:43], v[96:111]
    ds_read_b64_tr_b16 v[60:61], v19 offset:26624
    ds_read_b64_tr_b16 v[62:63], v19 offset:27136
    s_mov_b32 s42, 11752064
    buffer_store_dwordx4 v[236:239], v12, s[16:19], s42 offen sc1
    v_cvt_pk_bf16_f32 v240, v28, v29
    v_cvt_pk_bf16_f32 v242, v168, v169
    v_add_f32 v30, v152, v184
    v_sub_f32 v184, v152, v184
    v_mfma_f32_32x32x16_bf16 v[112:127], v[208:211], v[44:47], v[112:127]
    ds_read_b64_tr_b16 v[32:33], v18 offset:12288
    ds_read_b64_tr_b16 v[34:35], v18 offset:12800
    v_add_f32 v31, v153, v185
    v_sub_f32 v185, v153, v185
    v_cvt_pk_bf16_f32 v241, v30, v31
    v_cvt_pk_bf16_f32 v243, v184, v185
    s_waitcnt lgkmcnt(6)
    v_mfma_f32_32x32x16_bf16 v[64:79], v[212:215], v[48:51], v[64:79]
    ds_read_b64_tr_b16 v[36:37], v19 offset:12288
    ds_read_b64_tr_b16 v[38:39], v19 offset:12800
    v_add_f32 v28, v138, v170
    v_sub_f32 v170, v138, v170
    v_add_f32 v29, v139, v171
    v_sub_f32 v171, v139, v171
    v_permlane16_swap_b32 v240, v242
    v_mfma_f32_32x32x16_bf16 v[80:95], v[212:215], v[52:55], v[80:95]
    ds_read_b64_tr_b16 v[40:41], v18 offset:28672
    ds_read_b64_tr_b16 v[42:43], v18 offset:29184
    v_permlane16_swap_b32 v241, v243
    v_cvt_pk_bf16_f32 v244, v28, v29
    v_cvt_pk_bf16_f32 v246, v170, v171
    s_waitcnt lgkmcnt(6)
    v_mfma_f32_32x32x16_bf16 v[96:111], v[212:215], v[56:59], v[96:111]
    ds_read_b64_tr_b16 v[44:45], v19 offset:28672
    ds_read_b64_tr_b16 v[46:47], v19 offset:29184
    s_mov_b32 s42, 11875328
    buffer_store_dwordx4 v[240:243], v12, s[16:19], s42 offen sc1
    v_add_f32 v30, v154, v186
    v_sub_f32 v186, v154, v186
    v_add_f32 v31, v155, v187
    v_sub_f32 v187, v155, v187
    v_mfma_f32_32x32x16_bf16 v[112:127], v[212:215], v[60:63], v[112:127]
    ds_read_b64_tr_b16 v[48:49], v18 offset:14336
    ds_read_b64_tr_b16 v[50:51], v18 offset:14848
    v_cvt_pk_bf16_f32 v245, v30, v31
    v_cvt_pk_bf16_f32 v247, v186, v187
    v_add_f32 v28, v140, v172
    v_sub_f32 v172, v140, v172
    s_waitcnt lgkmcnt(6)
    v_mfma_f32_32x32x16_bf16 v[64:79], v[216:219], v[32:35], v[64:79]
    ds_read_b64_tr_b16 v[52:53], v19 offset:14336
    ds_read_b64_tr_b16 v[54:55], v19 offset:14848
    v_add_f32 v29, v141, v173
    v_sub_f32 v173, v141, v173
    v_permlane16_swap_b32 v244, v246
    v_permlane16_swap_b32 v245, v247
    v_mfma_f32_32x32x16_bf16 v[80:95], v[216:219], v[36:39], v[80:95]
    ds_read_b64_tr_b16 v[56:57], v18 offset:30720
    ds_read_b64_tr_b16 v[58:59], v18 offset:31232
    s_mov_b32 s42, 11916416
    buffer_store_dwordx4 v[244:247], v12, s[16:19], s42 offen sc1
    v_cvt_pk_bf16_f32 v248, v28, v29
    v_cvt_pk_bf16_f32 v250, v172, v173
    v_add_f32 v30, v156, v188
    v_sub_f32 v188, v156, v188
    s_waitcnt lgkmcnt(6)
    v_mfma_f32_32x32x16_bf16 v[96:111], v[216:219], v[40:43], v[96:111]
    ds_read_b64_tr_b16 v[60:61], v19 offset:30720
    ds_read_b64_tr_b16 v[62:63], v19 offset:31232
    v_add_f32 v31, v157, v189
    v_sub_f32 v189, v157, v189
    v_cvt_pk_bf16_f32 v249, v30, v31
    v_cvt_pk_bf16_f32 v251, v188, v189
    v_mfma_f32_32x32x16_bf16 v[112:127], v[216:219], v[44:47], v[112:127]
    v_add_f32 v28, v142, v174
    v_sub_f32 v174, v142, v174
    v_add_f32 v29, v143, v175
    v_sub_f32 v175, v143, v175
    s_waitcnt lgkmcnt(4)
    v_mfma_f32_32x32x16_bf16 v[64:79], v[220:223], v[48:51], v[64:79]
    v_permlane16_swap_b32 v248, v250
    v_permlane16_swap_b32 v249, v251
    v_cvt_pk_bf16_f32 v252, v28, v29
    v_cvt_pk_bf16_f32 v254, v174, v175
    v_mfma_f32_32x32x16_bf16 v[80:95], v[220:223], v[52:55], v[80:95]
    s_mov_b32 s42, 12039680
    buffer_store_dwordx4 v[248:251], v12, s[16:19], s42 offen sc1
    v_add_f32 v30, v158, v190
    v_sub_f32 v190, v158, v190
    v_add_f32 v31, v159, v191
    v_sub_f32 v191, v159, v191
    s_waitcnt lgkmcnt(0)
    v_mfma_f32_32x32x16_bf16 v[96:111], v[220:223], v[56:59], v[96:111]
    v_cvt_pk_bf16_f32 v253, v30, v31
    v_cvt_pk_bf16_f32 v255, v190, v191
    s_nop 1
    v_permlane16_swap_b32 v252, v254
    v_mfma_f32_32x32x16_bf16 v[112:127], v[220:223], v[60:63], v[112:127]
    v_permlane16_swap_b32 v253, v255
    v_mov_b32 v26, 163764
    v_mov_b32 v27, 1
    s_mov_b64 exec, 1
    ds_add_u32 v26, v27
    s_mov_b64 exec, -1
    s_mov_b32 s42, 12080768
    buffer_store_dwordx4 v[252:255], v12, s[16:19], s42 offen sc1
    s_nop 6
    v_add_f32 v28, v64, v96
    v_sub_f32 v96, v64, v96
    v_add_f32 v29, v65, v97
    v_sub_f32 v97, v65, v97
    v_cvt_pk_bf16_f32 v224, v28, v29
    v_cvt_pk_bf16_f32 v226, v96, v97
    v_add_f32 v30, v80, v112
    v_sub_f32 v112, v80, v112
    v_add_f32 v31, v81, v113
    v_sub_f32 v113, v81, v113
    v_cvt_pk_bf16_f32 v225, v30, v31
    v_cvt_pk_bf16_f32 v227, v112, v113
    v_add_f32 v28, v66, v98
    v_sub_f32 v98, v66, v98
    v_add_f32 v29, v67, v99
    v_sub_f32 v99, v67, v99
    v_permlane16_swap_b32 v224, v226
    v_permlane16_swap_b32 v225, v227
    s_mov_b32 s42, 11550720
    buffer_store_dwordx4 v[224:227], v12, s[16:19], s42 offen sc1
    v_cvt_pk_bf16_f32 v228, v28, v29
    v_cvt_pk_bf16_f32 v230, v98, v99
    v_add_f32 v30, v82, v114
    v_sub_f32 v114, v82, v114
    v_add_f32 v31, v83, v115
    v_sub_f32 v115, v83, v115
    v_cvt_pk_bf16_f32 v229, v30, v31
    v_cvt_pk_bf16_f32 v231, v114, v115
    v_add_f32 v28, v68, v100
    v_sub_f32 v100, v68, v100
    v_add_f32 v29, v69, v101
    v_sub_f32 v101, v69, v101
    v_permlane16_swap_b32 v228, v230
    v_permlane16_swap_b32 v229, v231
    s_mov_b32 s42, 11591808
    buffer_store_dwordx4 v[228:231], v12, s[16:19], s42 offen sc1
    v_cvt_pk_bf16_f32 v232, v28, v29
    v_cvt_pk_bf16_f32 v234, v100, v101
    v_add_f32 v30, v84, v116
    v_sub_f32 v116, v84, v116
    v_add_f32 v31, v85, v117
    v_sub_f32 v117, v85, v117
    v_cvt_pk_bf16_f32 v233, v30, v31
    v_cvt_pk_bf16_f32 v235, v116, v117
    v_add_f32 v28, v70, v102
    v_sub_f32 v102, v70, v102
    v_add_f32 v29, v71, v103
    v_sub_f32 v103, v71, v103
    v_permlane16_swap_b32 v232, v234
    v_permlane16_swap_b32 v233, v235
    s_mov_b32 s42, 11715072
    buffer_store_dwordx4 v[232:235], v12, s[16:19], s42 offen sc1
    v_cvt_pk_bf16_f32 v236, v28, v29
    v_cvt_pk_bf16_f32 v238, v102, v103
    v_add_f32 v30, v86, v118
    v_sub_f32 v118, v86, v118
    v_add_f32 v31, v87, v119
    v_sub_f32 v119, v87, v119
    v_cvt_pk_bf16_f32 v237, v30, v31
    v_cvt_pk_bf16_f32 v239, v118, v119
    v_add_f32 v28, v72, v104
    v_sub_f32 v104, v72, v104
    v_add_f32 v29, v73, v105
    v_sub_f32 v105, v73, v105
    v_permlane16_swap_b32 v236, v238
    v_permlane16_swap_b32 v237, v239
    s_mov_b32 s42, 11756160
    buffer_store_dwordx4 v[236:239], v12, s[16:19], s42 offen sc1
    v_cvt_pk_bf16_f32 v240, v28, v29
    v_cvt_pk_bf16_f32 v242, v104, v105
    v_add_f32 v30, v88, v120
    v_sub_f32 v120, v88, v120
    v_add_f32 v31, v89, v121
    v_sub_f32 v121, v89, v121
    v_cvt_pk_bf16_f32 v241, v30, v31
    v_cvt_pk_bf16_f32 v243, v120, v121
    v_add_f32 v28, v74, v106
    v_sub_f32 v106, v74, v106
    v_add_f32 v29, v75, v107
    v_sub_f32 v107, v75, v107
    v_permlane16_swap_b32 v240, v242
    v_permlane16_swap_b32 v241, v243
    s_mov_b32 s42, 11879424
    buffer_store_dwordx4 v[240:243], v12, s[16:19], s42 offen sc1
    v_cvt_pk_bf16_f32 v244, v28, v29
    v_cvt_pk_bf16_f32 v246, v106, v107
    v_add_f32 v30, v90, v122
    v_sub_f32 v122, v90, v122
    v_add_f32 v31, v91, v123
    v_sub_f32 v123, v91, v123
    v_cvt_pk_bf16_f32 v245, v30, v31
    v_cvt_pk_bf16_f32 v247, v122, v123
    v_add_f32 v28, v76, v108
    v_sub_f32 v108, v76, v108
    v_add_f32 v29, v77, v109
    v_sub_f32 v109, v77, v109
    v_permlane16_swap_b32 v244, v246
    v_permlane16_swap_b32 v245, v247
    s_mov_b32 s42, 11920512
    buffer_store_dwordx4 v[244:247], v12, s[16:19], s42 offen sc1
    v_cvt_pk_bf16_f32 v248, v28, v29
    v_cvt_pk_bf16_f32 v250, v108, v109
    v_add_f32 v30, v92, v124
    v_sub_f32 v124, v92, v124
    v_add_f32 v31, v93, v125
    v_sub_f32 v125, v93, v125
    v_cvt_pk_bf16_f32 v249, v30, v31
    v_cvt_pk_bf16_f32 v251, v124, v125
    v_add_f32 v28, v78, v110
    v_sub_f32 v110, v78, v110
    v_add_f32 v29, v79, v111
    v_sub_f32 v111, v79, v111
    v_permlane16_swap_b32 v248, v250
    v_permlane16_swap_b32 v249, v251
    s_mov_b32 s42, 12043776
    buffer_store_dwordx4 v[248:251], v12, s[16:19], s42 offen sc1
    v_cvt_pk_bf16_f32 v252, v28, v29
    v_cvt_pk_bf16_f32 v254, v110, v111
    v_add_f32 v30, v94, v126
    v_sub_f32 v126, v94, v126
    v_add_f32 v31, v95, v127
    v_sub_f32 v127, v95, v127
    v_cvt_pk_bf16_f32 v253, v30, v31
    v_cvt_pk_bf16_f32 v255, v126, v127
    s_nop 1
    v_permlane16_swap_b32 v252, v254
    v_permlane16_swap_b32 v253, v255
    s_mov_b32 s42, 12084864
    buffer_store_dwordx4 v[252:255], v12, s[16:19], s42 offen sc1
    v_mov_b32 v17, 163712
    ds_read_b64 v[18:19], v17
    s_waitcnt lgkmcnt(0)
    v_readfirstlane_b32 s32, v18
    v_readfirstlane_b32 s33, v19
    s_mov_b32 s96, 4
    s_branch L_SETV
L_SETR4:
    s_mul_i32 s54, s34, 12288
    s_lshr_b32 s53, s0, 3
    s_lshl_b32 s53, s53, 7
    s_add_u32 s54, s54, s53
    s_and_b32 s53, s0, 7
    s_lshl3_add_u32 s54, s53, s54
    s_add_u32 s54, s54, 15990784
    v_lshl_add_u32 v21, v2, 9, s54
    s_cmp_eq_u32 s34, 3
    s_cbranch_scc1 L_ATT
    s_waitcnt vmcnt(0)
    s_mov_b64 exec, 0xffffff
    v_mov_b32 v22, s32
    v_mov_b32 v23, s33
    buffer_store_dwordx2 v[22:23], v21, s[16:19], 0 offen sc1
    s_mov_b64 exec, -1
    s_branch L_ATT
L_SET:
    s_mov_b32 s0, s6
    s_mov_b32 s1, s7
    s_add_u32 s40, s1, 1
    s_cmp_eq_u32 s0, 0
    s_cselect_b32 s40, s40, s0
    s_cselect_b32 s41, 15, s1
    s_cmp_eq_u32 s1, 15
    s_cselect_b32 s7, s0, s41
    s_cselect_b32 s6, 0, s40
    s_lshl4_add_u32 s36, s6, s7
    s_mul_i32 s40, s7, 5
    s_lshr_b32 s40, s40, 1
    s_and_b32 s41, s7, 1
    s_lshl_b32 s47, s41, 3
    s_mul_i32 s42, s35, 40
    s_add_u32 s42, s42, s40
    s_add_u32 s45, s42, s41
    s_add_u32 s46, s42, 2
    s_cmp_eq_u32 s41, 1
    s_cselect_b32 s46, s42, s46
    s_lshl_b32 s44, s35, 4
    s_add_u32 s44, s44, s7
    s_mul_i32 s48, s35, 36992
    s_lshl_b32 s49, s6, 7
    s_lshl_b32 s43, s34, 5
    s_add_u32 s49, s49, s43
    s_mul_i32 s52, s35, 12
    s_add_u32 s52, s52, 163724
    s_add_u32 s54, s45, s34
    s_cmp_ge_u32 s34, 2
    s_cselect_b32 s54, s46, s54
    s_add_u32 s54, s54, 80
    s_lshl_b32 s54, s54, 15
    s_sub_u32 s55, s6, 2
    s_max_i32 s55, s55, 0
    s_lshl_b32 s55, s55, 11
    s_add_u32 s8, s54, s55
    s_sub_u32 s55, s6, 1
    s_max_i32 s55, s55, 0
    s_lshl_b32 s55, s55, 11
    s_add_u32 s9, s54, s55
    s_sub_u32 s55, s6, 0
    s_max_i32 s55, s55, 0
    s_lshl_b32 s55, s55, 11
    s_add_u32 s10, s54, s55
    s_mul_i32 s11, s34, 6144
    s_add_u32 s11, s11, s48
    s_lshl_b32 s12, s34, 6
    s_add_u32 s12, s12, s11
    s_add_u32 s12, s12, 18432
    s_lshl_b32 s61, s45, 15
    s_lshl_b32 s62, s46, 15
    s_add_u32 s62, s62, s47
    s_lshl_b32 s50, s34, 9
    s_add_u32 s51, s50, s48
    s_lshr_b32 s13, 0x1248, s7
    s_and_b32 s13, s13, 1
    s_lshl_b32 s14, s35, 8
    s_add_u32 s14, s14, s36
    s_lshl_b32 s14, s14, 9
    s_add_u32 s14, s14, 14680064
    s_mov_b32 s15, 163720
    s_add_u32 s54, s1, s35
    s_cmp_eq_u32 s54, 16
    s_cselect_b32 s15, 163764, s15
    s_lshl_b32 s57, s44, 16
    s_add_u32 s57, s57, 8388608
    s_lshl_b32 s58, s44, 14
    s_add_u32 s58, s58, 10485760
    s_lshl4_add_u32 s53, s35, s6
    s_lshl_b32 s53, s53, 6
    s_add_u32 s53, s53, s34
    s_lshr_b32 s54, s7, 3
    s_lshl2_add_u32 s53, s53, s54
    s_and_b32 s54, s7, 7
    s_lshl4_add_u32 s53, s53, s54
    s_lshl_b32 s53, s53, 3
    s_add_u32 s59, s53, 14942208
    s_mov_b32 s56, s6
    s_lshr_b32 s7, s2, 5
    s_and_b32 s40, s2, 1
    s_lshl1_add_u32 s7, s7, s40
    s_and_b32 s6, s5, 3
    s_and_b32 s40, s2, 6
    s_lshl1_add_u32 s6, s40, s6
    s_lshl4_add_u32 s36, s6, s7
    s_lshl4_add_u32 s44, s35, s7
    s_cmp_lt_u32 s4, 2
    s_cselect_b32 s55, 1, 0
    s_cmp_eq_u32 s1, 15
    s_cselect_b32 s55, 0, s55
    s_cmp_lt_u32 s5, 28
    s_cselect_b32 s55, 1, s55
    s_cmp_eq_u32 s35, 0
    s_cselect_b32 s55, 1, 0
    s_cmp_lt_u32 s7, 10
    s_cselect_b32 s55, 0, s55
    s_cmp_eq_u32 s96, 6
    s_cbranch_scc1 L_SETR6
    s_cmp_eq_u32 s96, 7
    s_cbranch_scc1 L_SETR7
L_SETV:
    v_and_b32 v18, 31, v2
    v_lshrrev_b32 v19, 5, v2
    v_lshl_add_u32 v9, v18, 4, s51
    v_mul_u32_u24 v10, 6144, v19
    v_add_u32 v3, v9, v10
    s_add_u32 s54, s47, 12288
    v_add_u32 v9, s54, v9
    s_add_u32 s54, s50, 155968
    v_mov_b32 v10, s54
    v_cmp_eq_u32 vcc, 1, v19
    s_nop 1
    v_cndmask_b32 v4, v9, v10, vcc
    v_bfe_u32 v9, v2, 2, 2
    v_lshl_add_u32 v9, v19, 2, v9
    v_lshl_add_u32 v9, v9, 4, s51
    v_bfe_u32 v10, v2, 1, 1
    v_mul_u32_u24 v10, 6208, v10
    v_and_b32 v11, 1, v2
    v_lshl_add_u32 v10, v11, 3, v10
    v_add_u32 v10, 18432, v10
    v_add_u32 v10, v9, v10
    s_add_u32 s54, s47, 30848
    v_add_u32 v9, s54, v9
    v_mov_b32 v11, 155904
    v_and_b32 v5, 3, v2
    v_cmp_eq_u32 vcc, 0, v5
    s_nop 1
    v_cndmask_b32 v9, v11, v9, vcc
    v_and_b32 v5, 16, v2
    v_cmp_eq_u32 vcc, 0, v5
    s_nop 1
    v_cndmask_b32 v5, v9, v10, vcc
    v_lshlrev_b32 v9, 2, v19
    v_sub_u32 v9, v9, v18
    v_add_u32 v9, 31, v9
    v_and_b32 v10, 3, v9
    v_mul_u32_u24 v10, 412, v10
    v_lshl_add_u32 v9, v9, 2, v10
    v_add_u32 v6, 162048, v9
    v_add_u32 v9, s49, v18
    v_lshlrev_b32 v129, 4, v9
    v_lshl_add_u32 v128, v19, 15, v129
    v_lshlrev_b32 v130, 4, v2
    v_add_u32 v131, 2621440, v130
    v_lshl_add_u32 v132, v2, 11, s59
    s_cmp_eq_u32 s96, 2
    s_cbranch_scc1 L_SETR2
    s_cmp_eq_u32 s96, 3
    s_cbranch_scc1 L_SETR3
    s_cmp_eq_u32 s96, 5
    s_cbranch_scc1 L_SETR5
    s_branch L_SETR4
L_ATT:
    s_cmp_lg_u32 s34, 3
    s_cbranch_scc1 L_aw_31
    s_mov_b32 s60, 0
L_sp_33:
    s_add_u32 s60, s60, 1
    s_cmp_gt_u32 s60, 1600000
    s_cbranch_scc1 L_spd_34
    s_buffer_load_dwordx16 s[64:79], s[16:19], s14 glc
    s_buffer_load_dwordx16 s[80:95], s[16:19], s14 offset:128 glc
    s_cmp_lg_u32 s96, 4
    s_cbranch_scc1 L_zf_37
    s_mov_b32 s96, 0
    s_waitcnt vmcnt(0)
    s_mov_b64 exec, 0xffffff
    v_mov_b32 v22, s32
    v_mov_b32 v23, s33
    buffer_store_dwordx2 v[22:23], v21, s[16:19], 0 offen sc1
    s_mov_b64 exec, -1
L_zf_37:
    s_waitcnt lgkmcnt(0)
L_spc_35:
    s_and_b64 s[40:41], s[64:65], s[32:33]
    s_or_b64 s[42:43], s[64:65], s[32:33]
    s_and_b64 s[40:41], s[40:41], s[68:69]
    s_or_b64 s[42:43], s[42:43], s[68:69]
    s_and_b64 s[40:41], s[40:41], s[72:73]
    s_or_b64 s[42:43], s[42:43], s[72:73]
    s_and_b64 s[40:41], s[40:41], s[76:77]
    s_or_b64 s[42:43], s[42:43], s[76:77]
    s_cmp_lg_u64 s[40:41], s[42:43]
    s_cbranch_scc1 L_sp_33
    s_cmp_eq_u32 s13, 0
    s_cbranch_scc1 L_spd_34
    s_and_b64 s[40:41], s[66:67], s[32:33]
    s_or_b64 s[42:43], s[66:67], s[32:33]
    s_and_b64 s[40:41], s[40:41], s[70:71]
    s_or_b64 s[42:43], s[42:43], s[70:71]
    s_and_b64 s[40:41], s[40:41], s[74:75]
    s_or_b64 s[42:43], s[42:43], s[74:75]
    s_and_b64 s[40:41], s[40:41], s[78:79]
    s_or_b64 s[42:43], s[42:43], s[78:79]
    s_cmp_lg_u64 s[40:41], s[42:43]
    s_cbranch_scc1 L_sp_33
L_spd_34:
    v_mov_b32 v9, s52
    v_mov_b32 v10, 1
    s_mov_b64 exec, 1
    ds_add_u32 v9, v10
    s_mov_b64 exec, -1
    buffer_load_dwordx4 v[12:15], v128, s[16:19], s61 offen sc1
    buffer_load_dwordx2 v[16:17], v129, s[16:19], s62 offen sc1
    s_mov_b32 s60, 0
    s_branch L_spc_40
L_sp_38:
    s_add_u32 s60, s60, 1
    s_cmp_gt_u32 s60, 1600000
    s_cbranch_scc1 L_spd_39
    s_buffer_load_dwordx16 s[64:79], s[16:19], s14 glc
    s_buffer_load_dwordx16 s[80:95], s[16:19], s14 offset:128 glc
    s_waitcnt lgkmcnt(0)
L_spc_40:
    s_and_b64 s[40:41], s[80:81], s[32:33]
    s_or_b64 s[42:43], s[80:81], s[32:33]
    s_and_b64 s[40:41], s[40:41], s[84:85]
    s_or_b64 s[42:43], s[42:43], s[84:85]
    s_and_b64 s[40:41], s[40:41], s[88:89]
    s_or_b64 s[42:43], s[42:43], s[88:89]
    s_cmp_lg_u64 s[40:41], s[42:43]
    s_cbranch_scc1 L_sp_38
    s_cmp_eq_u32 s13, 0
    s_cbranch_scc1 L_spd_39
    s_and_b64 s[40:41], s[82:83], s[32:33]
    s_or_b64 s[42:43], s[82:83], s[32:33]
    s_and_b64 s[40:41], s[40:41], s[86:87]
    s_or_b64 s[42:43], s[42:43], s[86:87]
    s_and_b64 s[40:41], s[40:41], s[90:91]
    s_or_b64 s[42:43], s[42:43], s[90:91]
    s_cmp_lg_u64 s[40:41], s[42:43]
    s_cbranch_scc1 L_sp_38
L_spd_39:
    v_mov_b32 v9, s52
    s_mov_b32 s60, 0
L_lw_42:
    ds_read_b32 v10, v9
    s_add_u32 s60, s60, 1
    s_waitcnt lgkmcnt(0)
    v_readfirstlane_b32 s40, v10
    s_cmp_gt_u32 s60, 1600000
    s_cbranch_scc1 L_lwd_43
    s_cmp_lt_u32 s40, 4
    s_cbranch_scc1 L_lw_42
L_lwd_43:
    s_sub_u32 s53, s45, s46
    s_lshl_b32 s53, s53, 15
    v_add_u32 v10, s53, v131
    v_add_u32 v11, 32768, v10
    s_add_u32 m0, s48, 22528
    s_nop 0
    buffer_load_dwordx4 v10, s[16:19], s10 offen offset:0 sc1 lds
    buffer_load_dwordx4 v10, s[16:19], s10 offen offset:1024 sc1 lds
    s_add_u32 m0, s48, 28736
    s_nop 0
    buffer_load_dwordx4 v11, s[16:19], s10 offen offset:0 sc1 lds
    buffer_load_dwordx4 v11, s[16:19], s10 offen offset:1024 sc1 lds
    s_add_u32 m0, s48, 34944
    s_nop 0
    buffer_load_dwordx4 v131, s[16:19], s10 offen offset:0 sc1 lds
    buffer_load_dwordx4 v131, s[16:19], s10 offen offset:1024 sc1 lds
    s_add_u32 m0, s48, 20480
    s_nop 0
    buffer_load_dwordx4 v10, s[16:19], s9 offen offset:0 sc1 lds
    buffer_load_dwordx4 v10, s[16:19], s9 offen offset:1024 sc1 lds
    s_add_u32 m0, s48, 26688
    s_nop 0
    buffer_load_dwordx4 v11, s[16:19], s9 offen offset:0 sc1 lds
    buffer_load_dwordx4 v11, s[16:19], s9 offen offset:1024 sc1 lds
    s_add_u32 m0, s48, 32896
    s_nop 0
    buffer_load_dwordx4 v131, s[16:19], s9 offen offset:0 sc1 lds
    buffer_load_dwordx4 v131, s[16:19], s9 offen offset:1024 sc1 lds
    s_add_u32 m0, s48, 18432
    s_nop 0
    buffer_load_dwordx4 v10, s[16:19], s8 offen offset:0 sc1 lds
    buffer_load_dwordx4 v10, s[16:19], s8 offen offset:1024 sc1 lds
    s_add_u32 m0, s48, 24640
    s_nop 0
    buffer_load_dwordx4 v11, s[16:19], s8 offen offset:0 sc1 lds
    buffer_load_dwordx4 v11, s[16:19], s8 offen offset:1024 sc1 lds
    s_add_u32 m0, s48, 30848
    s_nop 0
    buffer_load_dwordx4 v131, s[16:19], s8 offen offset:0 sc1 lds
    buffer_load_dwordx4 v131, s[16:19], s8 offen offset:1024 sc1 lds
    s_branch L_ag_32
L_aw_31:
    v_mov_b32 v9, s15
    s_mov_b32 s60, 0
L_lw_44:
    ds_read_b32 v10, v9
    s_add_u32 s60, s60, 1
    s_waitcnt lgkmcnt(0)
    v_readfirstlane_b32 s40, v10
    s_cmp_gt_u32 s60, 1600000
    s_cbranch_scc1 L_lwd_45
    s_cmp_lt_u32 s40, 4
    s_cbranch_scc1 L_lw_44
L_lwd_45:
    v_mov_b32 v9, s52
    s_mov_b32 s60, 0
L_lw_46:
    ds_read_b32 v10, v9
    s_add_u32 s60, s60, 1
    s_waitcnt lgkmcnt(0)
    v_readfirstlane_b32 s40, v10
    s_cmp_gt_u32 s60, 1600000
    s_cbranch_scc1 L_lwd_47
    s_cmp_lt_u32 s40, 1
    s_cbranch_scc1 L_lw_46
L_lwd_47:
    s_add_u32 m0, s11, 4096
    s_nop 0
    buffer_load_dwordx4 v130, s[16:19], s10 offen offset:0 sc1 lds
    buffer_load_dwordx4 v130, s[16:19], s10 offen offset:1024 sc1 lds
    s_add_u32 m0, s11, 2048
    s_nop 0
    buffer_load_dwordx4 v130, s[16:19], s9 offen offset:0 sc1 lds
    buffer_load_dwordx4 v130, s[16:19], s9 offen offset:1024 sc1 lds
    buffer_load_dwordx4 v[12:15], v128, s[16:19], s61 offen sc1
    buffer_load_dwordx2 v[16:17], v129, s[16:19], s62 offen sc1
    v_mov_b32 v9, s52
    v_mov_b32 v10, 1
    s_mov_b64 exec, 1
    ds_add_u32 v9, v10
    s_mov_b64 exec, -1
    s_add_u32 m0, s11, 0
    s_nop 0
    buffer_load_dwordx4 v130, s[16:19], s8 offen offset:0 sc1 lds
    buffer_load_dwordx4 v130, s[16:19], s8 offen offset:1024 sc1 lds
L_ag_32:
    s_setprio 2
    s_cmp_eq_u32 s35, 1
    s_cbranch_scc1 L_cq_48
    s_setprio 3
    s_cmp_ge_u32 s7, 10
    s_cbranch_scc1 L_CG2
L_CG2R:
L_cq_48:
    s_add_u32 s52, s52, 4
    s_waitcnt vmcnt(18)
    s_cmp_eq_u32 s34, 3
    s_cbranch_scc1 L_KW
    s_waitcnt vmcnt(2)
L_cq_49:
    v_mov_b32 v9, s52
    v_mov_b32 v10, 1
    s_mov_b64 exec, 1
    ds_add_u32 v9, v10
    s_mov_b64 exec, -1
L_KW:
    ds_read_b128 v[80:83], v6 offset:0
    ds_read_b128 v[84:87], v6 offset:32
    ds_read_b128 v[88:91], v6 offset:64
    ds_read_b128 v[92:95], v6 offset:96
    s_mov_b32 exec_lo, 0
    v_mov_b32 v16, 0
    v_mov_b32 v17, 0x3f800000
    s_mov_b32 exec_lo, -1
    v_mov_b32 v7, 0xf149f2ca
    v_mov_b32 v8, 0xf149f2ca
    v_mov_b32 v134, s52
    v_mov_b32 v135, 1
    s_mov_b32 s63, 0
    v_mov_b32 v10, 0
    v_mov_b32 v11, 0
    v_mov_b32 v32, s52
    s_mov_b32 s60, 0
L_lw_51:
    ds_read_b32 v33, v32
    s_add_u32 s60, s60, 1
    s_waitcnt lgkmcnt(0)
    v_readfirstlane_b32 s40, v33
    s_cmp_gt_u32 s60, 1600000
    s_cbranch_scc1 L_lwd_52
    s_cmp_lt_u32 s40, 3
    s_cbranch_scc1 L_lw_51
L_lwd_52:
    ds_read_b128 v[20:23], v3 offset:4096
    ds_read_b64 v[24:25], v4 offset:4096
    ds_read_b128 v[26:29], v3 offset:3584
    ds_read_b64 v[30:31], v4 offset:3584
    s_waitcnt lgkmcnt(2)
    v_mfma_f32_32x32x16_bf16 v[48:63], v[20:23], v[12:15], v[80:95]
    v_mfma_f32_32x32x8bf16_1k v[48:63], v[24:25], v[16:17], v[48:63]
    s_waitcnt lgkmcnt(0)
    v_mfma_f32_32x32x16_bf16 v[64:79], v[26:29], v[12:15], 0
    ds_read_b128 v[20:23], v3 offset:3072
    ds_read_b64 v[24:25], v4 offset:3072
    v_mfma_f32_32x32x8bf16_1k v[64:79], v[30:31], v[16:17], v[64:79]
    s_nop 6
    v_max3_f32 v7, v7, v48, v49
    v_max3_f32 v8, v8, v50, v51
    v_max3_f32 v7, v7, v52, v53
    v_max3_f32 v8, v8, v54, v55
    v_max3_f32 v7, v7, v56, v57
    v_max3_f32 v8, v8, v58, v59
    v_max3_f32 v7, v7, v60, v61
    v_max3_f32 v8, v8, v62, v63
    v_max3_f32 v7, v7, v64, v65
    v_max3_f32 v8, v8, v66, v67
    v_max3_f32 v7, v7, v68, v69
    v_max3_f32 v8, v8, v70, v71
    v_max3_f32 v7, v7, v72, v73
    v_max3_f32 v8, v8, v74, v75
    v_max3_f32 v7, v7, v76, v77
    v_max3_f32 v8, v8, v78, v79
    v_max_f32 v7, v7, v8
    v_mov_b32 v8, v7
    s_nop 1
    v_permlane32_swap_b32 v7, v8
    s_nop 0
    v_max_f32 v7, v7, v8
    v_sub_f32 v7, 0xc2200000, v7
    v_and_b32 v7, 0xffff0000, v7
    s_mov_b32 exec_lo, 0
    v_mov_b32 v10, v7
    v_mov_b32 v16, v7
    s_mov_b32 exec_lo, -1
L_P2:
    v_add_f32 v48, v7, v48
    v_mfma_f32_32x32x8bf16_1k v[64:79], v[30:31], v[10:11], v[64:79]
    ds_read_b128 v[26:29], v3 offset:2560
    ds_read_b64 v[30:31], v4 offset:2560
    v_add_f32 v49, v7, v49
    v_add_f32 v50, v7, v50
    v_add_f32 v51, v7, v51
    v_add_f32 v52, v7, v52
    v_add_f32 v53, v7, v53
    v_add_f32 v54, v7, v54
    v_add_f32 v55, v7, v55
    v_add_f32 v56, v7, v56
    v_add_f32 v57, v7, v57
    v_add_f32 v58, v7, v58
    v_add_f32 v59, v7, v59
    v_add_f32 v60, v7, v60
    v_add_f32 v61, v7, v61
    v_add_f32 v62, v7, v62
    v_add_f32 v63, v7, v63
    v_exp_f32 v48, v48
    v_exp_f32 v49, v49
    v_exp_f32 v50, v50
    v_exp_f32 v51, v51
    v_exp_f32 v52, v52
    s_waitcnt vmcnt(0)
    s_mov_b64 exec, 1
    ds_add_u32 v134, v135 offset:4
    s_mov_b64 exec, -1
    v_exp_f32 v53, v53
    v_exp_f32 v54, v54
    v_exp_f32 v55, v55
    v_exp_f32 v56, v56
    v_cvt_pk_bf16_f32 v96, v48, v49
    v_cvt_pk_bf16_f32 v97, v50, v51
    v_cvt_pk_bf16_f32 v98, v52, v53
    v_cvt_pk_bf16_f32 v99, v54, v55
    v_exp_f32 v57, v57
    v_exp_f32 v58, v58
    v_exp_f32 v59, v59
    ds_read_b32 v9, v134 offset:4
    v_exp_f32 v60, v60
    v_exp_f32 v61, v61
    v_exp_f32 v62, v62
    v_exp_f32 v63, v63
    v_cvt_pk_bf16_f32 v100, v56, v57
    v_cvt_pk_bf16_f32 v101, v58, v59
    v_cvt_pk_bf16_f32 v102, v60, v61
    v_cvt_pk_bf16_f32 v103, v62, v63
    s_waitcnt lgkmcnt(4)
    v_mfma_f32_32x32x16_bf16 v[48:63], v[20:23], v[12:15], 0
    s_waitcnt lgkmcnt(0)
    v_readfirstlane_b32 s40, v9
    s_add_u32 s53, s52, 4
    s_cmp_ge_u32 s40, 4
    s_cbranch_scc1 L_vl_53
    v_mov_b32 v8, s53
    s_mov_b32 s60, 0
L_lw_54:
    ds_read_b32 v9, v8
    s_add_u32 s60, s60, 1
    s_waitcnt lgkmcnt(0)
    v_readfirstlane_b32 s40, v9
    s_cmp_gt_u32 s60, 1600000
    s_cbranch_scc1 L_lwd_55
    s_cmp_lt_u32 s40, 4
    s_cbranch_scc1 L_lw_54
L_lwd_55:
L_vl_53:
    ds_read_b64_tr_b16 v[32:33], v5 offset:4096
    ds_read_b64_tr_b16 v[34:35], v5 offset:4224
    ds_read_b64_tr_b16 v[36:37], v5 offset:4352
    ds_read_b64_tr_b16 v[38:39], v5 offset:4480
    ds_read_b64_tr_b16 v[40:41], v5 offset:3584
    ds_read_b64_tr_b16 v[42:43], v5 offset:3712
    v_exp_f32 v64, v64
    v_exp_f32 v65, v65
    v_exp_f32 v66, v66
    v_exp_f32 v67, v67
    v_mfma_f32_32x32x8bf16_1k v[48:63], v[24:25], v[16:17], v[48:63]
    ds_read_b128 v[20:23], v3 offset:2048
    ds_read_b64 v[24:25], v4 offset:2048
    v_exp_f32 v68, v68
    v_exp_f32 v69, v69
    v_exp_f32 v70, v70
    v_exp_f32 v71, v71
    s_waitcnt lgkmcnt(4)
    v_mfma_f32_32x32x16_bf16 v[112:127], v[32:35], v[96:99], 0
    ds_read_b64_tr_b16 v[44:45], v5 offset:3840
    v_exp_f32 v72, v72
    v_cvt_pk_bf16_f32 v104, v64, v65
    v_cvt_pk_bf16_f32 v105, v66, v67
    v_cvt_pk_bf16_f32 v106, v68, v69
    v_cvt_pk_bf16_f32 v107, v70, v71
    v_exp_f32 v73, v73
    v_exp_f32 v74, v74
    v_exp_f32 v75, v75
    v_mfma_f32_32x32x16_bf16 v[112:127], v[36:39], v[100:103], v[112:127]
    ds_read_b64_tr_b16 v[46:47], v5 offset:3968
    v_exp_f32 v76, v76
    v_exp_f32 v77, v77
    v_exp_f32 v78, v78
    v_exp_f32 v79, v79
    v_cvt_pk_bf16_f32 v108, v72, v73
    v_cvt_pk_bf16_f32 v109, v74, v75
    v_cvt_pk_bf16_f32 v110, v76, v77
    v_cvt_pk_bf16_f32 v111, v78, v79
    v_mfma_f32_32x32x16_bf16 v[64:79], v[26:29], v[12:15], 0
    ds_read_b64_tr_b16 v[32:33], v5 offset:3072
    ds_read_b64_tr_b16 v[34:35], v5 offset:3200
    v_exp_f32 v48, v48
    v_exp_f32 v49, v49
    v_exp_f32 v50, v50
    v_exp_f32 v51, v51
    v_mfma_f32_32x32x8bf16_1k v[64:79], v[30:31], v[16:17], v[64:79]
    s_waitcnt lgkmcnt(2)
    ds_read_b128 v[26:29], v3 offset:1536
    ds_read_b64 v[30:31], v4 offset:1536
    v_exp_f32 v52, v52
    v_exp_f32 v53, v53
    v_exp_f32 v54, v54
    v_exp_f32 v55, v55
    v_mfma_f32_32x32x16_bf16 v[112:127], v[40:43], v[104:107], v[112:127]
    ds_read_b64_tr_b16 v[36:37], v5 offset:3328
    v_exp_f32 v56, v56
    v_cvt_pk_bf16_f32 v96, v48, v49
    v_cvt_pk_bf16_f32 v97, v50, v51
    v_cvt_pk_bf16_f32 v98, v52, v53
    v_cvt_pk_bf16_f32 v99, v54, v55
    v_exp_f32 v57, v57
    v_exp_f32 v58, v58
    v_exp_f32 v59, v59
    v_mfma_f32_32x32x16_bf16 v[112:127], v[44:47], v[108:111], v[112:127]
    ds_read_b64_tr_b16 v[38:39], v5 offset:3456
    v_exp_f32 v60, v60
    v_exp_f32 v61, v61
    v_exp_f32 v62, v62
    v_exp_f32 v63, v63
    v_cvt_pk_bf16_f32 v100, v56, v57
    v_cvt_pk_bf16_f32 v101, v58, v59
    v_cvt_pk_bf16_f32 v102, v60, v61
    v_cvt_pk_bf16_f32 v103, v62, v63
    v_mfma_f32_32x32x16_bf16 v[48:63], v[20:23], v[12:15], 0
    ds_read_b64_tr_b16 v[40:41], v5 offset:2560
    ds_read_b64_tr_b16 v[42:43], v5 offset:2688
    v_exp_f32 v64, v64
    v_exp_f32 v65, v65
    v_exp_f32 v66, v66
    v_exp_f32 v67, v67
    v_mfma_f32_32x32x8bf16_1k v[48:63], v[24:25], v[16:17], v[48:63]
    s_waitcnt lgkmcnt(2)
    ds_read_b128 v[20:23], v3 offset:1024
    ds_read_b64 v[24:25], v4 offset:1024
    v_exp_f32 v68, v68
    v_exp_f32 v69, v69
    v_exp_f32 v70, v70
    v_exp_f32 v71, v71
    v_mfma_f32_32x32x16_bf16 v[112:127], v[32:35], v[96:99], v[112:127]
    ds_read_b64_tr_b16 v[44:45], v5 offset:2816
    ds_read_b128 v[80:83], v6 offset:128
    v_exp_f32 v72, v72
    v_cvt_pk_bf16_f32 v104, v64, v65
    v_cvt_pk_bf16_f32 v105, v66, v67
    v_cvt_pk_bf16_f32 v106, v68, v69
    v_cvt_pk_bf16_f32 v107, v70, v71
    v_exp_f32 v73, v73
    v_exp_f32 v74, v74
    v_exp_f32 v75, v75
    v_mfma_f32_32x32x16_bf16 v[112:127], v[36:39], v[100:103], v[112:127]
    ds_read_b64_tr_b16 v[46:47], v5 offset:2944
    ds_read_b128 v[84:87], v6 offset:160
    v_exp_f32 v76, v76
    v_exp_f32 v77, v77
    v_exp_f32 v78, v78
    v_exp_f32 v79, v79
    v_cvt_pk_bf16_f32 v108, v72, v73
    v_cvt_pk_bf16_f32 v109, v74, v75
    v_cvt_pk_bf16_f32 v110, v76, v77
    v_cvt_pk_bf16_f32 v111, v78, v79
    s_cmp_eq_u32 s56, 0
    s_cbranch_scc1 L_SHORT
    v_mfma_f32_32x32x16_bf16 v[64:79], v[26:29], v[12:15], 0
    ds_read_b64_tr_b16 v[32:33], v5 offset:2048
    ds_read_b64_tr_b16 v[34:35], v5 offset:2176
    v_exp_f32 v48, v48
    v_exp_f32 v49, v49
    v_exp_f32 v50, v50
    v_exp_f32 v51, v51
    v_mfma_f32_32x32x8bf16_1k v[64:79], v[30:31], v[16:17], v[64:79]
    s_waitcnt lgkmcnt(2)
    ds_read_b128 v[26:29], v3 offset:512
    ds_read_b64 v[30:31], v4 offset:512
    v_exp_f32 v52, v52
    v_exp_f32 v53, v53
    v_exp_f32 v54, v54
    v_exp_f32 v55, v55
    v_mfma_f32_32x32x16_bf16 v[112:127], v[40:43], v[104:107], v[112:127]
    ds_read_b64_tr_b16 v[36:37], v5 offset:2304
    ds_read_b128 v[88:91], v6 offset:192
    v_exp_f32 v56, v56
    v_cvt_pk_bf16_f32 v96, v48, v49
    v_cvt_pk_bf16_f32 v97, v50, v51
    v_cvt_pk_bf16_f32 v98, v52, v53
    v_cvt_pk_bf16_f32 v99, v54, v55
    v_exp_f32 v57, v57
    v_exp_f32 v58, v58
    v_exp_f32 v59, v59
    v_mfma_f32_32x32x16_bf16 v[112:127], v[44:47], v[108:111], v[112:127]
    ds_read_b64_tr_b16 v[38:39], v5 offset:2432
    ds_read_b128 v[92:95], v6 offset:224
    v_exp_f32 v60, v60
    v_exp_f32 v61, v61
    v_exp_f32 v62, v62
    v_exp_f32 v63, v63
    v_cvt_pk_bf16_f32 v100, v56, v57
    v_cvt_pk_bf16_f32 v101, v58, v59
    v_cvt_pk_bf16_f32 v102, v60, v61
    v_cvt_pk_bf16_f32 v103, v62, v63
    v_mfma_f32_32x32x16_bf16 v[48:63], v[20:23], v[12:15], 0
    ds_read_b64_tr_b16 v[40:41], v5 offset:1536
    ds_read_b64_tr_b16 v[42:43], v5 offset:1664
    v_exp_f32 v64, v64
    v_exp_f32 v65, v65
    v_exp_f32 v66, v66
    v_exp_f32 v67, v67
    v_mfma_f32_32x32x8bf16_1k v[48:63], v[24:25], v[16:17], v[48:63]
    s_waitcnt lgkmcnt(2)
    ds_read_b128 v[20:23], v3 offset:0
    ds_read_b64 v[24:25], v4 offset:0
    v_exp_f32 v68, v68
    v_exp_f32 v69, v69
    v_exp_f32 v70, v70
    v_exp_f32 v71, v71
    v_mfma_f32_32x32x16_bf16 v[112:127], v[32:35], v[96:99], v[112:127]
    ds_read_b64_tr_b16 v[44:45], v5 offset:1792
    v_exp_f32 v72, v72
    v_cvt_pk_bf16_f32 v104, v64, v65
    v_cvt_pk_bf16_f32 v105, v66, v67
    v_cvt_pk_bf16_f32 v106, v68, v69
    v_cvt_pk_bf16_f32 v107, v70, v71
    v_exp_f32 v73, v73
    v_exp_f32 v74, v74
    v_exp_f32 v75, v75
    v_mfma_f32_32x32x16_bf16 v[112:127], v[36:39], v[100:103], v[112:127]
    ds_read_b64_tr_b16 v[46:47], v5 offset:1920
    v_exp_f32 v76, v76
    v_exp_f32 v77, v77
    v_exp_f32 v78, v78
    v_exp_f32 v79, v79
    v_cvt_pk_bf16_f32 v108, v72, v73
    v_cvt_pk_bf16_f32 v109, v74, v75
    v_cvt_pk_bf16_f32 v110, v76, v77
    v_cvt_pk_bf16_f32 v111, v78, v79
    v_mfma_f32_32x32x16_bf16 v[64:79], v[26:29], v[12:15], 0
    ds_read_b64_tr_b16 v[32:33], v5 offset:1024
    ds_read_b64_tr_b16 v[34:35], v5 offset:1152
    v_exp_f32 v48, v48
    v_exp_f32 v49, v49
    v_exp_f32 v50, v50
    v_exp_f32 v51, v51
    v_mfma_f32_32x32x8bf16_1k v[64:79], v[30:31], v[16:17], v[64:79]
    s_waitcnt lgkmcnt(2)
    v_exp_f32 v52, v52
    v_exp_f32 v53, v53
    v_exp_f32 v54, v54
    v_exp_f32 v55, v55
    v_mfma_f32_32x32x16_bf16 v[112:127], v[40:43], v[104:107], v[112:127]
    ds_read_b64_tr_b16 v[36:37], v5 offset:1280
    v_exp_f32 v56, v56
    v_cvt_pk_bf16_f32 v96, v48, v49
    v_cvt_pk_bf16_f32 v97, v50, v51
    v_cvt_pk_bf16_f32 v98, v52, v53
    v_cvt_pk_bf16_f32 v99, v54, v55
    v_exp_f32 v57, v57
    v_exp_f32 v58, v58
    v_exp_f32 v59, v59
    v_mfma_f32_32x32x16_bf16 v[112:127], v[44:47], v[108:111], v[112:127]
    ds_read_b64_tr_b16 v[38:39], v5 offset:1408
    v_exp_f32 v60, v60
    v_exp_f32 v61, v61
    v_exp_f32 v62, v62
    v_exp_f32 v63, v63
    v_cvt_pk_bf16_f32 v100, v56, v57
    v_cvt_pk_bf16_f32 v101, v58, v59
    v_cvt_pk_bf16_f32 v102, v60, v61
    v_cvt_pk_bf16_f32 v103, v62, v63
    v_mfma_f32_32x32x16_bf16 v[48:63], v[20:23], v[12:15], v[80:95]
    ds_read_b64_tr_b16 v[40:41], v5 offset:512
    ds_read_b64_tr_b16 v[42:43], v5 offset:640
    v_exp_f32 v64, v64
    v_exp_f32 v65, v65
    v_exp_f32 v66, v66
    v_exp_f32 v67, v67
    v_mfma_f32_32x32x8bf16_1k v[48:63], v[24:25], v[16:17], v[48:63]
    s_waitcnt lgkmcnt(2)
    v_exp_f32 v68, v68
    v_exp_f32 v69, v69
    v_exp_f32 v70, v70
    v_exp_f32 v71, v71
    v_mfma_f32_32x32x16_bf16 v[112:127], v[32:35], v[96:99], v[112:127]
    ds_read_b64_tr_b16 v[44:45], v5 offset:768
    v_exp_f32 v72, v72
    v_cvt_pk_bf16_f32 v104, v64, v65
    v_cvt_pk_bf16_f32 v105, v66, v67
    v_cvt_pk_bf16_f32 v106, v68, v69
    v_cvt_pk_bf16_f32 v107, v70, v71
    v_exp_f32 v73, v73
    v_exp_f32 v74, v74
    v_exp_f32 v75, v75
    v_mfma_f32_32x32x16_bf16 v[112:127], v[36:39], v[100:103], v[112:127]
    ds_read_b64_tr_b16 v[46:47], v5 offset:896
    v_exp_f32 v76, v76
    v_exp_f32 v77, v77
    v_exp_f32 v78, v78
    v_exp_f32 v79, v79
    v_cvt_pk_bf16_f32 v108, v72, v73
    v_cvt_pk_bf16_f32 v109, v74, v75
    v_cvt_pk_bf16_f32 v110, v76, v77
    v_cvt_pk_bf16_f32 v111, v78, v79
    v_exp_f32 v48, v48
    v_exp_f32 v49, v49
    s_waitcnt lgkmcnt(0)
    v_mfma_f32_32x32x16_bf16 v[112:127], v[40:43], v[104:107], v[112:127]
    ds_read_b64_tr_b16 v[32:33], v5 offset:0
    ds_read_b64_tr_b16 v[34:35], v5 offset:128
    ds_read_b64_tr_b16 v[36:37], v5 offset:256
    ds_read_b64_tr_b16 v[38:39], v5 offset:384
    v_exp_f32 v50, v50
    v_exp_f32 v51, v51
    v_exp_f32 v52, v52
    v_exp_f32 v53, v53
    v_mfma_f32_32x32x16_bf16 v[112:127], v[44:47], v[108:111], v[112:127]
    v_exp_f32 v54, v54
    v_exp_f32 v55, v55
    v_exp_f32 v56, v56
    v_cvt_pk_bf16_f32 v96, v48, v49
    v_cvt_pk_bf16_f32 v97, v50, v51
    v_cvt_pk_bf16_f32 v98, v52, v53
    v_cvt_pk_bf16_f32 v99, v54, v55
    v_exp_f32 v57, v57
    v_exp_f32 v58, v58
    v_exp_f32 v59, v59
    s_waitcnt lgkmcnt(0)
    v_mfma_f32_32x32x16_bf16 v[112:127], v[32:35], v[96:99], v[112:127]
    v_exp_f32 v60, v60
    v_exp_f32 v61, v61
    v_exp_f32 v62, v62
    v_exp_f32 v63, v63
    v_cvt_pk_bf16_f32 v100, v56, v57
    v_cvt_pk_bf16_f32 v101, v58, v59
    v_cvt_pk_bf16_f32 v102, v60, v61
    v_cvt_pk_bf16_f32 v103, v62, v63
    s_nop 1
    v_mfma_f32_32x32x16_bf16 v[112:127], v[36:39], v[100:103], v[112:127]
L_PVD:
    v_lshrrev_b32 v19, 1, v129
    s_nop 10
    v_rcp_f32 v10, v124
    v_max3_f32 v11, abs(v112), abs(v113), abs(v114)
    v_max3_f32 v8, abs(v115), abs(v116), abs(v117)
    v_max3_f32 v11, v11, abs(v118), abs(v119)
    v_max3_f32 v8, v8, abs(v120), abs(v121)
    v_max3_f32 v11, v11, abs(v122), abs(v123)
    v_max3_f32 v11, v11, v8, v10
    v_cmp_ngt_f32 vcc, 0x67800000, v11
    v_mul_f32 v112, v10, v112
    v_mul_f32 v113, v10, v113
    v_mul_f32 v114, v10, v114
    v_mul_f32 v115, v10, v115
    v_mul_f32 v116, v10, v116
    v_mul_f32 v117, v10, v117
    v_mul_f32 v118, v10, v118
    v_mul_f32 v119, v10, v119
    v_mul_f32 v120, v10, v120
    v_mul_f32 v121, v10, v121
    v_mul_f32 v122, v10, v122
    v_mul_f32 v123, v10, v123
    s_cbranch_vccz L_P3
    s_cmp_eq_u32 s63, 0
    s_cbranch_scc1 L_EXACT
L_P3:
    v_cvt_pk_bf16_f32 v96, v112, v113
    v_cvt_pk_bf16_f32 v97, v114, v115
    v_cvt_pk_bf16_f32 v98, v116, v117
    v_cvt_pk_bf16_f32 v99, v118, v119
    v_cvt_pk_bf16_f32 v100, v120, v121
    v_cvt_pk_bf16_f32 v101, v122, v123
    buffer_store_dwordx4 v[96:99], v128, s[16:19], s57 offen sc1
    s_mov_b32 exec_hi, 0
    buffer_store_dwordx2 v[100:101], v19, s[16:19], s58 offen sc1
    s_cmp_eq_u32 s55, 1
    s_cbranch_scc1 L_A2
    s_setprio 0
    s_cmp_eq_u32 s35, 0
    s_cbranch_scc1 L_OPW
    s_mov_b64 exec, 0x3ff
    v_mov_b32 v10, s32
    v_mov_b32 v11, s33
    s_waitcnt vmcnt(0)
    buffer_store_dwordx2 v[10:11], v132, s[16:19], 0 offen sc1
    s_mov_b64 exec, -1
    s_cmp_eq_u32 s35, 0
    s_cbranch_scc1 L_OP
    s_cmp_ge_u32 s7, 10
    s_cbranch_scc1 L_A2C
    s_lshl2_add_u32 s30, s36, s34
    s_lshl_b32 s30, s30, 9
    s_add_u32 s30, s30, 15466496
    s_lshl2_add_u32 s31, s34, 163808
    v_mov_b32 v9, s31
    v_mov_b32 v10, 1
    s_mov_b64 exec, 1
    s_mov_b32 s60, 0
L_sp_56:
    s_add_u32 s60, s60, 1
    s_cmp_gt_u32 s60, 1600000
    s_cbranch_scc1 L_spd_57
    s_buffer_load_dwordx16 s[64:79], s[16:19], s30 glc
    s_buffer_load_dwordx16 s[80:95], s[16:19], s30 offset:128 glc
    s_waitcnt lgkmcnt(0)
L_spc_58:
    s_and_b64 s[40:41], s[64:65], s[32:33]
    s_or_b64 s[42:43], s[64:65], s[32:33]
    s_and_b64 s[40:41], s[40:41], s[66:67]
    s_or_b64 s[42:43], s[42:43], s[66:67]
    s_and_b64 s[40:41], s[40:41], s[68:69]
    s_or_b64 s[42:43], s[42:43], s[68:69]
    s_and_b64 s[40:41], s[40:41], s[70:71]
    s_or_b64 s[42:43], s[42:43], s[70:71]
    s_and_b64 s[40:41], s[40:41], s[72:73]
    s_or_b64 s[42:43], s[42:43], s[72:73]
    s_and_b64 s[40:41], s[40:41], s[74:75]
    s_or_b64 s[42:43], s[42:43], s[74:75]
    s_and_b64 s[40:41], s[40:41], s[76:77]
    s_or_b64 s[42:43], s[42:43], s[76:77]
    s_and_b64 s[40:41], s[40:41], s[78:79]
    s_or_b64 s[42:43], s[42:43], s[78:79]
    s_cmp_lg_u64 s[40:41], s[42:43]
    s_cbranch_scc1 L_sp_56
L_spd_57:
    ds_add_u32 v9, v10
    s_mov_b32 s60, 0
    s_branch L_spc_62
L_sp_60:
    s_add_u32 s60, s60, 1
    s_cmp_gt_u32 s60, 1600000
    s_cbranch_scc1 L_spd_61
    s_buffer_load_dwordx16 s[64:79], s[16:19], s30 glc
    s_buffer_load_dwordx16 s[80:95], s[16:19], s30 offset:128 glc
    s_waitcnt lgkmcnt(0)
L_spc_62:
    s_and_b64 s[40:41], s[80:81], s[32:33]
    s_or_b64 s[42:43], s[80:81], s[32:33]
    s_and_b64 s[40:41], s[40:41], s[82:83]
    s_or_b64 s[42:43], s[42:43], s[82:83]
    s_and_b64 s[40:41], s[40:41], s[84:85]
    s_or_b64 s[42:43], s[42:43], s[84:85]
    s_and_b64 s[40:41], s[40:41], s[86:87]
    s_or_b64 s[42:43], s[42:43], s[86:87]
    s_and_b64 s[40:41], s[40:41], s[88:89]
    s_or_b64 s[42:43], s[42:43], s[88:89]
    s_and_b64 s[40:41], s[40:41], s[90:91]
    s_or_b64 s[42:43], s[42:43], s[90:91]
    s_and_b64 s[40:41], s[40:41], s[92:93]
    s_or_b64 s[42:43], s[42:43], s[92:93]
    s_and_b64 s[40:41], s[40:41], s[94:95]
    s_or_b64 s[42:43], s[42:43], s[94:95]
    s_cmp_lg_u64 s[40:41], s[42:43]
    s_cbranch_scc1 L_sp_60
L_spd_61:
    ds_add_u32 v9, v10
    s_mov_b64 exec, -1
    s_branch L_FIN
L_A2:
    s_mov_b64 exec, -1
    v_mov_b32 v6, v130
    v_mov_b32 v12, v132
    v_mov_b32 v13, v133
    v_mov_b32 v10, s32
    v_mov_b32 v11, s33
    s_mov_b32 s60, 0
L_sp_66:
    s_add_u32 s60, s60, 1
    s_cmp_gt_u32 s60, 1600000
    s_cbranch_scc1 L_spd_67
    s_buffer_load_dwordx16 s[64:79], s[16:19], s37 glc
    s_buffer_load_dwordx16 s[80:95], s[16:19], s37 offset:128 glc
    s_cmp_lg_u32 s60, 1
    s_cbranch_scc1 L_zh_70
    s_mov_b64 exec, 0x3ff
    s_waitcnt vmcnt(0)
    buffer_store_dwordx2 v[10:11], v12, s[16:19], 0 offen sc1
    s_mov_b64 exec, -1
    s_setprio 3
    s_cmp_eq_u32 s35, 0
    s_cbranch_scc1 L_pr_71
    s_setprio 0
L_pr_71:
L_zh_70:
    s_waitcnt lgkmcnt(0)
L_spc_68:
    s_and_b64 s[40:41], s[64:65], s[32:33]
    s_or_b64 s[42:43], s[64:65], s[32:33]
    s_and_b64 s[40:41], s[40:41], s[66:67]
    s_or_b64 s[42:43], s[42:43], s[66:67]
    s_and_b64 s[40:41], s[40:41], s[68:69]
    s_or_b64 s[42:43], s[42:43], s[68:69]
    s_and_b64 s[40:41], s[40:41], s[70:71]
    s_or_b64 s[42:43], s[42:43], s[70:71]
    s_and_b64 s[40:41], s[40:41], s[72:73]
    s_or_b64 s[42:43], s[42:43], s[72:73]
    s_and_b64 s[40:41], s[40:41], s[74:75]
    s_or_b64 s[42:43], s[42:43], s[74:75]
    s_and_b64 s[40:41], s[40:41], s[76:77]
    s_or_b64 s[42:43], s[42:43], s[76:77]
    s_and_b64 s[40:41], s[40:41], s[78:79]
    s_or_b64 s[42:43], s[42:43], s[78:79]
    s_and_b64 s[40:41], s[40:41], s[80:81]
    s_or_b64 s[42:43], s[42:43], s[80:81]
    s_and_b64 s[40:41], s[40:41], s[82:83]
    s_or_b64 s[42:43], s[42:43], s[82:83]
    s_and_b64 s[40:41], s[40:41], s[84:85]
    s_or_b64 s[42:43], s[42:43], s[84:85]
    s_and_b64 s[40:41], s[40:41], s[86:87]
    s_or_b64 s[42:43], s[42:43], s[86:87]
    s_and_b64 s[40:41], s[40:41], s[88:89]
    s_or_b64 s[42:43], s[42:43], s[88:89]
    s_and_b64 s[40:41], s[40:41], s[90:91]
    s_or_b64 s[42:43], s[42:43], s[90:91]
    s_and_b64 s[40:41], s[40:41], s[92:93]
    s_or_b64 s[42:43], s[42:43], s[92:93]
    s_and_b64 s[40:41], s[40:41], s[94:95]
    s_or_b64 s[42:43], s[42:43], s[94:95]
    s_cmp_lg_u64 s[40:41], s[42:43]
    s_cbranch_scc1 L_sp_66
L_spd_67:
    buffer_load_dwordx4 v[96:99], v6, s[16:19], s28 offen offset:0 sc1
    buffer_load_dwordx4 v[100:103], v6, s[16:19], s28 offen offset:1024 sc1
    buffer_load_dwordx4 v[104:107], v6, s[16:19], s28 offen offset:2048 sc1
    buffer_load_dwordx4 v[108:111], v6, s[16:19], s28 offen offset:3072 sc1
    buffer_load_dwordx4 v[112:115], v6, s[16:19], s29 offen offset:0 sc1
    buffer_load_dwordx4 v[116:119], v6, s[16:19], s29 offen offset:1024 sc1
    buffer_load_dwordx4 v[120:123], v6, s[16:19], s29 offen offset:2048 sc1
    buffer_load_dwordx4 v[124:127], v6, s[16:19], s29 offen offset:3072 sc1
    buffer_load_dwordx2 v[128:129], v6, s[16:19], s30 offen offset:0 sc1
    buffer_load_dwordx2 v[130:131], v6, s[16:19], s30 offen offset:1024 sc1
    buffer_load_dwordx2 v[132:133], v6, s[16:19], s30 offen offset:2048 sc1
    buffer_load_dwordx2 v[134:135], v6, s[16:19], s30 offen offset:3072 sc1
L_zg_65:
    s_and_b32 s45, s5, 3
    s_sub_u32 s40, s5, 20
    s_lshr_b32 s40, s40, 2
    s_mul_i32 s41, s40, 3
    s_lshl_b32 s44, s4, 3
    s_add_u32 s44, s44, s41
    s_cmp_lt_u32 s4, 2
    s_cselect_b32 s49, 3, 2
    s_cmp_eq_u32 s1, 15
    s_cselect_b32 s49, 2, s49
    s_cmp_lt_u32 s40, 2
    s_cselect_b32 s49, 3, s49
    s_cselect_b32 s63, 0, 1
    s_mov_b32 s47, 0
    s_mov_b32 s61, 0
    s_add_u32 s44, s44, s35
    s_mov_b32 s61, s35
    s_mov_b32 s48, 1
    s_lshl_b32 s54, s48, 2
    s_mul_i32 s56, s48, 6656
    v_and_b32 v3, 15, v2
    v_lshrrev_b32 v4, 4, v2
    s_mul_i32 s46, s34, 20480
    s_add_u32 s46, s46, 73984
    s_mul_i32 s40, s35, 6656
    s_add_u32 s40, s40, s46
    v_mul_u32_u24 v9, 208, v3
    v_lshl_add_u32 v9, v4, 4, v9
    v_add_u32 v5, s40, v9
    s_cmp_lg_u32 s1, 15
    s_cbranch_scc1 L_c0_72
    s_setprio 1
    s_and_b32 s40, s5, 3
    s_mul_i32 s40, s40, 80
    s_and_b32 s41, s34, 1
    s_add_u32 s40, s40, s41
    s_lshr_b32 s41, s34, 1
    s_lshl4_add_u32 s42, s41, 128
    s_mul_i32 s41, s41, 192
    v_and_b32 v20, 15, v2
    v_lshl_add_u32 v20, v20, 1, s40
    v_lshrrev_b32 v21, 4, v2
    v_lshl_add_u32 v22, v21, 2, s42
    v_lshl_add_u32 v21, v21, 2, s41
    v_cvt_f32_u32 v20, v20
    v_cvt_f32_u32 v21, v21
    v_cvt_f32_u32 v22, v22
    v_add_f32 v29, 0x0, v20
    v_mul_f32 v23, 0x3acccccd, v29
    v_mul_f32 v30, 0x41800000, v29
    v_mul_f32 v31, 0x3acccccd, v30
    v_rndne_f32 v31, v31
    v_fmamk_f32 v30, v31, 0xc4200000, v30
    v_mul_f32 v24, 0x3acccccd, v30
    v_mul_f32 v30, v29, v21
    v_mul_f32 v31, 0x3acccccd, v30
    v_rndne_f32 v31, v31
    v_fmamk_f32 v30, v31, 0xc4200000, v30
    v_mul_f32 v25, 0x3acccccd, v30
    v_mul_f32 v30, v29, v22
    v_mul_f32 v31, 0x3acccccd, v30
    v_rndne_f32 v31, v31
    v_fmamk_f32 v30, v31, 0xc4200000, v30
    v_mul_f32 v26, 0x3acccccd, v30
    v_cos_f32 v27, v23
    v_cos_f32 v28, v24
    s_nop 0
    v_add_f32 v27, v27, v27
    v_add_f32 v28, v28, v28
    v_add_f32 v30, v25, v23
    v_cos_f32 v32, v25
    v_cos_f32 v33, v30
    v_sin_f32 v34, v25
    v_sin_f32 v35, v30
    v_fma_f32 v40, v27, v33, -v32
    v_cvt_pk_bf16_f32 v136, v32, v33
    v_fma_f32 v42, v27, v35, -v34
    v_cvt_pk_bf16_f32 v140, v34, v35
    v_fma_f32 v41, v27, v40, -v33
    v_fma_f32 v43, v27, v42, -v35
    v_cvt_pk_bf16_f32 v137, v40, v41
    v_cvt_pk_bf16_f32 v141, v42, v43
    v_add_f32 v25, v25, v24
    v_add_f32 v30, v25, v23
    v_cos_f32 v36, v25
    v_cos_f32 v37, v30
    v_sin_f32 v38, v25
    v_sin_f32 v39, v30
    v_fma_f32 v40, v27, v37, -v36
    v_cvt_pk_bf16_f32 v160, v36, v37
    v_fma_f32 v42, v27, v39, -v38
    v_cvt_pk_bf16_f32 v164, v38, v39
    v_fma_f32 v41, v27, v40, -v37
    v_fma_f32 v43, v27, v42, -v39
    v_cvt_pk_bf16_f32 v161, v40, v41
    v_cvt_pk_bf16_f32 v165, v42, v43
    v_fma_f32 v32, v28, v36, -v32
    v_fma_f32 v33, v28, v37, -v33
    v_fma_f32 v34, v28, v38, -v34
    v_fma_f32 v35, v28, v39, -v35
    v_fma_f32 v40, v27, v33, -v32
    v_cvt_pk_bf16_f32 v138, v32, v33
    v_fma_f32 v42, v27, v35, -v34
    v_cvt_pk_bf16_f32 v142, v34, v35
    v_fma_f32 v41, v27, v40, -v33
    v_fma_f32 v43, v27, v42, -v35
    v_cvt_pk_bf16_f32 v139, v40, v41
    v_cvt_pk_bf16_f32 v143, v42, v43
    v_fma_f32 v36, v28, v32, -v36
    v_fma_f32 v37, v28, v33, -v37
    v_fma_f32 v38, v28, v34, -v38
    v_fma_f32 v39, v28, v35, -v39
    v_fma_f32 v40, v27, v37, -v36
    v_cvt_pk_bf16_f32 v162, v36, v37
    v_fma_f32 v42, v27, v39, -v38
    v_cvt_pk_bf16_f32 v166, v38, v39
    v_fma_f32 v41, v27, v40, -v37
    v_fma_f32 v43, v27, v42, -v39
    v_cvt_pk_bf16_f32 v163, v40, v41
    v_cvt_pk_bf16_f32 v167, v42, v43
    v_fma_f32 v32, v28, v36, -v32
    v_fma_f32 v33, v28, v37, -v33
    v_fma_f32 v34, v28, v38, -v34
    v_fma_f32 v35, v28, v39, -v35
    v_fma_f32 v40, v27, v33, -v32
    v_cvt_pk_bf16_f32 v184, v32, v33
    v_fma_f32 v42, v27, v35, -v34
    v_cvt_pk_bf16_f32 v188, v34, v35
    v_fma_f32 v41, v27, v40, -v33
    v_fma_f32 v43, v27, v42, -v35
    v_cvt_pk_bf16_f32 v185, v40, v41
    v_cvt_pk_bf16_f32 v189, v42, v43
    v_fma_f32 v36, v28, v32, -v36
    v_fma_f32 v37, v28, v33, -v37
    v_fma_f32 v38, v28, v34, -v38
    v_fma_f32 v39, v28, v35, -v39
    v_fma_f32 v40, v27, v37, -v36
    v_cvt_pk_bf16_f32 v208, v36, v37
    v_fma_f32 v42, v27, v39, -v38
    v_cvt_pk_bf16_f32 v212, v38, v39
    v_fma_f32 v41, v27, v40, -v37
    v_fma_f32 v43, v27, v42, -v39
    v_cvt_pk_bf16_f32 v209, v40, v41
    v_cvt_pk_bf16_f32 v213, v42, v43
    v_fma_f32 v32, v28, v36, -v32
    v_fma_f32 v33, v28, v37, -v33
    v_fma_f32 v34, v28, v38, -v34
    v_fma_f32 v35, v28, v39, -v35
    v_fma_f32 v40, v27, v33, -v32
    v_cvt_pk_bf16_f32 v186, v32, v33
    v_fma_f32 v42, v27, v35, -v34
    v_cvt_pk_bf16_f32 v190, v34, v35
    v_fma_f32 v41, v27, v40, -v33
    v_fma_f32 v43, v27, v42, -v35
    v_cvt_pk_bf16_f32 v187, v40, v41
    v_cvt_pk_bf16_f32 v191, v42, v43
    v_fma_f32 v36, v28, v32, -v36
    v_fma_f32 v37, v28, v33, -v37
    v_fma_f32 v38, v28, v34, -v38
    v_fma_f32 v39, v28, v35, -v39
    v_fma_f32 v40, v27, v37, -v36
    v_cvt_pk_bf16_f32 v210, v36, v37
    v_fma_f32 v42, v27, v39, -v38
    v_cvt_pk_bf16_f32 v214, v38, v39
    v_fma_f32 v41, v27, v40, -v37
    v_fma_f32 v43, v27, v42, -v39
    v_cvt_pk_bf16_f32 v211, v40, v41
    v_cvt_pk_bf16_f32 v215, v42, v43
    v_add_f32 v30, v26, v23
    v_cos_f32 v32, v26
    v_cos_f32 v33, v30
    v_sin_f32 v34, v26
    v_sin_f32 v35, v30
    v_fma_f32 v40, v27, v33, -v32
    v_cvt_pk_bf16_f32 v232, v32, v33
    v_fma_f32 v42, v27, v35, -v34
    v_cvt_pk_bf16_f32 v236, v34, v35
    v_fma_f32 v41, v27, v40, -v33
    v_fma_f32 v43, v27, v42, -v35
    v_cvt_pk_bf16_f32 v233, v40, v41
    v_cvt_pk_bf16_f32 v237, v42, v43
    v_fma_f32 v26, 2.0, v24, v26
    v_add_f32 v30, v26, v23
    v_cos_f32 v36, v26
    v_cos_f32 v37, v30
    v_sin_f32 v38, v26
    v_sin_f32 v39, v30
    v_fma_f32 v40, v27, v37, -v36
    v_cvt_pk_bf16_f32 v234, v36, v37
    v_fma_f32 v42, v27, v39, -v38
    v_cvt_pk_bf16_f32 v238, v38, v39
    v_fma_f32 v41, v27, v40, -v37
    v_fma_f32 v43, v27, v42, -v39
    v_cvt_pk_bf16_f32 v235, v40, v41
    v_cvt_pk_bf16_f32 v239, v42, v43
    v_add_f32 v29, 0x42000000, v20
    v_mul_f32 v23, 0x3acccccd, v29
    v_mul_f32 v30, 0x41800000, v29
    v_mul_f32 v31, 0x3acccccd, v30
    v_rndne_f32 v31, v31
    v_fmamk_f32 v30, v31, 0xc4200000, v30
    v_mul_f32 v24, 0x3acccccd, v30
    v_mul_f32 v30, v29, v21
    v_mul_f32 v31, 0x3acccccd, v30
    v_rndne_f32 v31, v31
    v_fmamk_f32 v30, v31, 0xc4200000, v30
    v_mul_f32 v25, 0x3acccccd, v30
    v_mul_f32 v30, v29, v22
    v_mul_f32 v31, 0x3acccccd, v30
    v_rndne_f32 v31, v31
    v_fmamk_f32 v30, v31, 0xc4200000, v30
    v_mul_f32 v26, 0x3acccccd, v30
    v_cos_f32 v27, v23
    v_cos_f32 v28, v24
    s_nop 0
    v_add_f32 v27, v27, v27
    v_add_f32 v28, v28, v28
    v_add_f32 v30, v25, v23
    v_cos_f32 v32, v25
    v_cos_f32 v33, v30
    v_sin_f32 v34, v25
    v_sin_f32 v35, v30
    v_fma_f32 v40, v27, v33, -v32
    v_cvt_pk_bf16_f32 v144, v32, v33
    v_fma_f32 v42, v27, v35, -v34
    v_cvt_pk_bf16_f32 v148, v34, v35
    v_fma_f32 v41, v27, v40, -v33
    v_fma_f32 v43, v27, v42, -v35
    v_cvt_pk_bf16_f32 v145, v40, v41
    v_cvt_pk_bf16_f32 v149, v42, v43
    v_add_f32 v25, v25, v24
    v_add_f32 v30, v25, v23
    v_cos_f32 v36, v25
    v_cos_f32 v37, v30
    v_sin_f32 v38, v25
    v_sin_f32 v39, v30
    v_fma_f32 v40, v27, v37, -v36
    v_cvt_pk_bf16_f32 v168, v36, v37
    v_fma_f32 v42, v27, v39, -v38
    v_cvt_pk_bf16_f32 v172, v38, v39
    v_fma_f32 v41, v27, v40, -v37
    v_fma_f32 v43, v27, v42, -v39
    v_cvt_pk_bf16_f32 v169, v40, v41
    v_cvt_pk_bf16_f32 v173, v42, v43
    v_fma_f32 v32, v28, v36, -v32
    v_fma_f32 v33, v28, v37, -v33
    v_fma_f32 v34, v28, v38, -v34
    v_fma_f32 v35, v28, v39, -v35
    v_fma_f32 v40, v27, v33, -v32
    v_cvt_pk_bf16_f32 v146, v32, v33
    v_fma_f32 v42, v27, v35, -v34
    v_cvt_pk_bf16_f32 v150, v34, v35
    v_fma_f32 v41, v27, v40, -v33
    v_fma_f32 v43, v27, v42, -v35
    v_cvt_pk_bf16_f32 v147, v40, v41
    v_cvt_pk_bf16_f32 v151, v42, v43
    v_fma_f32 v36, v28, v32, -v36
    v_fma_f32 v37, v28, v33, -v37
    v_fma_f32 v38, v28, v34, -v38
    v_fma_f32 v39, v28, v35, -v39
    v_fma_f32 v40, v27, v37, -v36
    v_cvt_pk_bf16_f32 v170, v36, v37
    v_fma_f32 v42, v27, v39, -v38
    v_cvt_pk_bf16_f32 v174, v38, v39
    v_fma_f32 v41, v27, v40, -v37
    v_fma_f32 v43, v27, v42, -v39
    v_cvt_pk_bf16_f32 v171, v40, v41
    v_cvt_pk_bf16_f32 v175, v42, v43
    v_fma_f32 v32, v28, v36, -v32
    v_fma_f32 v33, v28, v37, -v33
    v_fma_f32 v34, v28, v38, -v34
    v_fma_f32 v35, v28, v39, -v35
    v_fma_f32 v40, v27, v33, -v32
    v_cvt_pk_bf16_f32 v192, v32, v33
    v_fma_f32 v42, v27, v35, -v34
    v_cvt_pk_bf16_f32 v196, v34, v35
    v_fma_f32 v41, v27, v40, -v33
    v_fma_f32 v43, v27, v42, -v35
    v_cvt_pk_bf16_f32 v193, v40, v41
    v_cvt_pk_bf16_f32 v197, v42, v43
    v_fma_f32 v36, v28, v32, -v36
    v_fma_f32 v37, v28, v33, -v37
    v_fma_f32 v38, v28, v34, -v38
    v_fma_f32 v39, v28, v35, -v39
    v_fma_f32 v40, v27, v37, -v36
    v_cvt_pk_bf16_f32 v216, v36, v37
    v_fma_f32 v42, v27, v39, -v38
    v_cvt_pk_bf16_f32 v220, v38, v39
    v_fma_f32 v41, v27, v40, -v37
    v_fma_f32 v43, v27, v42, -v39
    v_cvt_pk_bf16_f32 v217, v40, v41
    v_cvt_pk_bf16_f32 v221, v42, v43
    v_fma_f32 v32, v28, v36, -v32
    v_fma_f32 v33, v28, v37, -v33
    v_fma_f32 v34, v28, v38, -v34
    v_fma_f32 v35, v28, v39, -v35
    v_fma_f32 v40, v27, v33, -v32
    v_cvt_pk_bf16_f32 v194, v32, v33
    v_fma_f32 v42, v27, v35, -v34
    v_cvt_pk_bf16_f32 v198, v34, v35
    v_fma_f32 v41, v27, v40, -v33
    v_fma_f32 v43, v27, v42, -v35
    v_cvt_pk_bf16_f32 v195, v40, v41
    v_cvt_pk_bf16_f32 v199, v42, v43
    v_fma_f32 v36, v28, v32, -v36
    v_fma_f32 v37, v28, v33, -v37
    v_fma_f32 v38, v28, v34, -v38
    v_fma_f32 v39, v28, v35, -v39
    v_fma_f32 v40, v27, v37, -v36
    v_cvt_pk_bf16_f32 v218, v36, v37
    v_fma_f32 v42, v27, v39, -v38
    v_cvt_pk_bf16_f32 v222, v38, v39
    v_fma_f32 v41, v27, v40, -v37
    v_fma_f32 v43, v27, v42, -v39
    v_cvt_pk_bf16_f32 v219, v40, v41
    v_cvt_pk_bf16_f32 v223, v42, v43
    v_add_f32 v30, v26, v23
    v_cos_f32 v32, v26
    v_cos_f32 v33, v30
    v_sin_f32 v34, v26
    v_sin_f32 v35, v30
    v_fma_f32 v40, v27, v33, -v32
    v_cvt_pk_bf16_f32 v240, v32, v33
    v_fma_f32 v42, v27, v35, -v34
    v_cvt_pk_bf16_f32 v244, v34, v35
    v_fma_f32 v41, v27, v40, -v33
    v_fma_f32 v43, v27, v42, -v35
    v_cvt_pk_bf16_f32 v241, v40, v41
    v_cvt_pk_bf16_f32 v245, v42, v43
    v_fma_f32 v26, 2.0, v24, v26
    v_add_f32 v30, v26, v23
    v_cos_f32 v36, v26
    v_cos_f32 v37, v30
    v_sin_f32 v38, v26
    v_sin_f32 v39, v30
    v_fma_f32 v40, v27, v37, -v36
    v_cvt_pk_bf16_f32 v242, v36, v37
    v_fma_f32 v42, v27, v39, -v38
    v_cvt_pk_bf16_f32 v246, v38, v39
    v_fma_f32 v41, v27, v40, -v37
    v_fma_f32 v43, v27, v42, -v39
    v_cvt_pk_bf16_f32 v243, v40, v41
    v_cvt_pk_bf16_f32 v247, v42, v43
L_c0_72:
    v_mov_b32 v16, s38
    s_mov_b32 s60, 0
L_lw_73:
    ds_read_b32 v17, v16
    s_add_u32 s60, s60, 1
    s_waitcnt lgkmcnt(0)
    v_readfirstlane_b32 s40, v17
    s_cmp_gt_u32 s60, 1600000
    s_cbranch_scc1 L_lwd_74
    s_cmp_lt_u32 s40, 4
    s_cbranch_scc1 L_lw_73
L_lwd_74:
    s_lshl2_add_u32 s40, s35, 163776
    v_mov_b32 v0, s40
    v_mov_b32 v8, 0
    s_mov_b32 s62, 0
    s_setprio 3
    s_mov_b64 vcc, 0
L_A2F:
    v_lshl_add_u32 v9, v3, 1, s47
    v_cvt_f32_u32 v9, v9
    v_mul_f32 v9, 0x3d000000, v9
    v_cvt_f32_u32 v10, v4
    v_mul_f32 v10, v9, v10
    s_cmp_eq_u32 s47, 0
    s_cselect_b32 s50, 1.0, 0
    s_cselect_b32 s52, 0, 1.0
    s_cmp_eq_u32 s44, 0
    s_cselect_b32 s51, 0, 1.0
    v_fmamk_f32 v11, v9, 0x0, v10
    v_cos_f32 v12, v11
    v_sin_f32 v13, v11
    s_nop 0
    v_mul_f32 v14, s50, v12
    v_mul_f32 v15, s51, v13
    v_fmac_f32 v15, s52, v12
    v_cvt_pk_bf16_f32 v16, v14, v15
    v_mul_f32 v14, s50, v13
    v_mul_f32 v15, s51, v12
    v_mul_f32 v11, s52, v13
    v_sub_f32 v15, v15, v11
    v_cvt_pk_bf16_f32 v20, -v14, v15
    v_fmamk_f32 v11, v9, 0x40800000, v10
    v_cos_f32 v12, v11
    v_sin_f32 v13, v11
    s_nop 0
    v_mul_f32 v14, s50, v12
    v_mul_f32 v15, s51, v13
    v_fmac_f32 v15, s52, v12
    v_cvt_pk_bf16_f32 v17, v14, v15
    v_mul_f32 v14, s50, v13
    v_mul_f32 v15, s51, v12
    v_mul_f32 v11, s52, v13
    v_sub_f32 v15, v15, v11
    v_cvt_pk_bf16_f32 v21, -v14, v15
    v_fmamk_f32 v11, v9, 0x41000000, v10
    v_cos_f32 v12, v11
    v_sin_f32 v13, v11
    s_nop 0
    v_mul_f32 v14, s50, v12
    v_mul_f32 v15, s51, v13
    v_fmac_f32 v15, s52, v12
    v_cvt_pk_bf16_f32 v18, v14, v15
    v_mul_f32 v14, s50, v13
    v_mul_f32 v15, s51, v12
    v_mul_f32 v11, s52, v13
    v_sub_f32 v15, v15, v11
    v_cvt_pk_bf16_f32 v22, -v14, v15
    v_fmamk_f32 v11, v9, 0x41400000, v10
    v_cos_f32 v12, v11
    v_sin_f32 v13, v11
    s_nop 0
    v_mul_f32 v14, s50, v12
    v_mul_f32 v15, s51, v13
    v_fmac_f32 v15, s52, v12
    v_cvt_pk_bf16_f32 v19, v14, v15
    v_mul_f32 v14, s50, v13
    v_mul_f32 v15, s51, v12
    v_mul_f32 v11, s52, v13
    v_sub_f32 v15, v15, v11
    v_cvt_pk_bf16_f32 v23, -v14, v15
L_A2G:
    s_cmp_lg_u32 s62, 0
    s_cbranch_scc1 L_A2P
    s_add_u32 s57, s61, s48
    s_add_u32 s53, s44, s48
    s_mul_i32 s59, s57, s63
    s_cmp_eq_u32 s59, 2
    s_cselect_b32 s53, 0, s53
    s_cmp_ge_u32 s57, s49
    s_cselect_b32 s53, 0x4000, s53
    s_mul_i32 s28, s53, 41088
    s_add_u32 s30, s28, s39
    s_add_u32 s28, s28, s31
    s_add_u32 s29, s28, 4096
    s_waitcnt vmcnt(8)
    v_swap_b32 v97, v100
    v_swap_b32 v98, v104
    v_swap_b32 v99, v108
    v_swap_b32 v102, v105
    v_swap_b32 v103, v109
    v_swap_b32 v107, v110
    s_nop 1
L_A2P:
    v_mfma_f32_16x16x32_bf16 v[32:35], v[96:99], v[16:19], 0
    s_waitcnt vmcnt(4)
    v_swap_b32 v113, v116
    v_swap_b32 v114, v120
    v_mfma_f32_16x16x32_bf16 v[36:39], v[100:103], v[16:19], 0
    s_cbranch_vccz L_sk_75
    v_add_f32 v76, v76, v64
    v_add_f32 v77, v77, v65
    v_add_f32 v78, v78, v66
    v_add_f32 v79, v79, v67
    v_fma_f32 v64, -2.0, v64, v76
    v_fma_f32 v65, -2.0, v65, v77
    v_fma_f32 v66, -2.0, v66, v78
    v_fma_f32 v67, -2.0, v67, v79
L_sk_75:
    v_swap_b32 v115, v124
    v_swap_b32 v118, v121
    v_mfma_f32_16x16x32_bf16 v[40:43], v[96:99], v[20:23], 0
    s_cbranch_vccz L_sk_76
    ds_write_b128 v5, v[76:79] offset:0
    ds_write_b128 v5, v[64:67] offset:3328
    v_add_f32 v80, v80, v68
    v_add_f32 v81, v81, v69
    v_add_f32 v82, v82, v70
    v_add_f32 v83, v83, v71
    v_fma_f32 v68, -2.0, v68, v80
    v_fma_f32 v69, -2.0, v69, v81
    v_fma_f32 v70, -2.0, v70, v82
    v_fma_f32 v71, -2.0, v71, v83
L_sk_76:
    v_swap_b32 v119, v125
    v_mfma_f32_16x16x32_bf16 v[44:47], v[100:103], v[20:23], 0
    s_cbranch_vccz L_sk_77
    ds_write_b128 v5, v[80:83] offset:64
    ds_write_b128 v5, v[68:71] offset:3392
    v_add_f32 v84, v84, v72
    v_add_f32 v85, v85, v73
    v_add_f32 v86, v86, v74
    v_add_f32 v87, v87, v75
    v_fma_f32 v72, -2.0, v72, v84
    v_fma_f32 v73, -2.0, v73, v85
    v_fma_f32 v74, -2.0, v74, v86
    v_fma_f32 v75, -2.0, v75, v87
L_sk_77:
    v_swap_b32 v123, v126
    v_mfma_f32_16x16x32_bf16 v[48:51], v[104:107], v[16:19], 0
    s_cbranch_vccz L_sk_78
    ds_write_b128 v5, v[84:87] offset:128
    ds_write_b128 v5, v[72:75] offset:3456
L_sk_78:
    v_cvt_pk_bf16_f32 v24, v32, v33
    v_cvt_pk_bf16_f32 v25, v34, v35
    v_mfma_f32_16x16x32_bf16 v[52:55], v[108:111], v[16:19], 0
    v_cvt_pk_bf16_f32 v26, v36, v37
    v_cvt_pk_bf16_f32 v27, v38, v39
    v_mfma_f32_16x16x32_bf16 v[56:59], v[104:107], v[20:23], 0
    v_cvt_pk_bf16_f32 v28, v40, v41
    v_cvt_pk_bf16_f32 v29, v42, v43
    v_mfma_f32_16x16x32_bf16 v[60:63], v[108:111], v[20:23], 0
    v_cvt_pk_bf16_f32 v30, v44, v45
    v_cvt_pk_bf16_f32 v31, v46, v47
    v_mfma_f32_16x16x32_bf16 v[32:35], v[112:115], v[16:19], 0
    buffer_load_dwordx4 v[96:99], v6, s[16:19], s28 offen offset:0 sc1
    v_mfma_f32_16x16x32_bf16 v[36:39], v[116:119], v[16:19], 0
    buffer_load_dwordx4 v[100:103], v6, s[16:19], s28 offen offset:1024 sc1
    v_mfma_f32_16x16x32_bf16 v[40:43], v[112:115], v[20:23], 0
    v_cvt_pk_bf16_f32 v88, v48, v49
    s_mov_b64 vcc, -1
    v_mfma_f32_16x16x32_bf16 v[44:47], v[116:119], v[20:23], 0
    v_cvt_pk_bf16_f32 v89, v50, v51
    v_mfma_f32_16x16x32_bf16 v[76:79], v[136:139], v[24:27], 0
    s_mov_b64 exec, 1
    ds_add_u32 v0, v8
    s_mov_b64 exec, -1
    v_mad_u32_u24 v0, v8, s54, v0
    v_mov_b32 v8, 1
    v_cvt_pk_bf16_f32 v90, v52, v53
    v_mfma_f32_16x16x32_bf16 v[64:67], v[140:143], v[28:31], 0
    buffer_load_dwordx4 v[104:107], v6, s[16:19], s28 offen offset:2048 sc1
    v_cvt_pk_bf16_f32 v91, v54, v55
    v_mfma_f32_16x16x32_bf16 v[80:83], v[144:147], v[24:27], 0
    buffer_load_dwordx4 v[108:111], v6, s[16:19], s28 offen offset:3072 sc1
    v_cvt_pk_bf16_f32 v92, v56, v57
    v_mfma_f32_16x16x32_bf16 v[68:71], v[148:151], v[28:31], 0
    v_cvt_pk_bf16_f32 v93, v58, v59
    v_add_u32 v5, s62, v5
    v_mfma_f32_16x16x32_bf16 v[84:87], v[152:155], v[24:27], 0
    v_cvt_pk_bf16_f32 v94, v60, v61
    s_mov_b32 s62, s56
    v_mfma_f32_16x16x32_bf16 v[72:75], v[156:159], v[28:31], 0
    v_cvt_pk_bf16_f32 v95, v62, v63
    s_setprio 1
    v_mfma_f32_16x16x32_bf16 v[48:51], v[120:123], v[16:19], 0
    s_waitcnt vmcnt(4)
    v_swap_b32 v129, v130
    v_cvt_pk_bf16_f32 v24, v32, v33
    v_mfma_f32_16x16x32_bf16 v[52:55], v[124:127], v[16:19], 0
    v_swap_b32 v130, v132
    v_cvt_pk_bf16_f32 v25, v34, v35
    v_mfma_f32_16x16x32_bf16 v[56:59], v[120:123], v[20:23], 0
    v_swap_b32 v131, v134
    v_cvt_pk_bf16_f32 v26, v36, v37
    v_mfma_f32_16x16x32_bf16 v[60:63], v[124:127], v[20:23], 0
    v_swap_b32 v133, v134
    v_cvt_pk_bf16_f32 v27, v38, v39
    v_mfma_f32_16x16x32_bf16 v[76:79], v[160:163], v[88:91], v[76:79]
    buffer_load_dwordx4 v[112:115], v6, s[16:19], s29 offen offset:0 sc1
    v_cvt_pk_bf16_f32 v28, v40, v41
    v_mfma_f32_16x16x32_bf16 v[64:67], v[164:167], v[92:95], v[64:67]
    buffer_load_dwordx4 v[116:119], v6, s[16:19], s29 offen offset:1024 sc1
    v_cvt_pk_bf16_f32 v29, v42, v43
    v_mfma_f32_16x16x32_bf16 v[80:83], v[168:171], v[88:91], v[80:83]
    buffer_load_dwordx4 v[120:123], v6, s[16:19], s29 offen offset:2048 sc1
    v_cvt_pk_bf16_f32 v30, v44, v45
    v_mfma_f32_16x16x32_bf16 v[68:71], v[172:175], v[92:95], v[68:71]
    buffer_load_dwordx4 v[124:127], v6, s[16:19], s29 offen offset:3072 sc1
    v_cvt_pk_bf16_f32 v31, v46, v47
    v_mfma_f32_16x16x32_bf16 v[84:87], v[176:179], v[88:91], v[84:87]
    v_mfma_f32_16x16x32_bf16 v[72:75], v[180:183], v[92:95], v[72:75]
    v_mfma_f32_16x16x32_bf16 v[32:35], v[128:131], v[16:19], 0
    s_mov_b32 s58, s44
    v_cvt_pk_bf16_f32 v88, v48, v49
    v_mfma_f32_16x16x32_bf16 v[36:39], v[132:135], v[16:19], 0
    s_add_u32 s61, s61, s48
    v_cvt_pk_bf16_f32 v89, v50, v51
    v_mfma_f32_16x16x32_bf16 v[40:43], v[128:131], v[20:23], 0
    s_add_u32 s44, s44, s48
    v_cvt_pk_bf16_f32 v90, v52, v53
    v_mfma_f32_16x16x32_bf16 v[44:47], v[132:135], v[20:23], 0
    s_cmp_eq_u32 s61, 2
    v_cvt_pk_bf16_f32 v91, v54, v55
    v_mfma_f32_16x16x32_bf16 v[76:79], v[184:187], v[24:27], v[76:79]
    buffer_load_dwordx2 v[128:129], v6, s[16:19], s30 offen offset:0 sc1
    v_cvt_pk_bf16_f32 v92, v56, v57
    v_mfma_f32_16x16x32_bf16 v[64:67], v[188:191], v[28:31], v[64:67]
    buffer_load_dwordx2 v[130:131], v6, s[16:19], s30 offen offset:1024 sc1
    v_cvt_pk_bf16_f32 v93, v58, v59
    v_mfma_f32_16x16x32_bf16 v[80:83], v[192:195], v[24:27], v[80:83]
    buffer_load_dwordx2 v[132:133], v6, s[16:19], s30 offen offset:2048 sc1
    v_cvt_pk_bf16_f32 v94, v60, v61
    v_mfma_f32_16x16x32_bf16 v[68:71], v[196:199], v[28:31], v[68:71]
    buffer_load_dwordx2 v[134:135], v6, s[16:19], s30 offen offset:3072 sc1
    v_cvt_pk_bf16_f32 v95, v62, v63
    v_mfma_f32_16x16x32_bf16 v[84:87], v[200:203], v[24:27], v[84:87]
    s_cselect_b32 s47, s63, 0
    s_cmp_eq_u32 s47, 1
    v_mfma_f32_16x16x32_bf16 v[72:75], v[204:207], v[28:31], v[72:75]
    s_cselect_b32 s44, 0, s44
    s_mul_i32 s58, s58, s44
    v_mfma_f32_16x16x32_bf16 v[76:79], v[208:211], v[88:91], v[76:79]
    s_add_u32 s57, s61, s48
    v_cvt_pk_bf16_f32 v24, v32, v33
    v_cvt_pk_bf16_f32 v25, v34, v35
    v_mfma_f32_16x16x32_bf16 v[64:67], v[212:215], v[92:95], v[64:67]
    s_add_u32 s53, s44, s48
    v_cvt_pk_bf16_f32 v26, v36, v37
    v_cvt_pk_bf16_f32 v27, v38, v39
    v_mfma_f32_16x16x32_bf16 v[80:83], v[216:219], v[88:91], v[80:83]
    s_mul_i32 s59, s57, s63
    v_cvt_pk_bf16_f32 v28, v40, v41
    v_cvt_pk_bf16_f32 v29, v42, v43
    v_mfma_f32_16x16x32_bf16 v[68:71], v[220:223], v[92:95], v[68:71]
    s_cmp_eq_u32 s59, 2
    v_cvt_pk_bf16_f32 v30, v44, v45
    v_cvt_pk_bf16_f32 v31, v46, v47
    v_mfma_f32_16x16x32_bf16 v[84:87], v[224:227], v[88:91], v[84:87]
    s_cselect_b32 s53, 0, s53
    s_cmp_ge_u32 s57, s49
    v_mfma_f32_16x16x32_bf16 v[72:75], v[228:231], v[92:95], v[72:75]
    s_cselect_b32 s53, 0x4000, s53
    v_mfma_f32_16x16x32_bf16 v[76:79], v[232:235], v[24:27], v[76:79]
    s_cmp_lt_u32 s61, s49
    s_cbranch_scc0 L_lw0_79
    s_waitcnt vmcnt(8)
L_lw0_79:
    v_swap_b32 v97, v100
    v_mfma_f32_16x16x32_bf16 v[64:67], v[236:239], v[28:31], v[64:67]
    s_mul_i32 s28, s53, 41088
    v_swap_b32 v98, v104
    v_mfma_f32_16x16x32_bf16 v[80:83], v[240:243], v[24:27], v[80:83]
    s_add_u32 s30, s28, s39
    v_swap_b32 v99, v108
    v_mfma_f32_16x16x32_bf16 v[68:71], v[244:247], v[28:31], v[68:71]
    s_add_u32 s28, s28, s31
    v_swap_b32 v102, v105
    v_mfma_f32_16x16x32_bf16 v[84:87], v[248:251], v[24:27], v[84:87]
    s_add_u32 s29, s28, 4096
    v_swap_b32 v103, v109
    v_mfma_f32_16x16x32_bf16 v[72:75], v[252:255], v[28:31], v[72:75]
    s_cmp_lt_u32 s61, s49
    v_swap_b32 v107, v110
    s_cbranch_scc0 L_a2x_80
    s_cmp_lg_u32 s58, 0
    s_cbranch_scc1 L_A2P
    s_branch L_A2F
L_a2x_80:
    s_nop 1
    v_add_f32 v76, v76, v64
    v_add_f32 v77, v77, v65
    v_add_f32 v78, v78, v66
    v_add_f32 v79, v79, v67
    v_fma_f32 v64, -2.0, v64, v76
    v_fma_f32 v65, -2.0, v65, v77
    v_fma_f32 v66, -2.0, v66, v78
    v_fma_f32 v67, -2.0, v67, v79
    ds_write_b128 v5, v[76:79] offset:0
    ds_write_b128 v5, v[64:67] offset:3328
    v_add_f32 v80, v80, v68
    v_add_f32 v81, v81, v69
    v_add_f32 v82, v82, v70
    v_add_f32 v83, v83, v71
    v_fma_f32 v68, -2.0, v68, v80
    v_fma_f32 v69, -2.0, v69, v81
    v_fma_f32 v70, -2.0, v70, v82
    v_fma_f32 v71, -2.0, v71, v83
    ds_write_b128 v5, v[80:83] offset:64
    ds_write_b128 v5, v[68:71] offset:3392
    v_add_f32 v84, v84, v72
    v_add_f32 v85, v85, v73
    v_add_f32 v86, v86, v74
    v_add_f32 v87, v87, v75
    v_fma_f32 v72, -2.0, v72, v84
    v_fma_f32 v73, -2.0, v73, v85
    v_fma_f32 v74, -2.0, v74, v86
    v_fma_f32 v75, -2.0, v75, v87
    ds_write_b128 v5, v[84:87] offset:128
    ds_write_b128 v5, v[72:75] offset:3456
    s_mov_b64 exec, 1
    ds_add_u32 v0, v8
    s_mov_b64 exec, -1
    s_cmp_eq_u32 s35, 0
    s_cbranch_scc1 L_FIN
    s_waitcnt vmcnt(0)
L_A2C:
    s_and_b32 s45, s5, 3
    s_sub_u32 s40, s5, 20
    s_lshr_b32 s40, s40, 2
    s_mul_i32 s41, s40, 3
    s_lshl_b32 s44, s4, 3
    s_add_u32 s44, s44, s41
    s_cmp_lt_u32 s4, 2
    s_cselect_b32 s49, 3, 2
    s_cmp_eq_u32 s1, 15
    s_cselect_b32 s49, 2, s49
    s_cmp_lt_u32 s40, 2
    s_cselect_b32 s49, 3, s49
    s_cselect_b32 s63, 0, 1
    s_mov_b32 s47, 0
    s_mov_b32 s61, 0
    s_and_b32 s58, s34, 1
    s_lshr_b32 s59, s34, 1
    s_xor_b32 s52, s58, s59
    s_mul_i32 s52, s52, 3328
    s_add_u32 s52, s52, 73984
    s_cmp_eq_u32 s59, 0
    s_cselect_b32 s54, 1, -1
    s_mul_i32 s54, s54, 327680
    s_mul_i32 s55, s45, 160
    s_sub_u32 s56, 1264, s55
    s_cmp_eq_u32 s58, 0
    s_cselect_b32 s55, s55, s56
    s_cselect_b32 s56, 16, -16
    v_add_u32 v9, 0, v2
    v_min_u32 v9, 159, v9
    v_mul_u32_u24 v10, 6554, v9
    v_lshrrev_b32 v10, 16, v10
    v_mul_u32_u24 v11, 10, v10
    v_sub_u32 v11, v9, v11
    v_mul_u32_u24 v9, 208, v10
    v_lshl_add_u32 v9, v11, 4, v9
    v_add_u32 v20, s52, v9
    v_add_u32 v14, 40960, v20
    v_mul_lo_u32 v10, v10, s54
    v_mul_lo_u32 v11, v11, s56
    v_add3_u32 v28, v10, v11, s55
    v_add_u32 v9, 64, v2
    v_min_u32 v9, 159, v9
    v_mul_u32_u24 v10, 6554, v9
    v_lshrrev_b32 v10, 16, v10
    v_mul_u32_u24 v11, 10, v10
    v_sub_u32 v11, v9, v11
    v_mul_u32_u24 v9, 208, v10
    v_lshl_add_u32 v9, v11, 4, v9
    v_add_u32 v21, s52, v9
    v_add_u32 v15, 40960, v21
    v_mul_lo_u32 v10, v10, s54
    v_mul_lo_u32 v11, v11, s56
    v_add3_u32 v29, v10, v11, s55
    v_add_u32 v9, 128, v2
    v_min_u32 v9, 159, v9
    v_mul_u32_u24 v10, 6554, v9
    v_lshrrev_b32 v10, 16, v10
    v_mul_u32_u24 v11, 10, v10
    v_sub_u32 v11, v9, v11
    v_mul_u32_u24 v9, 208, v10
    v_lshl_add_u32 v9, v11, 4, v9
    v_add_u32 v22, s52, v9
    v_add_u32 v16, 40960, v22
    v_mul_lo_u32 v10, v10, s54
    v_mul_lo_u32 v11, v11, s56
    v_add3_u32 v30, v10, v11, s55
L_A2S:
    s_lshl_b32 s53, s47, 6
    s_add_u32 s53, s53, s44
    s_sub_u32 s57, 2048, s53
    s_cmp_eq_u32 s59, 0
    s_cselect_b32 s53, s53, s57
    s_mul_i32 s53, s53, 2560
    s_lshl_b32 s57, s61, 2
    s_add_u32 s57, s57, 163776
    v_add_u32 v24, s53, v28
    v_add_u32 v25, s53, v29
    v_add_u32 v26, s53, v30
    s_cmp_lg_u32 s44, 0
    s_cselect_b32 s40, 0, s59
    s_cmp_lg_u32 s40, 0
    s_cbranch_scc1 L_std_82
    v_mov_b32 v9, s57
    s_mov_b32 s60, 0
L_lw_83:
    ds_read_b32 v10, v9
    s_add_u32 s60, s60, 1
    s_waitcnt lgkmcnt(0)
    v_readfirstlane_b32 s40, v10
    s_cmp_gt_u32 s60, 1600000
    s_cbranch_scc1 L_lwd_84
    s_cmp_lt_u32 s40, 4
    s_cbranch_scc1 L_lw_83
L_lwd_84:
    s_cmp_eq_u32 s58, 1
    s_cbranch_scc1 L_mir_81
    ds_read_b128 v[32:35], v20
    ds_read_b128 v[40:43], v20 offset:20480
    ds_read_b128 v[36:39], v14
    ds_read_b128 v[44:47], v14 offset:20480
    ds_read_b128 v[48:51], v21
    ds_read_b128 v[56:59], v21 offset:20480
    ds_read_b128 v[52:55], v15
    ds_read_b128 v[60:63], v15 offset:20480
    ds_read_b128 v[64:67], v22
    ds_read_b128 v[72:75], v22 offset:20480
    ds_read_b128 v[68:71], v16
    ds_read_b128 v[76:79], v16 offset:20480
    s_waitcnt lgkmcnt(8)
    v_add_f32 v32, v32, v36
    v_add_f32 v40, v40, v44
    v_add_f32 v33, v33, v37
    v_add_f32 v41, v41, v45
    v_add_f32 v34, v34, v38
    v_add_f32 v42, v42, v46
    v_add_f32 v35, v35, v39
    v_add_f32 v43, v43, v47
    v_cvt_pk_bf16_f32 v36, v32, v40
    v_cvt_pk_bf16_f32 v37, v33, v41
    v_cvt_pk_bf16_f32 v38, v34, v42
    v_cvt_pk_bf16_f32 v39, v35, v43
    buffer_store_dwordx4 v[36:39], v24, s[24:27], 0 offen sc1
    s_waitcnt lgkmcnt(4)
    v_add_f32 v48, v48, v52
    v_add_f32 v56, v56, v60
    v_add_f32 v49, v49, v53
    v_add_f32 v57, v57, v61
    v_add_f32 v50, v50, v54
    v_add_f32 v58, v58, v62
    v_add_f32 v51, v51, v55
    v_add_f32 v59, v59, v63
    v_cvt_pk_bf16_f32 v52, v48, v56
    v_cvt_pk_bf16_f32 v53, v49, v57
    v_cvt_pk_bf16_f32 v54, v50, v58
    v_cvt_pk_bf16_f32 v55, v51, v59
    buffer_store_dwordx4 v[52:55], v25, s[24:27], 0 offen sc1
    s_waitcnt lgkmcnt(0)
    v_add_f32 v64, v64, v68
    v_add_f32 v72, v72, v76
    v_add_f32 v65, v65, v69
    v_add_f32 v73, v73, v77
    v_add_f32 v66, v66, v70
    v_add_f32 v74, v74, v78
    v_add_f32 v67, v67, v71
    v_add_f32 v75, v75, v79
    v_cvt_pk_bf16_f32 v68, v64, v72
    v_cvt_pk_bf16_f32 v69, v65, v73
    v_cvt_pk_bf16_f32 v70, v66, v74
    v_cvt_pk_bf16_f32 v71, v67, v75
    s_mov_b32 exec_hi, 0
    buffer_store_dwordx4 v[68:71], v26, s[24:27], 0 offen sc1
    s_mov_b32 exec_hi, -1
    s_branch L_std_82
L_mir_81:
    ds_read2_b32 v[32:33], v20 offset0:1 offset1:2
    ds_read2_b32 v[34:35], v20 offset0:3 offset1:4
    ds_read_b128 v[40:43], v20 offset:20480
    ds_read2_b32 v[36:37], v14 offset0:1 offset1:2
    ds_read2_b32 v[38:39], v14 offset0:3 offset1:4
    ds_read_b128 v[44:47], v14 offset:20480
    ds_read2_b32 v[48:49], v21 offset0:1 offset1:2
    ds_read2_b32 v[50:51], v21 offset0:3 offset1:4
    ds_read_b128 v[56:59], v21 offset:20480
    ds_read2_b32 v[52:53], v15 offset0:1 offset1:2
    ds_read2_b32 v[54:55], v15 offset0:3 offset1:4
    ds_read_b128 v[60:63], v15 offset:20480
    ds_read2_b32 v[64:65], v22 offset0:1 offset1:2
    ds_read2_b32 v[66:67], v22 offset0:3 offset1:4
    ds_read_b128 v[72:75], v22 offset:20480
    s_waitcnt lgkmcnt(14)
    ds_read2_b32 v[68:69], v16 offset0:1 offset1:2
    s_waitcnt lgkmcnt(14)
    ds_read2_b32 v[70:71], v16 offset0:3 offset1:4
    s_waitcnt lgkmcnt(14)
    ds_read_b128 v[76:79], v16 offset:20480
    s_waitcnt lgkmcnt(12)
    v_add_f32 v32, v32, v36
    v_add_f32 v40, v40, v44
    v_add_f32 v33, v33, v37
    v_add_f32 v41, v41, v45
    v_add_f32 v34, v34, v38
    v_add_f32 v42, v42, v46
    v_add_f32 v35, v35, v39
    v_add_f32 v43, v43, v47
    v_cvt_pk_bf16_f32 v36, v35, v43
    v_cvt_pk_bf16_f32 v37, v34, v42
    v_cvt_pk_bf16_f32 v38, v33, v41
    v_cvt_pk_bf16_f32 v39, v32, v40
    buffer_store_dwordx4 v[36:39], v24, s[24:27], 0 offen sc1
    s_waitcnt lgkmcnt(6)
    v_add_f32 v48, v48, v52
    v_add_f32 v56, v56, v60
    v_add_f32 v49, v49, v53
    v_add_f32 v57, v57, v61
    v_add_f32 v50, v50, v54
    v_add_f32 v58, v58, v62
    v_add_f32 v51, v51, v55
    v_add_f32 v59, v59, v63
    v_cvt_pk_bf16_f32 v52, v51, v59
    v_cvt_pk_bf16_f32 v53, v50, v58
    v_cvt_pk_bf16_f32 v54, v49, v57
    v_cvt_pk_bf16_f32 v55, v48, v56
    buffer_store_dwordx4 v[52:55], v25, s[24:27], 0 offen sc1
    s_waitcnt lgkmcnt(0)
    v_add_f32 v64, v64, v68
    v_add_f32 v72, v72, v76
    v_add_f32 v65, v65, v69
    v_add_f32 v73, v73, v77
    v_add_f32 v66, v66, v70
    v_add_f32 v74, v74, v78
    v_add_f32 v67, v67, v71
    v_add_f32 v75, v75, v79
    v_cvt_pk_bf16_f32 v68, v67, v75
    v_cvt_pk_bf16_f32 v69, v66, v74
    v_cvt_pk_bf16_f32 v70, v65, v73
    v_cvt_pk_bf16_f32 v71, v64, v72
    s_mov_b32 exec_hi, 0
    buffer_store_dwordx4 v[68:71], v26, s[24:27], 0 offen sc1
    s_mov_b32 exec_hi, -1
L_std_82:
    v_add_u32 v20, 6656, v20
    v_add_u32 v14, 6656, v14
    v_add_u32 v21, 6656, v21
    v_add_u32 v15, 6656, v15
    v_add_u32 v22, 6656, v22
    v_add_u32 v16, 6656, v16
    s_add_u32 s61, s61, 1
    s_add_u32 s44, s44, 1
    s_cmp_eq_u32 s61, 2
    s_cselect_b32 s47, s63, 0
    s_cmp_eq_u32 s47, 1
    s_cselect_b32 s44, 0, s44
    s_cmp_lt_u32 s61, s49
    s_cbranch_scc1 L_A2S
    s_branch L_FIN
L_OP:
L_OPW:
    s_mov_b64 exec, -1
    v_lshrrev_b32 v9, 3, v2
    v_bfe_u32 v10, v2, 4, 1
    v_lshlrev_b32 v10, 2, v10
    v_and_b32 v11, 7, v2
    v_xor_b32 v10, v10, v11
    v_mul_u32_u24 v9, 1280, v9
    v_lshl_add_u32 v9, v10, 4, v9
    s_lshl_b32 s41, s7, 7
    v_add_u32 v9, s41, v9
    s_and_b32 s43, s6, 3
    s_mul_i32 s43, s43, 20
    s_add_u32 s43, s43, s34
    s_add_u32 s43, s43, 20
    s_sub_u32 s41, s43, 80
    s_cselect_b32 s43, s43, s41
    s_lshl_b32 s43, s43, 10
    s_add_u32 m0, s43, 73984
    s_mul_i32 s42, s43, 10
    buffer_load_dwordx4 v9, s[20:23], s42 offen lds
    s_add_u32 s43, s43, 4096
    s_sub_u32 s41, s43, 81920
    s_cselect_b32 s43, s43, s41
    s_add_u32 m0, s43, 73984
    s_mul_i32 s42, s43, 10
    buffer_load_dwordx4 v9, s[20:23], s42 offen lds
    s_add_u32 s43, s43, 4096
    s_sub_u32 s41, s43, 81920
    s_cselect_b32 s43, s43, s41
    s_add_u32 m0, s43, 73984
    s_mul_i32 s42, s43, 10
    buffer_load_dwordx4 v9, s[20:23], s42 offen lds
    s_add_u32 s43, s43, 4096
    s_sub_u32 s41, s43, 81920
    s_cselect_b32 s43, s43, s41
    s_add_u32 m0, s43, 73984
    s_mul_i32 s42, s43, 10
    buffer_load_dwordx4 v9, s[20:23], s42 offen lds
    s_add_u32 s43, s43, 4096
    s_sub_u32 s41, s43, 81920
    s_cselect_b32 s43, s43, s41
    s_add_u32 m0, s43, 73984
    s_mul_i32 s42, s43, 10
    buffer_load_dwordx4 v9, s[20:23], s42 offen lds
    s_add_u32 s43, s43, 4096
    s_sub_u32 s41, s43, 81920
    s_cselect_b32 s43, s43, s41
    s_add_u32 m0, s43, 73984
    s_mul_i32 s42, s43, 10
    buffer_load_dwordx4 v9, s[20:23], s42 offen lds
    s_add_u32 s43, s43, 4096
    s_sub_u32 s41, s43, 81920
    s_cselect_b32 s43, s43, s41
    s_mov_b64 exec, 0x3ff
    v_mov_b32 v10, s32
    v_mov_b32 v11, s33
    s_waitcnt vmcnt(6)
    buffer_store_dwordx2 v[10:11], v132, s[16:19], 0 offen sc1
    s_mov_b64 exec, -1
    s_add_u32 m0, s43, 73984
    s_mul_i32 s42, s43, 10
    buffer_load_dwordx4 v9, s[20:23], s42 offen lds
    s_add_u32 s43, s43, 4096
    s_sub_u32 s41, s43, 81920
    s_cselect_b32 s43, s43, s41
    s_add_u32 m0, s43, 73984
    s_mul_i32 s42, s43, 10
    buffer_load_dwordx4 v9, s[20:23], s42 offen lds
    s_add_u32 s43, s43, 4096
    s_sub_u32 s41, s43, 81920
    s_cselect_b32 s43, s43, s41
    s_add_u32 m0, s43, 73984
    s_mul_i32 s42, s43, 10
    buffer_load_dwordx4 v9, s[20:23], s42 offen lds
    s_add_u32 s43, s43, 4096
    s_sub_u32 s41, s43, 81920
    s_cselect_b32 s43, s43, s41
    s_add_u32 m0, s43, 73984
    s_mul_i32 s42, s43, 10
    buffer_load_dwordx4 v9, s[20:23], s42 offen lds
    s_add_u32 s43, s43, 4096
    s_sub_u32 s41, s43, 81920
    s_cselect_b32 s43, s43, s41
    s_add_u32 m0, s43, 73984
    s_mul_i32 s42, s43, 10
    buffer_load_dwordx4 v9, s[20:23], s42 offen lds
    s_add_u32 s43, s43, 4096
    s_sub_u32 s41, s43, 81920
    s_cselect_b32 s43, s43, s41
    s_add_u32 m0, s43, 73984
    s_mul_i32 s42, s43, 10
    buffer_load_dwordx4 v9, s[20:23], s42 offen lds
    s_add_u32 s43, s43, 4096
    s_sub_u32 s41, s43, 81920
    s_cselect_b32 s43, s43, s41
    s_add_u32 m0, s43, 73984
    s_mul_i32 s42, s43, 10
    buffer_load_dwordx4 v9, s[20:23], s42 offen lds
    s_add_u32 s43, s43, 4096
    s_sub_u32 s41, s43, 81920
    s_cselect_b32 s43, s43, s41
    s_add_u32 m0, s43, 73984
    s_mul_i32 s42, s43, 10
    buffer_load_dwordx4 v9, s[20:23], s42 offen lds
    s_add_u32 s43, s43, 4096
    s_sub_u32 s41, s43, 81920
    s_cselect_b32 s43, s43, s41
    s_add_u32 m0, s43, 73984
    s_mul_i32 s42, s43, 10
    buffer_load_dwordx4 v9, s[20:23], s42 offen lds
    s_add_u32 s43, s43, 4096
    s_sub_u32 s41, s43, 81920
    s_cselect_b32 s43, s43, s41
    v_lshrrev_b32 v9, 3, v2
    v_and_b32 v10, 7, v2
    v_mul_u32_u24 v9, 2560, v9
    v_lshl_add_u32 v181, v10, 4, v9
    s_lshl2_add_u32 s40, s6, s34
    s_lshl_b32 s40, s40, 9
    v_lshrrev_b32 v9, 5, v2
    v_lshl_add_u32 v10, v18, 4, s40
    v_lshl_add_u32 v182, v9, 15, v10
    v_lshrrev_b32 v10, 1, v10
    v_lshl_add_u32 v183, v9, 15, v10
    v_add_u32 v20, 40960, v168
    v_add_u32 v21, 40960, v169
    v_add_u32 v22, 40960, v170
    v_add_u32 v23, 40960, v171
    s_lshl2_add_u32 s45, s34, 163808
    v_mov_b32 v24, s45
    v_mov_b32 v26, 163748
    v_mov_b32 v27, 1
    s_mov_b32 s60, 0
L_sp_85:
    s_add_u32 s60, s60, 1
    s_cmp_gt_u32 s60, 1600000
    s_cbranch_scc1 L_spd_86
    s_buffer_load_dwordx16 s[64:79], s[16:19], s30 glc
    s_buffer_load_dwordx16 s[80:95], s[16:19], s30 offset:128 glc
    s_cmp_lg_u32 s60, 1
    s_cbranch_scc1 L_pfh_89
    s_waitcnt vmcnt(0)
    s_mov_b64 exec, 1
    ds_add_u32 v26, v27
    s_mov_b64 exec, -1
L_pfh_89:
    s_waitcnt lgkmcnt(0)
L_spc_87:
    s_and_b64 s[40:41], s[64:65], s[32:33]
    s_or_b64 s[42:43], s[64:65], s[32:33]
    s_and_b64 s[40:41], s[40:41], s[66:67]
    s_or_b64 s[42:43], s[42:43], s[66:67]
    s_and_b64 s[40:41], s[40:41], s[68:69]
    s_or_b64 s[42:43], s[42:43], s[68:69]
    s_and_b64 s[40:41], s[40:41], s[70:71]
    s_or_b64 s[42:43], s[42:43], s[70:71]
    s_and_b64 s[40:41], s[40:41], s[72:73]
    s_or_b64 s[42:43], s[42:43], s[72:73]
    s_and_b64 s[40:41], s[40:41], s[74:75]
    s_or_b64 s[42:43], s[42:43], s[74:75]
    s_and_b64 s[40:41], s[40:41], s[76:77]
    s_or_b64 s[42:43], s[42:43], s[76:77]
    s_and_b64 s[40:41], s[40:41], s[78:79]
    s_or_b64 s[42:43], s[42:43], s[78:79]
    s_cmp_lg_u64 s[40:41], s[42:43]
    s_cbranch_scc1 L_sp_85
L_spd_86:
    s_mov_b32 s41, 8388608
    buffer_load_dwordx4 v[184:187], v182, s[16:19], s41 offen sc1
    s_mov_b32 s41, 8454144
    buffer_load_dwordx4 v[188:191], v182, s[16:19], s41 offen sc1
    s_mov_b32 s41, 8519680
    buffer_load_dwordx4 v[192:195], v182, s[16:19], s41 offen sc1
    s_mov_b32 s41, 8585216
    buffer_load_dwordx4 v[196:199], v182, s[16:19], s41 offen sc1
    v_mov_b32 v9, 163748
    s_mov_b32 s60, 0
L_lw_90:
    ds_read_b32 v10, v9
    s_add_u32 s60, s60, 1
    s_waitcnt lgkmcnt(0)
    v_readfirstlane_b32 s40, v10
    s_cmp_gt_u32 s60, 1600000
    s_cbranch_scc1 L_lwd_91
    s_cmp_lt_u32 s40, 4
    s_cbranch_scc1 L_lw_90
L_lwd_91:
    ds_read_b64_tr_b16 v[32:33], v168 offset:0
    ds_read_b64_tr_b16 v[34:35], v168 offset:1024
    ds_read_b64_tr_b16 v[36:37], v169 offset:0
    ds_read_b64_tr_b16 v[38:39], v169 offset:1024
    ds_read_b64_tr_b16 v[40:41], v168 offset:3072
    ds_read_b64_tr_b16 v[42:43], v168 offset:4096
    ds_read_b64_tr_b16 v[44:45], v169 offset:3072
    ds_read_b64_tr_b16 v[46:47], v169 offset:4096
    ds_read_b64_tr_b16 v[48:49], v168 offset:5120
    ds_read_b64_tr_b16 v[50:51], v168 offset:6144
    ds_read_b64_tr_b16 v[52:53], v169 offset:5120
    ds_read_b64_tr_b16 v[54:55], v169 offset:6144
    s_mov_b32 s41, 10485760
    buffer_load_dwordx2 v[200:201], v183, s[16:19], s41 offen sc1
    s_mov_b32 s41, 10502144
    buffer_load_dwordx2 v[202:203], v183, s[16:19], s41 offen sc1
    s_mov_b32 s41, 8650752
    buffer_load_dwordx4 v[204:207], v182, s[16:19], s41 offen sc1
    s_mov_b32 s41, 8716288
    buffer_load_dwordx4 v[208:211], v182, s[16:19], s41 offen sc1
    s_mov_b32 s41, 8781824
    buffer_load_dwordx4 v[212:215], v182, s[16:19], s41 offen sc1
    s_mov_b32 s41, 8847360
    buffer_load_dwordx4 v[216:219], v182, s[16:19], s41 offen sc1
    s_mov_b32 s41, 10551296
    buffer_load_dwordx2 v[220:221], v183, s[16:19], s41 offen sc1
    s_mov_b32 s41, 10567680
    buffer_load_dwordx2 v[222:223], v183, s[16:19], s41 offen sc1
    s_waitcnt vmcnt(11)
    s_waitcnt lgkmcnt(8)
    v_mfma_f32_32x32x16_bf16 v[136:151], v[32:35], v[184:187], v[136:151]
    ds_read_b64_tr_b16 v[56:57], v168 offset:8192
    ds_read_b64_tr_b16 v[58:59], v168 offset:9216
    v_mfma_f32_32x32x16_bf16 v[152:167], v[36:39], v[184:187], v[152:167]
    ds_read_b64_tr_b16 v[60:61], v169 offset:8192
    ds_read_b64_tr_b16 v[62:63], v169 offset:9216
    s_waitcnt vmcnt(10)
    s_waitcnt lgkmcnt(8)
    v_mfma_f32_32x32x16_bf16 v[136:151], v[40:43], v[188:191], v[136:151]
    ds_read_b64_tr_b16 v[32:33], v170 offset:0
    ds_read_b64_tr_b16 v[34:35], v170 offset:512
    v_mfma_f32_32x32x16_bf16 v[152:167], v[44:47], v[188:191], v[152:167]
    ds_read_b64_tr_b16 v[36:37], v171 offset:0
    ds_read_b64_tr_b16 v[38:39], v171 offset:512
    s_waitcnt vmcnt(9)
    s_waitcnt lgkmcnt(8)
    v_mfma_f32_32x32x16_bf16 v[136:151], v[48:51], v[192:195], v[136:151]
    ds_read_b64_tr_b16 v[40:41], v168 offset:10240
    ds_read_b64_tr_b16 v[42:43], v168 offset:11264
    v_mfma_f32_32x32x16_bf16 v[152:167], v[52:55], v[192:195], v[152:167]
    ds_read_b64_tr_b16 v[44:45], v169 offset:10240
    ds_read_b64_tr_b16 v[46:47], v169 offset:11264
    s_waitcnt vmcnt(8)
    s_waitcnt lgkmcnt(8)
    v_mfma_f32_32x32x16_bf16 v[136:151], v[56:59], v[196:199], v[136:151]
    ds_read_b64_tr_b16 v[48:49], v168 offset:13312
    ds_read_b64_tr_b16 v[50:51], v168 offset:14336
    v_mfma_f32_32x32x16_bf16 v[152:167], v[60:63], v[196:199], v[152:167]
    ds_read_b64_tr_b16 v[52:53], v169 offset:13312
    ds_read_b64_tr_b16 v[54:55], v169 offset:14336
    s_mov_b32 s60, 0
    s_branch L_spc_94
L_sp_92:
    s_add_u32 s60, s60, 1
    s_cmp_gt_u32 s60, 1600000
    s_cbranch_scc1 L_spd_93
    s_buffer_load_dwordx16 s[64:79], s[16:19], s30 glc
    s_buffer_load_dwordx16 s[80:95], s[16:19], s30 offset:128 glc
    s_waitcnt lgkmcnt(0)
L_spc_94:
    s_and_b64 s[40:41], s[80:81], s[32:33]
    s_or_b64 s[42:43], s[80:81], s[32:33]
    s_and_b64 s[40:41], s[40:41], s[82:83]
    s_or_b64 s[42:43], s[42:43], s[82:83]
    s_and_b64 s[40:41], s[40:41], s[84:85]
    s_or_b64 s[42:43], s[42:43], s[84:85]
    s_and_b64 s[40:41], s[40:41], s[86:87]
    s_or_b64 s[42:43], s[42:43], s[86:87]
    s_and_b64 s[40:41], s[40:41], s[88:89]
    s_or_b64 s[42:43], s[42:43], s[88:89]
    s_and_b64 s[40:41], s[40:41], s[90:91]
    s_or_b64 s[42:43], s[42:43], s[90:91]
    s_and_b64 s[40:41], s[40:41], s[92:93]
    s_or_b64 s[42:43], s[42:43], s[92:93]
    s_and_b64 s[40:41], s[40:41], s[94:95]
    s_or_b64 s[42:43], s[42:43], s[94:95]
    s_cmp_lg_u64 s[40:41], s[42:43]
    s_cbranch_scc1 L_sp_92
L_spd_93:
    s_mov_b32 s41, 8912896
    buffer_load_dwordx4 v[224:227], v182, s[16:19], s41 offen sc1
    s_mov_b32 s41, 8978432
    buffer_load_dwordx4 v[228:231], v182, s[16:19], s41 offen sc1
    s_mov_b32 s41, 9043968
    buffer_load_dwordx4 v[232:235], v182, s[16:19], s41 offen sc1
    s_mov_b32 s41, 9109504
    buffer_load_dwordx4 v[236:239], v182, s[16:19], s41 offen sc1
    s_mov_b32 s41, 10616832
    buffer_load_dwordx2 v[240:241], v183, s[16:19], s41 offen sc1
    s_mov_b32 s41, 10633216
    buffer_load_dwordx2 v[242:243], v183, s[16:19], s41 offen sc1
    s_mov_b32 s41, 9175040
    buffer_load_dwordx4 v[244:247], v182, s[16:19], s41 offen sc1
    s_mov_b32 s41, 9240576
    buffer_load_dwordx4 v[184:187], v182, s[16:19], s41 offen sc1
    s_mov_b32 s41, 9306112
    buffer_load_dwordx4 v[188:191], v182, s[16:19], s41 offen sc1
    s_mov_b32 s41, 9371648
    buffer_load_dwordx4 v[192:195], v182, s[16:19], s41 offen sc1
    s_mov_b32 s41, 10682368
    buffer_load_dwordx2 v[196:197], v183, s[16:19], s41 offen sc1
    s_mov_b32 s41, 10698752
    buffer_load_dwordx2 v[198:199], v183, s[16:19], s41 offen sc1
    s_waitcnt vmcnt(18)
    s_waitcnt lgkmcnt(8)
    v_mfma_f32_32x32x16_bf16 v[136:151], v[32:35], v[200:203], v[136:151]
    ds_read_b64_tr_b16 v[56:57], v168 offset:15360
    ds_read_b64_tr_b16 v[58:59], v168 offset:16384
    v_mfma_f32_32x32x16_bf16 v[152:167], v[36:39], v[200:203], v[152:167]
    ds_read_b64_tr_b16 v[60:61], v169 offset:15360
    ds_read_b64_tr_b16 v[62:63], v169 offset:16384
    s_waitcnt vmcnt(17)
    s_waitcnt lgkmcnt(8)
    v_mfma_f32_32x32x16_bf16 v[136:151], v[40:43], v[204:207], v[136:151]
    ds_read_b64_tr_b16 v[32:33], v168 offset:18432
    ds_read_b64_tr_b16 v[34:35], v168 offset:19456
    v_mfma_f32_32x32x16_bf16 v[152:167], v[44:47], v[204:207], v[152:167]
    ds_read_b64_tr_b16 v[36:37], v169 offset:18432
    ds_read_b64_tr_b16 v[38:39], v169 offset:19456
    s_waitcnt vmcnt(16)
    s_waitcnt lgkmcnt(8)
    v_mfma_f32_32x32x16_bf16 v[136:151], v[48:51], v[208:211], v[136:151]
    ds_read_b64_tr_b16 v[40:41], v170 offset:10240
    ds_read_b64_tr_b16 v[42:43], v170 offset:10752
    v_mfma_f32_32x32x16_bf16 v[152:167], v[52:55], v[208:211], v[152:167]
    ds_read_b64_tr_b16 v[44:45], v171 offset:10240
    ds_read_b64_tr_b16 v[46:47], v171 offset:10752
    s_waitcnt vmcnt(15)
    s_waitcnt lgkmcnt(8)
    v_mfma_f32_32x32x16_bf16 v[136:151], v[56:59], v[212:215], v[136:151]
    ds_read_b64_tr_b16 v[48:49], v168 offset:20480
    ds_read_b64_tr_b16 v[50:51], v168 offset:21504
    v_mfma_f32_32x32x16_bf16 v[152:167], v[60:63], v[212:215], v[152:167]
    ds_read_b64_tr_b16 v[52:53], v169 offset:20480
    ds_read_b64_tr_b16 v[54:55], v169 offset:21504
    s_waitcnt vmcnt(14)
    s_waitcnt lgkmcnt(8)
    v_mfma_f32_32x32x16_bf16 v[136:151], v[32:35], v[216:219], v[136:151]
    ds_read_b64_tr_b16 v[56:57], v168 offset:23552
    ds_read_b64_tr_b16 v[58:59], v168 offset:24576
    v_mfma_f32_32x32x16_bf16 v[152:167], v[36:39], v[216:219], v[152:167]
    ds_read_b64_tr_b16 v[60:61], v169 offset:23552
    ds_read_b64_tr_b16 v[62:63], v169 offset:24576
    s_waitcnt vmcnt(12)
    s_waitcnt lgkmcnt(8)
    v_mfma_f32_32x32x16_bf16 v[136:151], v[40:43], v[220:223], v[136:151]
    ds_read_b64_tr_b16 v[32:33], v168 offset:25600
    ds_read_b64_tr_b16 v[34:35], v168 offset:26624
    v_mfma_f32_32x32x16_bf16 v[152:167], v[44:47], v[220:223], v[152:167]
    ds_read_b64_tr_b16 v[36:37], v169 offset:25600
    ds_read_b64_tr_b16 v[38:39], v169 offset:26624
    s_waitcnt vmcnt(11)
    s_waitcnt lgkmcnt(8)
    v_mfma_f32_32x32x16_bf16 v[136:151], v[48:51], v[224:227], v[136:151]
    ds_read_b64_tr_b16 v[40:41], v168 offset:28672
    ds_read_b64_tr_b16 v[42:43], v168 offset:29696
    v_mfma_f32_32x32x16_bf16 v[152:167], v[52:55], v[224:227], v[152:167]
    ds_read_b64_tr_b16 v[44:45], v169 offset:28672
    ds_read_b64_tr_b16 v[46:47], v169 offset:29696
    s_waitcnt vmcnt(10)
    s_waitcnt lgkmcnt(8)
    v_mfma_f32_32x32x16_bf16 v[136:151], v[56:59], v[228:231], v[136:151]
    ds_read_b64_tr_b16 v[48:49], v170 offset:20480
    ds_read_b64_tr_b16 v[50:51], v170 offset:20992
    v_mfma_f32_32x32x16_bf16 v[152:167], v[60:63], v[228:231], v[152:167]
    ds_read_b64_tr_b16 v[52:53], v171 offset:20480
    ds_read_b64_tr_b16 v[54:55], v171 offset:20992
    ds_read_b32 v25, v24
    s_waitcnt vmcnt(9)
    s_waitcnt lgkmcnt(9)
    v_mfma_f32_32x32x16_bf16 v[136:151], v[32:35], v[232:235], v[136:151]
    ds_read_b64_tr_b16 v[56:57], v168 offset:30720
    ds_read_b64_tr_b16 v[58:59], v168 offset:31744
    v_mfma_f32_32x32x16_bf16 v[152:167], v[36:39], v[232:235], v[152:167]
    ds_read_b64_tr_b16 v[60:61], v169 offset:30720
    ds_read_b64_tr_b16 v[62:63], v169 offset:31744
    s_waitcnt vmcnt(8)
    s_waitcnt lgkmcnt(9)
    v_mfma_f32_32x32x16_bf16 v[136:151], v[40:43], v[236:239], v[136:151]
    ds_read_b64_tr_b16 v[32:33], v168 offset:33792
    ds_read_b64_tr_b16 v[34:35], v168 offset:34816
    v_mfma_f32_32x32x16_bf16 v[152:167], v[44:47], v[236:239], v[152:167]
    ds_read_b64_tr_b16 v[36:37], v169 offset:33792
    ds_read_b64_tr_b16 v[38:39], v169 offset:34816
    s_waitcnt lgkmcnt(8)
    v_readfirstlane_b32 s40, v25
    s_cmp_ge_u32 s40, 1
    s_cbranch_scc1 L_ob_96
    v_mov_b32 v9, s45
    s_mov_b32 s60, 0
L_lw_97:
    ds_read_b32 v10, v9
    s_add_u32 s60, s60, 1
    s_waitcnt lgkmcnt(0)
    v_readfirstlane_b32 s40, v10
    s_cmp_gt_u32 s60, 1600000
    s_cbranch_scc1 L_lwd_98
    s_cmp_lt_u32 s40, 1
    s_cbranch_scc1 L_lw_97
L_lwd_98:
L_ob_96:
    s_mov_b32 s41, 9437184
    buffer_load_dwordx4 v[200:203], v182, s[16:19], s41 offen sc1
    s_mov_b32 s41, 9502720
    buffer_load_dwordx4 v[204:207], v182, s[16:19], s41 offen sc1
    s_mov_b32 s41, 9568256
    buffer_load_dwordx4 v[208:211], v182, s[16:19], s41 offen sc1
    s_mov_b32 s41, 9633792
    buffer_load_dwordx4 v[212:215], v182, s[16:19], s41 offen sc1
    s_mov_b32 s41, 10747904
    buffer_load_dwordx2 v[216:217], v183, s[16:19], s41 offen sc1
    s_mov_b32 s41, 10764288
    buffer_load_dwordx2 v[218:219], v183, s[16:19], s41 offen sc1
    s_mov_b32 s41, 9699328
    buffer_load_dwordx4 v[220:223], v182, s[16:19], s41 offen sc1
    s_mov_b32 s41, 9764864
    buffer_load_dwordx4 v[224:227], v182, s[16:19], s41 offen sc1
    s_waitcnt vmcnt(14)
    v_mfma_f32_32x32x16_bf16 v[136:151], v[48:51], v[240:243], v[136:151]
    ds_read_b64_tr_b16 v[40:41], v168 offset:35840
    ds_read_b64_tr_b16 v[42:43], v168 offset:36864
    v_mfma_f32_32x32x16_bf16 v[152:167], v[52:55], v[240:243], v[152:167]
    ds_read_b64_tr_b16 v[44:45], v169 offset:35840
    ds_read_b64_tr_b16 v[46:47], v169 offset:36864
    s_mov_b32 s41, 9830400
    buffer_load_dwordx4 v[228:231], v182, s[16:19], s41 offen sc1
    s_waitcnt vmcnt(14)
    s_waitcnt lgkmcnt(8)
    v_mfma_f32_32x32x16_bf16 v[136:151], v[56:59], v[244:247], v[136:151]
    ds_read_b64_tr_b16 v[48:49], v168 offset:38912
    ds_read_b64_tr_b16 v[50:51], v168 offset:39936
    v_mfma_f32_32x32x16_bf16 v[152:167], v[60:63], v[244:247], v[152:167]
    ds_read_b64_tr_b16 v[52:53], v169 offset:38912
    ds_read_b64_tr_b16 v[54:55], v169 offset:39936
    s_mov_b32 s41, 9895936
    buffer_load_dwordx4 v[232:235], v182, s[16:19], s41 offen sc1
    s_waitcnt vmcnt(14)
    s_waitcnt lgkmcnt(8)
    v_mfma_f32_32x32x16_bf16 v[136:151], v[32:35], v[184:187], v[136:151]
    ds_read_b64_tr_b16 v[56:57], v170 offset:30720
    ds_read_b64_tr_b16 v[58:59], v170 offset:31232
    v_mfma_f32_32x32x16_bf16 v[152:167], v[36:39], v[184:187], v[152:167]
    ds_read_b64_tr_b16 v[60:61], v171 offset:30720
    ds_read_b64_tr_b16 v[62:63], v171 offset:31232
    s_mov_b32 s41, 10813440
    buffer_load_dwordx2 v[236:237], v183, s[16:19], s41 offen sc1
    s_mov_b32 s41, 10829824
    buffer_load_dwordx2 v[238:239], v183, s[16:19], s41 offen sc1
    s_waitcnt vmcnt(15)
    s_waitcnt lgkmcnt(8)
    v_mfma_f32_32x32x16_bf16 v[136:151], v[40:43], v[188:191], v[136:151]
    ds_read_b64_tr_b16 v[32:33], v20 offset:0
    ds_read_b64_tr_b16 v[34:35], v20 offset:1024
    v_mfma_f32_32x32x16_bf16 v[152:167], v[44:47], v[188:191], v[152:167]
    ds_read_b64_tr_b16 v[36:37], v21 offset:0
    ds_read_b64_tr_b16 v[38:39], v21 offset:1024
    s_waitcnt vmcnt(14)
    s_waitcnt lgkmcnt(8)
    v_mfma_f32_32x32x16_bf16 v[136:151], v[48:51], v[192:195], v[136:151]
    ds_read_b64_tr_b16 v[40:41], v20 offset:3072
    ds_read_b64_tr_b16 v[42:43], v20 offset:4096
    v_mfma_f32_32x32x16_bf16 v[152:167], v[52:55], v[192:195], v[152:167]
    ds_read_b64_tr_b16 v[44:45], v21 offset:3072
    ds_read_b64_tr_b16 v[46:47], v21 offset:4096
    s_waitcnt vmcnt(12)
    s_waitcnt lgkmcnt(8)
    v_mfma_f32_32x32x16_bf16 v[136:151], v[56:59], v[196:199], v[136:151]
    ds_read_b64_tr_b16 v[48:49], v20 offset:5120
    ds_read_b64_tr_b16 v[50:51], v20 offset:6144
    v_mfma_f32_32x32x16_bf16 v[152:167], v[60:63], v[196:199], v[152:167]
    ds_read_b64_tr_b16 v[52:53], v21 offset:5120
    ds_read_b64_tr_b16 v[54:55], v21 offset:6144
    s_waitcnt vmcnt(11)
    s_waitcnt lgkmcnt(8)
    v_mfma_f32_32x32x16_bf16 v[136:151], v[32:35], v[200:203], v[136:151]
    ds_read_b64_tr_b16 v[56:57], v20 offset:8192
    ds_read_b64_tr_b16 v[58:59], v20 offset:9216
    v_mfma_f32_32x32x16_bf16 v[152:167], v[36:39], v[200:203], v[152:167]
    ds_read_b64_tr_b16 v[60:61], v21 offset:8192
    ds_read_b64_tr_b16 v[62:63], v21 offset:9216
    s_waitcnt vmcnt(10)
    s_waitcnt lgkmcnt(8)
    v_mfma_f32_32x32x16_bf16 v[136:151], v[40:43], v[204:207], v[136:151]
    ds_read_b64_tr_b16 v[32:33], v22 offset:0
    ds_read_b64_tr_b16 v[34:35], v22 offset:512
    v_mfma_f32_32x32x16_bf16 v[152:167], v[44:47], v[204:207], v[152:167]
    ds_read_b64_tr_b16 v[36:37], v23 offset:0
    ds_read_b64_tr_b16 v[38:39], v23 offset:512
    ds_read_b32 v25, v24
    s_waitcnt vmcnt(9)
    s_waitcnt lgkmcnt(9)
    v_mfma_f32_32x32x16_bf16 v[136:151], v[48:51], v[208:211], v[136:151]
    ds_read_b64_tr_b16 v[40:41], v20 offset:10240
    ds_read_b64_tr_b16 v[42:43], v20 offset:11264
    v_mfma_f32_32x32x16_bf16 v[152:167], v[52:55], v[208:211], v[152:167]
    ds_read_b64_tr_b16 v[44:45], v21 offset:10240
    ds_read_b64_tr_b16 v[46:47], v21 offset:11264
    s_waitcnt vmcnt(8)
    s_waitcnt lgkmcnt(9)
    v_mfma_f32_32x32x16_bf16 v[136:151], v[56:59], v[212:215], v[136:151]
    ds_read_b64_tr_b16 v[48:49], v20 offset:13312
    ds_read_b64_tr_b16 v[50:51], v20 offset:14336
    v_mfma_f32_32x32x16_bf16 v[152:167], v[60:63], v[212:215], v[152:167]
    ds_read_b64_tr_b16 v[52:53], v21 offset:13312
    ds_read_b64_tr_b16 v[54:55], v21 offset:14336
    s_waitcnt lgkmcnt(8)
    v_readfirstlane_b32 s40, v25
    s_cmp_ge_u32 s40, 2
    s_cbranch_scc1 L_ob_99
    v_mov_b32 v9, s45
    s_mov_b32 s60, 0
L_lw_100:
    ds_read_b32 v10, v9
    s_add_u32 s60, s60, 1
    s_waitcnt lgkmcnt(0)
    v_readfirstlane_b32 s40, v10
    s_cmp_gt_u32 s60, 1600000
    s_cbranch_scc1 L_lwd_101
    s_cmp_lt_u32 s40, 2
    s_cbranch_scc1 L_lw_100
L_lwd_101:
L_ob_99:
    s_mov_b32 s41, 9961472
    buffer_load_dwordx4 v[240:243], v182, s[16:19], s41 offen sc1
    s_mov_b32 s41, 10027008
    buffer_load_dwordx4 v[244:247], v182, s[16:19], s41 offen sc1
    s_mov_b32 s41, 10092544
    buffer_load_dwordx4 v[184:187], v182, s[16:19], s41 offen sc1
    s_mov_b32 s41, 10158080
    buffer_load_dwordx4 v[188:191], v182, s[16:19], s41 offen sc1
    s_mov_b32 s41, 10878976
    buffer_load_dwordx2 v[192:193], v183, s[16:19], s41 offen sc1
    s_mov_b32 s41, 10895360
    buffer_load_dwordx2 v[194:195], v183, s[16:19], s41 offen sc1
    s_mov_b32 s41, 10223616
    buffer_load_dwordx4 v[196:199], v182, s[16:19], s41 offen sc1
    s_mov_b32 s41, 10289152
    buffer_load_dwordx4 v[200:203], v182, s[16:19], s41 offen sc1
    s_waitcnt vmcnt(14)
    v_mfma_f32_32x32x16_bf16 v[136:151], v[32:35], v[216:219], v[136:151]
    ds_read_b64_tr_b16 v[56:57], v20 offset:15360
    ds_read_b64_tr_b16 v[58:59], v20 offset:16384
    v_mfma_f32_32x32x16_bf16 v[152:167], v[36:39], v[216:219], v[152:167]
    ds_read_b64_tr_b16 v[60:61], v21 offset:15360
    ds_read_b64_tr_b16 v[62:63], v21 offset:16384
    s_mov_b32 s41, 10354688
    buffer_load_dwordx4 v[204:207], v182, s[16:19], s41 offen sc1
    s_waitcnt vmcnt(14)
    s_waitcnt lgkmcnt(8)
    v_mfma_f32_32x32x16_bf16 v[136:151], v[40:43], v[220:223], v[136:151]
    ds_read_b64_tr_b16 v[32:33], v20 offset:18432
    ds_read_b64_tr_b16 v[34:35], v20 offset:19456
    v_mfma_f32_32x32x16_bf16 v[152:167], v[44:47], v[220:223], v[152:167]
    ds_read_b64_tr_b16 v[36:37], v21 offset:18432
    ds_read_b64_tr_b16 v[38:39], v21 offset:19456
    s_mov_b32 s41, 10420224
    buffer_load_dwordx4 v[208:211], v182, s[16:19], s41 offen sc1
    s_waitcnt vmcnt(14)
    s_waitcnt lgkmcnt(8)
    v_mfma_f32_32x32x16_bf16 v[136:151], v[48:51], v[224:227], v[136:151]
    ds_read_b64_tr_b16 v[40:41], v22 offset:10240
    ds_read_b64_tr_b16 v[42:43], v22 offset:10752
    v_mfma_f32_32x32x16_bf16 v[152:167], v[52:55], v[224:227], v[152:167]
    ds_read_b64_tr_b16 v[44:45], v23 offset:10240
    ds_read_b64_tr_b16 v[46:47], v23 offset:10752
    s_mov_b32 s41, 10944512
    buffer_load_dwordx2 v[212:213], v183, s[16:19], s41 offen sc1
    s_mov_b32 s41, 10960896
    buffer_load_dwordx2 v[214:215], v183, s[16:19], s41 offen sc1
    s_waitcnt vmcnt(15)
    s_waitcnt lgkmcnt(8)
    v_mfma_f32_32x32x16_bf16 v[136:151], v[56:59], v[228:231], v[136:151]
    ds_read_b64_tr_b16 v[48:49], v20 offset:20480
    ds_read_b64_tr_b16 v[50:51], v20 offset:21504
    v_mfma_f32_32x32x16_bf16 v[152:167], v[60:63], v[228:231], v[152:167]
    ds_read_b64_tr_b16 v[52:53], v21 offset:20480
    ds_read_b64_tr_b16 v[54:55], v21 offset:21504
    s_waitcnt vmcnt(14)
    s_waitcnt lgkmcnt(8)
    v_mfma_f32_32x32x16_bf16 v[136:151], v[32:35], v[232:235], v[136:151]
    ds_read_b64_tr_b16 v[56:57], v20 offset:23552
    ds_read_b64_tr_b16 v[58:59], v20 offset:24576
    v_mfma_f32_32x32x16_bf16 v[152:167], v[36:39], v[232:235], v[152:167]
    ds_read_b64_tr_b16 v[60:61], v21 offset:23552
    ds_read_b64_tr_b16 v[62:63], v21 offset:24576
    s_waitcnt vmcnt(12)
    s_waitcnt lgkmcnt(8)
    v_mfma_f32_32x32x16_bf16 v[136:151], v[40:43], v[236:239], v[136:151]
    ds_read_b64_tr_b16 v[32:33], v20 offset:25600
    ds_read_b64_tr_b16 v[34:35], v20 offset:26624
    v_mfma_f32_32x32x16_bf16 v[152:167], v[44:47], v[236:239], v[152:167]
    ds_read_b64_tr_b16 v[36:37], v21 offset:25600
    ds_read_b64_tr_b16 v[38:39], v21 offset:26624
    s_waitcnt vmcnt(11)
    s_waitcnt lgkmcnt(8)
    v_mfma_f32_32x32x16_bf16 v[136:151], v[48:51], v[240:243], v[136:151]
    ds_read_b64_tr_b16 v[40:41], v20 offset:28672
    ds_read_b64_tr_b16 v[42:43], v20 offset:29696
    v_mfma_f32_32x32x16_bf16 v[152:167], v[52:55], v[240:243], v[152:167]
    ds_read_b64_tr_b16 v[44:45], v21 offset:28672
    ds_read_b64_tr_b16 v[46:47], v21 offset:29696
    s_waitcnt vmcnt(10)
    s_waitcnt lgkmcnt(8)
    v_mfma_f32_32x32x16_bf16 v[136:151], v[56:59], v[244:247], v[136:151]
    ds_read_b64_tr_b16 v[48:49], v22 offset:20480
    ds_read_b64_tr_b16 v[50:51], v22 offset:20992
    v_mfma_f32_32x32x16_bf16 v[152:167], v[60:63], v[244:247], v[152:167]
    ds_read_b64_tr_b16 v[52:53], v23 offset:20480
    ds_read_b64_tr_b16 v[54:55], v23 offset:20992
    s_waitcnt vmcnt(9)
    s_waitcnt lgkmcnt(8)
    v_mfma_f32_32x32x16_bf16 v[136:151], v[32:35], v[184:187], v[136:151]
    ds_read_b64_tr_b16 v[56:57], v20 offset:30720
    ds_read_b64_tr_b16 v[58:59], v20 offset:31744
    v_mfma_f32_32x32x16_bf16 v[152:167], v[36:39], v[184:187], v[152:167]
    ds_read_b64_tr_b16 v[60:61], v21 offset:30720
    ds_read_b64_tr_b16 v[62:63], v21 offset:31744
    s_waitcnt vmcnt(8)
    s_waitcnt lgkmcnt(8)
    v_mfma_f32_32x32x16_bf16 v[136:151], v[40:43], v[188:191], v[136:151]
    ds_read_b64_tr_b16 v[32:33], v20 offset:33792
    ds_read_b64_tr_b16 v[34:35], v20 offset:34816
    v_mfma_f32_32x32x16_bf16 v[152:167], v[44:47], v[188:191], v[152:167]
    ds_read_b64_tr_b16 v[36:37], v21 offset:33792
    ds_read_b64_tr_b16 v[38:39], v21 offset:34816
    s_waitcnt vmcnt(6)
    s_waitcnt lgkmcnt(8)
    v_mfma_f32_32x32x16_bf16 v[136:151], v[48:51], v[192:195], v[136:151]
    ds_read_b64_tr_b16 v[40:41], v20 offset:35840
    ds_read_b64_tr_b16 v[42:43], v20 offset:36864
    v_mfma_f32_32x32x16_bf16 v[152:167], v[52:55], v[192:195], v[152:167]
    ds_read_b64_tr_b16 v[44:45], v21 offset:35840
    ds_read_b64_tr_b16 v[46:47], v21 offset:36864
    s_waitcnt vmcnt(5)
    s_waitcnt lgkmcnt(8)
    v_mfma_f32_32x32x16_bf16 v[136:151], v[56:59], v[196:199], v[136:151]
    ds_read_b64_tr_b16 v[48:49], v20 offset:38912
    ds_read_b64_tr_b16 v[50:51], v20 offset:39936
    v_mfma_f32_32x32x16_bf16 v[152:167], v[60:63], v[196:199], v[152:167]
    ds_read_b64_tr_b16 v[52:53], v21 offset:38912
    ds_read_b64_tr_b16 v[54:55], v21 offset:39936
    s_waitcnt vmcnt(4)
    s_waitcnt lgkmcnt(8)
    v_mfma_f32_32x32x16_bf16 v[136:151], v[32:35], v[200:203], v[136:151]
    ds_read_b64_tr_b16 v[56:57], v22 offset:30720
    ds_read_b64_tr_b16 v[58:59], v22 offset:31232
    v_mfma_f32_32x32x16_bf16 v[152:167], v[36:39], v[200:203], v[152:167]
    ds_read_b64_tr_b16 v[60:61], v23 offset:30720
    ds_read_b64_tr_b16 v[62:63], v23 offset:31232
    s_waitcnt vmcnt(3)
    s_waitcnt lgkmcnt(8)
    v_mfma_f32_32x32x16_bf16 v[136:151], v[40:43], v[204:207], v[136:151]
    v_mfma_f32_32x32x16_bf16 v[152:167], v[44:47], v[204:207], v[152:167]
    s_waitcnt vmcnt(2)
    s_waitcnt lgkmcnt(4)
    v_mfma_f32_32x32x16_bf16 v[136:151], v[48:51], v[208:211], v[136:151]
    v_mfma_f32_32x32x16_bf16 v[152:167], v[52:55], v[208:211], v[152:167]
    s_waitcnt vmcnt(0)
    s_waitcnt lgkmcnt(0)
    v_mfma_f32_32x32x16_bf16 v[136:151], v[56:59], v[212:215], v[136:151]
    v_mfma_f32_32x32x16_bf16 v[152:167], v[60:63], v[212:215], v[152:167]
    s_nop 10
    v_cvt_pk_bf16_f32 v96, v136, v137
    v_cvt_pk_bf16_f32 v97, v138, v139
    ds_write_b64 v172, v[96:97]
    v_cvt_pk_bf16_f32 v98, v140, v141
    v_cvt_pk_bf16_f32 v99, v142, v143
    ds_write_b64 v173, v[98:99]
    v_cvt_pk_bf16_f32 v100, v144, v145
    v_cvt_pk_bf16_f32 v101, v146, v147
    ds_write_b64 v174, v[100:101]
    v_cvt_pk_bf16_f32 v102, v148, v149
    v_cvt_pk_bf16_f32 v103, v150, v151
    ds_write_b64 v175, v[102:103]
    v_cvt_pk_bf16_f32 v104, v152, v153
    v_cvt_pk_bf16_f32 v105, v154, v155
    ds_write_b64 v176, v[104:105]
    v_cvt_pk_bf16_f32 v106, v156, v157
    v_cvt_pk_bf16_f32 v107, v158, v159
    ds_write_b64 v177, v[106:107]
    v_cvt_pk_bf16_f32 v108, v160, v161
    v_cvt_pk_bf16_f32 v109, v162, v163
    ds_write_b64 v178, v[108:109]
    v_cvt_pk_bf16_f32 v110, v164, v165
    v_cvt_pk_bf16_f32 v111, v166, v167
    ds_write_b64 v179, v[110:111]
    ds_read_b128 v[32:35], v180 offset:0
    ds_read_b128 v[36:39], v180 offset:1024
    ds_read_b128 v[40:43], v180 offset:2048
    ds_read_b128 v[44:47], v180 offset:3072
    s_add_u32 s40, s31, 0
    s_waitcnt lgkmcnt(3)
    buffer_store_dwordx4 v[32:35], v181, s[24:27], s40 offen sc1
    s_add_u32 s40, s31, 20480
    s_waitcnt lgkmcnt(2)
    buffer_store_dwordx4 v[36:39], v181, s[24:27], s40 offen sc1
    s_add_u32 s40, s31, 40960
    s_waitcnt lgkmcnt(1)
    buffer_store_dwordx4 v[40:43], v181, s[24:27], s40 offen sc1
    s_add_u32 s40, s31, 61440
    s_waitcnt lgkmcnt(0)
    buffer_store_dwordx4 v[44:47], v181, s[24:27], s40 offen sc1
L_FIN:
L_end:
    s_endpgm
L_EXACT:
    s_mov_b32 s63, 1
    s_mov_b32 exec_lo, 0
    v_mov_b32 v16, 0
    v_mov_b32 v17, 0x3f800000
    s_mov_b32 exec_lo, -1
    v_mov_b32 v7, 0xf149f2ca
    v_mov_b32 v8, 0xf149f2ca
    ds_read_b128 v[80:83], v6 offset:128
    ds_read_b128 v[84:87], v6 offset:160
    ds_read_b128 v[88:91], v6 offset:192
    ds_read_b128 v[92:95], v6 offset:224
    ds_read_b128 v[20:23], v3 offset:0
    ds_read_b64 v[24:25], v4 offset:0
    ds_read_b128 v[26:29], v3 offset:512
    ds_read_b64 v[30:31], v4 offset:512
    s_waitcnt lgkmcnt(2)
    v_mfma_f32_32x32x16_bf16 v[48:63], v[20:23], v[12:15], v[80:95]
    v_mfma_f32_32x32x8bf16_1k v[48:63], v[24:25], v[16:17], v[48:63]
    ds_read_b128 v[20:23], v3 offset:1024
    ds_read_b64 v[24:25], v4 offset:1024
    s_nop 9
    s_waitcnt lgkmcnt(2)
    v_mfma_f32_32x32x16_bf16 v[64:79], v[26:29], v[12:15], 0
    v_mfma_f32_32x32x8bf16_1k v[64:79], v[30:31], v[16:17], v[64:79]
    ds_read_b128 v[26:29], v3 offset:1536
    ds_read_b64 v[30:31], v4 offset:1536
    s_nop 1
    v_max3_f32 v7, v7, v48, v49
    v_max3_f32 v8, v8, v50, v51
    v_max3_f32 v7, v7, v52, v53
    v_max3_f32 v8, v8, v54, v55
    v_max3_f32 v7, v7, v56, v57
    v_max3_f32 v8, v8, v58, v59
    v_max3_f32 v7, v7, v60, v61
    v_max3_f32 v8, v8, v62, v63
    s_waitcnt lgkmcnt(2)
    v_mfma_f32_32x32x16_bf16 v[48:63], v[20:23], v[12:15], 0
    v_mfma_f32_32x32x8bf16_1k v[48:63], v[24:25], v[16:17], v[48:63]
    ds_read_b128 v[20:23], v3 offset:2048
    ds_read_b64 v[24:25], v4 offset:2048
    ds_read_b128 v[80:83], v6 offset:0
    ds_read_b128 v[84:87], v6 offset:32
    ds_read_b128 v[88:91], v6 offset:64
    ds_read_b128 v[92:95], v6 offset:96
    s_nop 1
    v_max3_f32 v7, v7, v64, v65
    v_max3_f32 v8, v8, v66, v67
    v_max3_f32 v7, v7, v68, v69
    v_max3_f32 v8, v8, v70, v71
    v_max3_f32 v7, v7, v72, v73
    v_max3_f32 v8, v8, v74, v75
    v_max3_f32 v7, v7, v76, v77
    v_max3_f32 v8, v8, v78, v79
    s_waitcnt lgkmcnt(6)
    v_mfma_f32_32x32x16_bf16 v[64:79], v[26:29], v[12:15], 0
    v_mfma_f32_32x32x8bf16_1k v[64:79], v[30:31], v[16:17], v[64:79]
    ds_read_b128 v[26:29], v3 offset:2560
    ds_read_b64 v[30:31], v4 offset:2560
    s_nop 1
    v_max3_f32 v7, v7, v48, v49
    v_max3_f32 v8, v8, v50, v51
    v_max3_f32 v7, v7, v52, v53
    v_max3_f32 v8, v8, v54, v55
    v_max3_f32 v7, v7, v56, v57
    v_max3_f32 v8, v8, v58, v59
    v_max3_f32 v7, v7, v60, v61
    v_max3_f32 v8, v8, v62, v63
    s_waitcnt lgkmcnt(6)
    v_mfma_f32_32x32x16_bf16 v[48:63], v[20:23], v[12:15], 0
    v_mfma_f32_32x32x8bf16_1k v[48:63], v[24:25], v[16:17], v[48:63]
    ds_read_b128 v[20:23], v3 offset:3072
    ds_read_b64 v[24:25], v4 offset:3072
    s_nop 1
    v_max3_f32 v7, v7, v64, v65
    v_max3_f32 v8, v8, v66, v67
    v_max3_f32 v7, v7, v68, v69
    v_max3_f32 v8, v8, v70, v71
    v_max3_f32 v7, v7, v72, v73
    v_max3_f32 v8, v8, v74, v75
    v_max3_f32 v7, v7, v76, v77
    v_max3_f32 v8, v8, v78, v79
    s_waitcnt lgkmcnt(2)
    v_mfma_f32_32x32x16_bf16 v[64:79], v[26:29], v[12:15], 0
    v_mfma_f32_32x32x8bf16_1k v[64:79], v[30:31], v[16:17], v[64:79]
    ds_read_b128 v[26:29], v3 offset:3584
    ds_read_b64 v[30:31], v4 offset:3584
    s_nop 1
    v_max3_f32 v7, v7, v48, v49
    v_max3_f32 v8, v8, v50, v51
    v_max3_f32 v7, v7, v52, v53
    v_max3_f32 v8, v8, v54, v55
    v_max3_f32 v7, v7, v56, v57
    v_max3_f32 v8, v8, v58, v59
    v_max3_f32 v7, v7, v60, v61
    v_max3_f32 v8, v8, v62, v63
    s_waitcnt lgkmcnt(2)
    v_mfma_f32_32x32x16_bf16 v[48:63], v[20:23], v[12:15], 0
    v_mfma_f32_32x32x8bf16_1k v[48:63], v[24:25], v[16:17], v[48:63]
    ds_read_b128 v[20:23], v3 offset:4096
    ds_read_b64 v[24:25], v4 offset:4096
    s_nop 1
    v_max3_f32 v7, v7, v64, v65
    v_max3_f32 v8, v8, v66, v67
    v_max3_f32 v7, v7, v68, v69
    v_max3_f32 v8, v8, v70, v71
    v_max3_f32 v7, v7, v72, v73
    v_max3_f32 v8, v8, v74, v75
    v_max3_f32 v7, v7, v76, v77
    v_max3_f32 v8, v8, v78, v79
    s_waitcnt lgkmcnt(2)
    v_mfma_f32_32x32x16_bf16 v[64:79], v[26:29], v[12:15], 0
    v_mfma_f32_32x32x8bf16_1k v[64:79], v[30:31], v[16:17], v[64:79]
    s_nop 1
    v_max3_f32 v7, v7, v48, v49
    v_max3_f32 v8, v8, v50, v51
    v_max3_f32 v7, v7, v52, v53
    v_max3_f32 v8, v8, v54, v55
    v_max3_f32 v7, v7, v56, v57
    v_max3_f32 v8, v8, v58, v59
    v_max3_f32 v7, v7, v60, v61
    v_max3_f32 v8, v8, v62, v63
    s_waitcnt lgkmcnt(0)
    v_mfma_f32_32x32x16_bf16 v[48:63], v[20:23], v[12:15], v[80:95]
    v_mfma_f32_32x32x8bf16_1k v[48:63], v[24:25], v[16:17], v[48:63]
    s_nop 9
    v_max3_f32 v7, v7, v64, v65
    v_max3_f32 v8, v8, v66, v67
    v_max3_f32 v7, v7, v68, v69
    v_max3_f32 v8, v8, v70, v71
    v_max3_f32 v7, v7, v72, v73
    v_max3_f32 v8, v8, v74, v75
    v_max3_f32 v7, v7, v76, v77
    v_max3_f32 v8, v8, v78, v79
    ds_read_b128 v[20:23], v3 offset:3072
    ds_read_b64 v[24:25], v4 offset:3072
    v_max3_f32 v7, v7, v48, v49
    v_max3_f32 v8, v8, v50, v51
    v_max3_f32 v7, v7, v52, v53
    v_max3_f32 v8, v8, v54, v55
    v_max3_f32 v7, v7, v56, v57
    v_max3_f32 v8, v8, v58, v59
    v_max3_f32 v7, v7, v60, v61
    v_max3_f32 v8, v8, v62, v63
    v_max_f32 v7, v7, v8
    v_mov_b32 v8, v7
    s_nop 1
    v_permlane32_swap_b32 v7, v8
    s_nop 0
    v_max_f32 v7, v7, v8
    v_sub_f32 v7, 0, v7
    v_mov_b32 v10, 0
    v_mov_b32 v11, 0
    s_mov_b32 exec_lo, 0
    v_and_b32 v8, 0xffff0000, v7
    v_sub_f32 v9, v7, v8
    v_and_b32 v10, 0xffff0000, v9
    v_sub_f32 v11, v9, v10
    v_lshrrev_b32 v8, 16, v8
    v_lshrrev_b32 v11, 16, v11
    v_or_b32 v10, v10, v8
    v_or_b32 v17, 0x3f800000, v11
    v_mov_b32 v16, v10
    s_mov_b32 exec_lo, -1
    s_branch L_P2
L_SHORT:
    s_waitcnt lgkmcnt(0)
    v_mfma_f32_32x32x16_bf16 v[112:127], v[40:43], v[104:107], v[112:127]
    v_mfma_f32_32x32x16_bf16 v[112:127], v[44:47], v[108:111], v[112:127]
    s_branch L_PVD
L_codeend:
.section .rodata,"a"
.p2align 6
.amdhsa_kernel concat_heads__spectral_fnet__sliding_block__prompt_kernel
  .amdhsa_next_free_vgpr 256
  .amdhsa_next_free_sgpr 102
  .amdhsa_accum_offset 256
  .amdhsa_group_segment_fixed_size 0
  .amdhsa_kernarg_size 88
  .amdhsa_user_sgpr_count 2
  .amdhsa_user_sgpr_kernarg_segment_ptr 1
  .amdhsa_system_sgpr_workgroup_id_x 1
.end_amdhsa_kernel
```
